```python
import torch

def _softmax(x, axis=-1):
    return torch.softmax(x, dim=axis)
def _gelu(x):
    return torch.nn.functional.gelu(x, approximate="tanh")
def _silu(x):
    return torch.nn.functional.silu(x)
def _sigmoid(x):
    return torch.sigmoid(x)
def _layernorm(x, axis=-1, eps=1e-5):
    m = x.mean(dim=axis, keepdim=True)
    v = x.var(dim=axis, keepdim=True, unbiased=False)
    return (x - m) / torch.sqrt(v + eps)
def _scatter_add(tgt, idx, src, axis=0):
    return tgt.clone().index_add_(axis, idx, src)
def _segment_sum(src, seg, n):
    out = torch.zeros((n,) + src.shape[1:], dtype=src.dtype)
    return out.index_add_(0, seg, src)
def _pad(x, pw):
    flat = tuple(v for pair in reversed(pw) for v in pair)
    return torch.nn.functional.pad(x, flat)

kernel_name = 'parallel_sum__ssm_conv_s4__dense_activation_mish__prompt'

def setup_inputs():

    _w = (lambda a: (lambda t: t.to(torch.bfloat16) if t.is_floating_point() else t)(torch.as_tensor(a)))
    def _A_setup():
        B, L, D, N = 1, 2048, 576, 128
        A_re = -(lambda _x: torch.exp(torch.as_tensor(_x)))((lambda *s: torch.randn(*s, dtype=torch.bfloat16) * 6.4)(D, N))
        A_im = torch.pi * (lambda *s: torch.randn(*s, dtype=torch.bfloat16) * 0.05)(D, N)
        B_re = (lambda *s: torch.randn(*s, dtype=torch.bfloat16) * 0.1)(D, N)
        B_im = (lambda *s: torch.randn(*s, dtype=torch.bfloat16) * 0.1)(D, N)
        C_re = (lambda *s: torch.randn(*s, dtype=torch.bfloat16) * 0.1)(D, N)
        C_im = (lambda *s: torch.randn(*s, dtype=torch.bfloat16) * 0.1)(D, N)
        log_dt = (lambda *s: torch.randn(*s, dtype=torch.bfloat16) * 0.05)(D) * 0.5 - 4.0
        Dskip = (lambda *s: torch.randn(*s, dtype=torch.bfloat16) * 0.05)(D)
        return {
            "u": _w((lambda *s: torch.randn(*s, dtype=torch.bfloat16) * 0.05)(B, L, D)),
            "A_re": _w(A_re),
            "A_im": _w(A_im),
            "B_re": _w(B_re),
            "B_im": _w(B_im),
            "C_re": _w(C_re),
            "C_im": _w(C_im),
            "log_dt": _w(log_dt),
            "Dskip": _w(Dskip),
        }
    _A_in = _A_setup()

    def _B_setup():
        B, S, D, F = 1, 2048, 576, 4608
        return {
            "x": _w((lambda *s: torch.randn(*s, dtype=torch.bfloat16) * 0.05)(B, S, D)),
            "w1": _w((lambda *s: torch.randn(*s, dtype=torch.bfloat16) * 0.8)(D, F) * (D ** -0.5)),
            "b1": _w((lambda *s: torch.randn(*s, dtype=torch.bfloat16) * 0.2)(F)),
            "w2": _w((lambda *s: torch.randn(*s, dtype=torch.bfloat16) * 0.2)(F, D) * (F ** -0.5)),
        }
    _B_in = _B_setup()

    return {
        "A_u": _A_in["u"],
        "A_A_re": _A_in["A_re"],
        "A_A_im": _A_in["A_im"],
        "A_B_re": _A_in["B_re"],
        "A_B_im": _A_in["B_im"],
        "A_C_re": _A_in["C_re"],
        "A_C_im": _A_in["C_im"],
        "A_log_dt": _A_in["log_dt"],
        "A_Dskip": _A_in["Dskip"],
        "B_x": _B_in["x"],
        "B_w1": _B_in["w1"],
        "B_b1": _B_in["b1"],
        "B_w2": _B_in["w2"],
    }

def reference(A_u, A_A_re, A_A_im, A_B_re, A_B_im, A_C_re, A_C_im, A_log_dt, A_Dskip, B_x, B_w1, B_b1, B_w2):
    def _A_ref(u, A_re, A_im, B_re, B_im, C_re, C_im, log_dt, Dskip):
        Bsz, L, D = u.shape
        dt = torch.exp(log_dt)[:, None]
        A = A_re + 1j * A_im
        Bc = B_re + 1j * B_im
        Cc = C_re + 1j * C_im
        logdA = dt * A
        dB = dt * Bc
        l = (lambda x, dt: x.to(dt))(torch.arange(L), A_re.dtype)
        P = torch.exp(logdA[:, :, None] * l[None, None, :])
        K = torch.einsum("dn,dnl,dn->dl", Cc, P, dB).real
        L2 = 2 * L
        Kp = _pad(K, ((0, 0), (0, L)))
        up = (lambda x, *d: x.permute(*d))(u, 0, 2, 1)
        up = _pad(up, ((0, 0), (0, 0), (0, L)))
        Kf = (lambda x, axes=(-2,-1): torch.fft.rfft2(x.float(), dim=axes))(Kp[:, None, :], axes=(-2, -1))
        Uf = (lambda x, axes=(-2,-1): torch.fft.rfft2(x.float(), dim=axes))(up[:, :, None, :], axes=(-2, -1))
        Yf = Uf * Kf[None, :, :, :]
        y = (lambda x, s, axes=(-2,-1): torch.fft.irfft2(x, s=s, dim=axes).to(torch.bfloat16))(Yf, (1, L2), axes=(-2, -1))[:, :, 0, :L]
        y = (lambda x, *d: x.permute(*d))(y, 0, 2, 1) + u * Dskip[None, None, :]
        return y

    def _B_ref(x, w1, b1, w2):
        h = torch.einsum("bsd,df->bsf", x, w1) + b1
        sp = torch.log1p(torch.exp(-torch.abs(h))) + torch.where(h > 0, h, torch.zeros_like(h))
        act = h * torch.tanh(sp)
        return torch.einsum("bsf,fd->bsd", act, w2)

    x = A_u
    xn = _layernorm(x, axis=-1)
    return x + _A_ref(xn, A_A_re, A_A_im, A_B_re, A_B_im, A_C_re, A_C_im, A_log_dt, A_Dskip) + _B_ref(xn, B_w1, B_b1, B_w2)
```

```asm
; @launch kernel=prep_kernel grid=(964,1,1) block=(256,1,1) lds=37376
; @launch kernel=gemm1_kernel grid=(512,1,1) block=(256,1,1) lds=73728
.amdgcn_target "amdgcn-amd-amdhsa--gfx950"
.text
.globl prep_kernel
.p2align 8
.type prep_kernel,@function
prep_kernel:
    s_load_dwordx16 s[16:31], s[0:1], 0
    s_load_dwordx16 s[32:47], s[0:1], 64
    s_waitcnt lgkmcnt(0)
    s_cmp_ge_u32 s2, 964
    s_cbranch_scc1 P_END
    s_cmp_ge_u32 s2, 64
    s_cbranch_scc1 P_NOTLN
    s_mov_b32 s4, s16
    s_and_b32 s5, s17, 0xffff
    s_mov_b32 s6, 2359296
    s_mov_b32 s7, 0x00020000
    s_add_u32 s8, s46, 0
    s_addc_u32 s9, s47, 0
    s_and_b32 s9, s9, 0xffff
    s_mov_b32 s10, 2359296
    s_mov_b32 s11, 0x00020000
    s_add_u32 s12, s46, 2359296
    s_addc_u32 s13, s47, 0
    s_and_b32 s13, s13, 0xffff
    s_mov_b32 s14, 2359296
    s_mov_b32 s15, 0x00020000
    v_lshrrev_b32 v1, 3, v0
    v_and_b32 v2, 7, v0
    s_lshl_b32 s3, s2, 5
    v_add_u32 v3, s3, v1
    v_mul_u32_u24 v4, 1152, v3
    v_lshl_add_u32 v4, v2, 4, v4
    buffer_load_dwordx4 v[76:79], v4, s[4:7], 0 offen offset:0
    buffer_load_dwordx4 v[80:83], v4, s[4:7], 0 offen offset:128
    buffer_load_dwordx4 v[84:87], v4, s[4:7], 0 offen offset:256
    buffer_load_dwordx4 v[88:91], v4, s[4:7], 0 offen offset:384
    buffer_load_dwordx4 v[92:95], v4, s[4:7], 0 offen offset:512
    buffer_load_dwordx4 v[96:99], v4, s[4:7], 0 offen offset:640
    buffer_load_dwordx4 v[100:103], v4, s[4:7], 0 offen offset:768
    buffer_load_dwordx4 v[104:107], v4, s[4:7], 0 offen offset:896
    buffer_load_dwordx4 v[108:111], v4, s[4:7], 0 offen offset:1024
    s_mov_b32 s58, 0xffff0000
    v_lshrrev_b32 v21, 4, v3
    v_mul_u32_u24 v21, 18432, v21
    v_and_b32 v22, 15, v3
    v_lshl_add_u32 v21, v22, 4, v21
    v_lshl_add_u32 v21, v2, 8, v21
    v_mul_u32_u24 v23, 1168, v1
    v_lshl_add_u32 v23, v2, 4, v23
    s_waitcnt vmcnt(0)
    v_lshlrev_b32 v40, 16, v76
    v_and_b32 v41, s58, v76
    v_lshlrev_b32 v42, 16, v77
    v_and_b32 v43, s58, v77
    v_lshlrev_b32 v44, 16, v78
    v_and_b32 v45, s58, v78
    v_lshlrev_b32 v46, 16, v79
    v_and_b32 v47, s58, v79
    v_lshlrev_b32 v48, 16, v80
    v_and_b32 v49, s58, v80
    v_lshlrev_b32 v50, 16, v81
    v_and_b32 v51, s58, v81
    v_lshlrev_b32 v52, 16, v82
    v_and_b32 v53, s58, v82
    v_lshlrev_b32 v54, 16, v83
    v_and_b32 v55, s58, v83
    v_lshlrev_b32 v56, 16, v84
    v_and_b32 v57, s58, v84
    v_lshlrev_b32 v58, 16, v85
    v_and_b32 v59, s58, v85
    v_lshlrev_b32 v60, 16, v86
    v_and_b32 v61, s58, v86
    v_lshlrev_b32 v62, 16, v87
    v_and_b32 v63, s58, v87
    v_lshlrev_b32 v64, 16, v88
    v_and_b32 v65, s58, v88
    v_lshlrev_b32 v66, 16, v89
    v_and_b32 v67, s58, v89
    v_lshlrev_b32 v68, 16, v90
    v_and_b32 v69, s58, v90
    v_lshlrev_b32 v70, 16, v91
    v_and_b32 v71, s58, v91
    v_lshlrev_b32 v72, 16, v92
    v_and_b32 v73, s58, v92
    v_lshlrev_b32 v74, 16, v93
    v_and_b32 v75, s58, v93
    v_lshlrev_b32 v76, 16, v94
    v_and_b32 v77, s58, v94
    v_lshlrev_b32 v78, 16, v95
    v_and_b32 v79, s58, v95
    v_lshlrev_b32 v80, 16, v96
    v_and_b32 v81, s58, v96
    v_lshlrev_b32 v82, 16, v97
    v_and_b32 v83, s58, v97
    v_lshlrev_b32 v84, 16, v98
    v_and_b32 v85, s58, v98
    v_lshlrev_b32 v86, 16, v99
    v_and_b32 v87, s58, v99
    v_lshlrev_b32 v88, 16, v100
    v_and_b32 v89, s58, v100
    v_lshlrev_b32 v90, 16, v101
    v_and_b32 v91, s58, v101
    v_lshlrev_b32 v92, 16, v102
    v_and_b32 v93, s58, v102
    v_lshlrev_b32 v94, 16, v103
    v_and_b32 v95, s58, v103
    v_lshlrev_b32 v96, 16, v104
    v_and_b32 v97, s58, v104
    v_lshlrev_b32 v98, 16, v105
    v_and_b32 v99, s58, v105
    v_lshlrev_b32 v100, 16, v106
    v_and_b32 v101, s58, v106
    v_lshlrev_b32 v102, 16, v107
    v_and_b32 v103, s58, v107
    v_lshlrev_b32 v104, 16, v108
    v_and_b32 v105, s58, v108
    v_lshlrev_b32 v106, 16, v109
    v_and_b32 v107, s58, v109
    v_lshlrev_b32 v108, 16, v110
    v_and_b32 v109, s58, v110
    v_lshlrev_b32 v110, 16, v111
    v_and_b32 v111, s58, v111
    v_add_f32 v4, v40, v41
    v_add_f32 v7, v42, v43
    v_add_f32 v4, v4, v44
    v_add_f32 v7, v7, v45
    v_add_f32 v4, v4, v46
    v_add_f32 v7, v7, v47
    v_add_f32 v4, v4, v48
    v_add_f32 v7, v7, v49
    v_add_f32 v4, v4, v50
    v_add_f32 v7, v7, v51
    v_add_f32 v4, v4, v52
    v_add_f32 v7, v7, v53
    v_add_f32 v4, v4, v54
    v_add_f32 v7, v7, v55
    v_add_f32 v4, v4, v56
    v_add_f32 v7, v7, v57
    v_add_f32 v4, v4, v58
    v_add_f32 v7, v7, v59
    v_add_f32 v4, v4, v60
    v_add_f32 v7, v7, v61
    v_add_f32 v4, v4, v62
    v_add_f32 v7, v7, v63
    v_add_f32 v4, v4, v64
    v_add_f32 v7, v7, v65
    v_add_f32 v4, v4, v66
    v_add_f32 v7, v7, v67
    v_add_f32 v4, v4, v68
    v_add_f32 v7, v7, v69
    v_add_f32 v4, v4, v70
    v_add_f32 v7, v7, v71
    v_add_f32 v4, v4, v72
    v_add_f32 v7, v7, v73
    v_add_f32 v4, v4, v74
    v_add_f32 v7, v7, v75
    v_add_f32 v4, v4, v76
    v_add_f32 v7, v7, v77
    v_add_f32 v4, v4, v78
    v_add_f32 v7, v7, v79
    v_add_f32 v4, v4, v80
    v_add_f32 v7, v7, v81
    v_add_f32 v4, v4, v82
    v_add_f32 v7, v7, v83
    v_add_f32 v4, v4, v84
    v_add_f32 v7, v7, v85
    v_add_f32 v4, v4, v86
    v_add_f32 v7, v7, v87
    v_add_f32 v4, v4, v88
    v_add_f32 v7, v7, v89
    v_add_f32 v4, v4, v90
    v_add_f32 v7, v7, v91
    v_add_f32 v4, v4, v92
    v_add_f32 v7, v7, v93
    v_add_f32 v4, v4, v94
    v_add_f32 v7, v7, v95
    v_add_f32 v4, v4, v96
    v_add_f32 v7, v7, v97
    v_add_f32 v4, v4, v98
    v_add_f32 v7, v7, v99
    v_add_f32 v4, v4, v100
    v_add_f32 v7, v7, v101
    v_add_f32 v4, v4, v102
    v_add_f32 v7, v7, v103
    v_add_f32 v4, v4, v104
    v_add_f32 v7, v7, v105
    v_add_f32 v4, v4, v106
    v_add_f32 v7, v7, v107
    v_add_f32 v4, v4, v108
    v_add_f32 v7, v7, v109
    v_add_f32 v4, v4, v110
    v_add_f32 v7, v7, v111
    v_add_f32 v4, v4, v7
    v_and_b32 v6, 63, v0
    v_xor_b32 v6, 1, v6
    v_lshlrev_b32 v6, 2, v6
    ds_bpermute_b32 v5, v6, v4
    s_waitcnt lgkmcnt(0)
    v_add_f32 v4, v4, v5
    v_and_b32 v6, 63, v0
    v_xor_b32 v6, 2, v6
    v_lshlrev_b32 v6, 2, v6
    ds_bpermute_b32 v5, v6, v4
    s_waitcnt lgkmcnt(0)
    v_add_f32 v4, v4, v5
    v_and_b32 v6, 63, v0
    v_xor_b32 v6, 4, v6
    v_lshlrev_b32 v6, 2, v6
    ds_bpermute_b32 v5, v6, v4
    s_waitcnt lgkmcnt(0)
    v_add_f32 v4, v4, v5
    v_mov_b32 v7, 0x3ae38e39
    v_mul_f32 v4, v4, v7
    v_mov_b32 v8, 0
    v_mov_b32 v9, 0
    v_sub_f32 v5, v40, v4
    v_sub_f32 v10, v41, v4
    v_fma_f32 v8, v5, v5, v8
    v_fma_f32 v9, v10, v10, v9
    v_sub_f32 v5, v42, v4
    v_sub_f32 v10, v43, v4
    v_fma_f32 v8, v5, v5, v8
    v_fma_f32 v9, v10, v10, v9
    v_sub_f32 v5, v44, v4
    v_sub_f32 v10, v45, v4
    v_fma_f32 v8, v5, v5, v8
    v_fma_f32 v9, v10, v10, v9
    v_sub_f32 v5, v46, v4
    v_sub_f32 v10, v47, v4
    v_fma_f32 v8, v5, v5, v8
    v_fma_f32 v9, v10, v10, v9
    v_sub_f32 v5, v48, v4
    v_sub_f32 v10, v49, v4
    v_fma_f32 v8, v5, v5, v8
    v_fma_f32 v9, v10, v10, v9
    v_sub_f32 v5, v50, v4
    v_sub_f32 v10, v51, v4
    v_fma_f32 v8, v5, v5, v8
    v_fma_f32 v9, v10, v10, v9
    v_sub_f32 v5, v52, v4
    v_sub_f32 v10, v53, v4
    v_fma_f32 v8, v5, v5, v8
    v_fma_f32 v9, v10, v10, v9
    v_sub_f32 v5, v54, v4
    v_sub_f32 v10, v55, v4
    v_fma_f32 v8, v5, v5, v8
    v_fma_f32 v9, v10, v10, v9
    v_sub_f32 v5, v56, v4
    v_sub_f32 v10, v57, v4
    v_fma_f32 v8, v5, v5, v8
    v_fma_f32 v9, v10, v10, v9
    v_sub_f32 v5, v58, v4
    v_sub_f32 v10, v59, v4
    v_fma_f32 v8, v5, v5, v8
    v_fma_f32 v9, v10, v10, v9
    v_sub_f32 v5, v60, v4
    v_sub_f32 v10, v61, v4
    v_fma_f32 v8, v5, v5, v8
    v_fma_f32 v9, v10, v10, v9
    v_sub_f32 v5, v62, v4
    v_sub_f32 v10, v63, v4
    v_fma_f32 v8, v5, v5, v8
    v_fma_f32 v9, v10, v10, v9
    v_sub_f32 v5, v64, v4
    v_sub_f32 v10, v65, v4
    v_fma_f32 v8, v5, v5, v8
    v_fma_f32 v9, v10, v10, v9
    v_sub_f32 v5, v66, v4
    v_sub_f32 v10, v67, v4
    v_fma_f32 v8, v5, v5, v8
    v_fma_f32 v9, v10, v10, v9
    v_sub_f32 v5, v68, v4
    v_sub_f32 v10, v69, v4
    v_fma_f32 v8, v5, v5, v8
    v_fma_f32 v9, v10, v10, v9
    v_sub_f32 v5, v70, v4
    v_sub_f32 v10, v71, v4
    v_fma_f32 v8, v5, v5, v8
    v_fma_f32 v9, v10, v10, v9
    v_sub_f32 v5, v72, v4
    v_sub_f32 v10, v73, v4
    v_fma_f32 v8, v5, v5, v8
    v_fma_f32 v9, v10, v10, v9
    v_sub_f32 v5, v74, v4
    v_sub_f32 v10, v75, v4
    v_fma_f32 v8, v5, v5, v8
    v_fma_f32 v9, v10, v10, v9
    v_sub_f32 v5, v76, v4
    v_sub_f32 v10, v77, v4
    v_fma_f32 v8, v5, v5, v8
    v_fma_f32 v9, v10, v10, v9
    v_sub_f32 v5, v78, v4
    v_sub_f32 v10, v79, v4
    v_fma_f32 v8, v5, v5, v8
    v_fma_f32 v9, v10, v10, v9
    v_sub_f32 v5, v80, v4
    v_sub_f32 v10, v81, v4
    v_fma_f32 v8, v5, v5, v8
    v_fma_f32 v9, v10, v10, v9
    v_sub_f32 v5, v82, v4
    v_sub_f32 v10, v83, v4
    v_fma_f32 v8, v5, v5, v8
    v_fma_f32 v9, v10, v10, v9
    v_sub_f32 v5, v84, v4
    v_sub_f32 v10, v85, v4
    v_fma_f32 v8, v5, v5, v8
    v_fma_f32 v9, v10, v10, v9
    v_sub_f32 v5, v86, v4
    v_sub_f32 v10, v87, v4
    v_fma_f32 v8, v5, v5, v8
    v_fma_f32 v9, v10, v10, v9
    v_sub_f32 v5, v88, v4
    v_sub_f32 v10, v89, v4
    v_fma_f32 v8, v5, v5, v8
    v_fma_f32 v9, v10, v10, v9
    v_sub_f32 v5, v90, v4
    v_sub_f32 v10, v91, v4
    v_fma_f32 v8, v5, v5, v8
    v_fma_f32 v9, v10, v10, v9
    v_sub_f32 v5, v92, v4
    v_sub_f32 v10, v93, v4
    v_fma_f32 v8, v5, v5, v8
    v_fma_f32 v9, v10, v10, v9
    v_sub_f32 v5, v94, v4
    v_sub_f32 v10, v95, v4
    v_fma_f32 v8, v5, v5, v8
    v_fma_f32 v9, v10, v10, v9
    v_sub_f32 v5, v96, v4
    v_sub_f32 v10, v97, v4
    v_fma_f32 v8, v5, v5, v8
    v_fma_f32 v9, v10, v10, v9
    v_sub_f32 v5, v98, v4
    v_sub_f32 v10, v99, v4
    v_fma_f32 v8, v5, v5, v8
    v_fma_f32 v9, v10, v10, v9
    v_sub_f32 v5, v100, v4
    v_sub_f32 v10, v101, v4
    v_fma_f32 v8, v5, v5, v8
    v_fma_f32 v9, v10, v10, v9
    v_sub_f32 v5, v102, v4
    v_sub_f32 v10, v103, v4
    v_fma_f32 v8, v5, v5, v8
    v_fma_f32 v9, v10, v10, v9
    v_sub_f32 v5, v104, v4
    v_sub_f32 v10, v105, v4
    v_fma_f32 v8, v5, v5, v8
    v_fma_f32 v9, v10, v10, v9
    v_sub_f32 v5, v106, v4
    v_sub_f32 v10, v107, v4
    v_fma_f32 v8, v5, v5, v8
    v_fma_f32 v9, v10, v10, v9
    v_sub_f32 v5, v108, v4
    v_sub_f32 v10, v109, v4
    v_fma_f32 v8, v5, v5, v8
    v_fma_f32 v9, v10, v10, v9
    v_sub_f32 v5, v110, v4
    v_sub_f32 v10, v111, v4
    v_fma_f32 v8, v5, v5, v8
    v_fma_f32 v9, v10, v10, v9
    v_add_f32 v8, v8, v9
    v_and_b32 v6, 63, v0
    v_xor_b32 v6, 1, v6
    v_lshlrev_b32 v6, 2, v6
    ds_bpermute_b32 v5, v6, v8
    s_waitcnt lgkmcnt(0)
    v_add_f32 v8, v8, v5
    v_and_b32 v6, 63, v0
    v_xor_b32 v6, 2, v6
    v_lshlrev_b32 v6, 2, v6
    ds_bpermute_b32 v5, v6, v8
    s_waitcnt lgkmcnt(0)
    v_add_f32 v8, v8, v5
    v_and_b32 v6, 63, v0
    v_xor_b32 v6, 4, v6
    v_lshlrev_b32 v6, 2, v6
    ds_bpermute_b32 v5, v6, v8
    s_waitcnt lgkmcnt(0)
    v_add_f32 v8, v8, v5
    v_mul_f32 v8, v8, v7
    v_cvt_pk_bf16_f32 v8, v8, v8
    v_lshlrev_b32 v8, 16, v8
    v_add_f32 v8, 0x3727c5ac, v8
    v_cvt_pk_bf16_f32 v8, v8, v8
    v_lshlrev_b32 v8, 16, v8
    v_sqrt_f32 v8, v8
    s_nop 0
    v_cvt_pk_bf16_f32 v8, v8, v8
    v_lshlrev_b32 v8, 16, v8
    v_rcp_f32 v9, v8
    v_cvt_pk_bf16_f32 v4, v4, v4
    v_lshlrev_b32 v4, 16, v4
    v_sub_f32 v40, v40, v4
    v_cvt_pk_bf16_f32 v40, v40, v40
    v_lshlrev_b32 v40, 16, v40
    v_mul_f32 v5, v40, v9
    v_fma_f32 v20, -v5, v8, v40
    v_fma_f32 v40, v20, v9, v5
    v_sub_f32 v41, v41, v4
    v_cvt_pk_bf16_f32 v41, v41, v41
    v_lshlrev_b32 v41, 16, v41
    v_mul_f32 v5, v41, v9
    v_fma_f32 v20, -v5, v8, v41
    v_fma_f32 v41, v20, v9, v5
    v_sub_f32 v42, v42, v4
    v_cvt_pk_bf16_f32 v42, v42, v42
    v_lshlrev_b32 v42, 16, v42
    v_mul_f32 v5, v42, v9
    v_fma_f32 v20, -v5, v8, v42
    v_fma_f32 v42, v20, v9, v5
    v_sub_f32 v43, v43, v4
    v_cvt_pk_bf16_f32 v43, v43, v43
    v_lshlrev_b32 v43, 16, v43
    v_mul_f32 v5, v43, v9
    v_fma_f32 v20, -v5, v8, v43
    v_fma_f32 v43, v20, v9, v5
    v_sub_f32 v44, v44, v4
    v_cvt_pk_bf16_f32 v44, v44, v44
    v_lshlrev_b32 v44, 16, v44
    v_mul_f32 v5, v44, v9
    v_fma_f32 v20, -v5, v8, v44
    v_fma_f32 v44, v20, v9, v5
    v_sub_f32 v45, v45, v4
    v_cvt_pk_bf16_f32 v45, v45, v45
    v_lshlrev_b32 v45, 16, v45
    v_mul_f32 v5, v45, v9
    v_fma_f32 v20, -v5, v8, v45
    v_fma_f32 v45, v20, v9, v5
    v_sub_f32 v46, v46, v4
    v_cvt_pk_bf16_f32 v46, v46, v46
    v_lshlrev_b32 v46, 16, v46
    v_mul_f32 v5, v46, v9
    v_fma_f32 v20, -v5, v8, v46
    v_fma_f32 v46, v20, v9, v5
    v_sub_f32 v47, v47, v4
    v_cvt_pk_bf16_f32 v47, v47, v47
    v_lshlrev_b32 v47, 16, v47
    v_mul_f32 v5, v47, v9
    v_fma_f32 v20, -v5, v8, v47
    v_fma_f32 v47, v20, v9, v5
    v_cvt_pk_bf16_f32 v40, v40, v41
    v_cvt_pk_bf16_f32 v41, v42, v43
    v_cvt_pk_bf16_f32 v42, v44, v45
    v_cvt_pk_bf16_f32 v43, v46, v47
    s_mov_b32 s3, 0
    buffer_store_dwordx4 v[40:43], v21, s[8:11], s3 offen sc0 sc1
    ds_write_b128 v23, v[40:43] offset:0
    v_sub_f32 v48, v48, v4
    v_cvt_pk_bf16_f32 v48, v48, v48
    v_lshlrev_b32 v48, 16, v48
    v_mul_f32 v5, v48, v9
    v_fma_f32 v20, -v5, v8, v48
    v_fma_f32 v48, v20, v9, v5
    v_sub_f32 v49, v49, v4
    v_cvt_pk_bf16_f32 v49, v49, v49
    v_lshlrev_b32 v49, 16, v49
    v_mul_f32 v5, v49, v9
    v_fma_f32 v20, -v5, v8, v49
    v_fma_f32 v49, v20, v9, v5
    v_sub_f32 v50, v50, v4
    v_cvt_pk_bf16_f32 v50, v50, v50
    v_lshlrev_b32 v50, 16, v50
    v_mul_f32 v5, v50, v9
    v_fma_f32 v20, -v5, v8, v50
    v_fma_f32 v50, v20, v9, v5
    v_sub_f32 v51, v51, v4
    v_cvt_pk_bf16_f32 v51, v51, v51
    v_lshlrev_b32 v51, 16, v51
    v_mul_f32 v5, v51, v9
    v_fma_f32 v20, -v5, v8, v51
    v_fma_f32 v51, v20, v9, v5
    v_sub_f32 v52, v52, v4
    v_cvt_pk_bf16_f32 v52, v52, v52
    v_lshlrev_b32 v52, 16, v52
    v_mul_f32 v5, v52, v9
    v_fma_f32 v20, -v5, v8, v52
    v_fma_f32 v52, v20, v9, v5
    v_sub_f32 v53, v53, v4
    v_cvt_pk_bf16_f32 v53, v53, v53
    v_lshlrev_b32 v53, 16, v53
    v_mul_f32 v5, v53, v9
    v_fma_f32 v20, -v5, v8, v53
    v_fma_f32 v53, v20, v9, v5
    v_sub_f32 v54, v54, v4
    v_cvt_pk_bf16_f32 v54, v54, v54
    v_lshlrev_b32 v54, 16, v54
    v_mul_f32 v5, v54, v9
    v_fma_f32 v20, -v5, v8, v54
    v_fma_f32 v54, v20, v9, v5
    v_sub_f32 v55, v55, v4
    v_cvt_pk_bf16_f32 v55, v55, v55
    v_lshlrev_b32 v55, 16, v55
    v_mul_f32 v5, v55, v9
    v_fma_f32 v20, -v5, v8, v55
    v_fma_f32 v55, v20, v9, v5
    v_cvt_pk_bf16_f32 v48, v48, v49
    v_cvt_pk_bf16_f32 v49, v50, v51
    v_cvt_pk_bf16_f32 v50, v52, v53
    v_cvt_pk_bf16_f32 v51, v54, v55
    s_mov_b32 s3, 2048
    buffer_store_dwordx4 v[48:51], v21, s[8:11], s3 offen sc0 sc1
    ds_write_b128 v23, v[48:51] offset:128
    v_sub_f32 v56, v56, v4
    v_cvt_pk_bf16_f32 v56, v56, v56
    v_lshlrev_b32 v56, 16, v56
    v_mul_f32 v5, v56, v9
    v_fma_f32 v20, -v5, v8, v56
    v_fma_f32 v56, v20, v9, v5
    v_sub_f32 v57, v57, v4
    v_cvt_pk_bf16_f32 v57, v57, v57
    v_lshlrev_b32 v57, 16, v57
    v_mul_f32 v5, v57, v9
    v_fma_f32 v20, -v5, v8, v57
    v_fma_f32 v57, v20, v9, v5
    v_sub_f32 v58, v58, v4
    v_cvt_pk_bf16_f32 v58, v58, v58
    v_lshlrev_b32 v58, 16, v58
    v_mul_f32 v5, v58, v9
    v_fma_f32 v20, -v5, v8, v58
    v_fma_f32 v58, v20, v9, v5
    v_sub_f32 v59, v59, v4
    v_cvt_pk_bf16_f32 v59, v59, v59
    v_lshlrev_b32 v59, 16, v59
    v_mul_f32 v5, v59, v9
    v_fma_f32 v20, -v5, v8, v59
    v_fma_f32 v59, v20, v9, v5
    v_sub_f32 v60, v60, v4
    v_cvt_pk_bf16_f32 v60, v60, v60
    v_lshlrev_b32 v60, 16, v60
    v_mul_f32 v5, v60, v9
    v_fma_f32 v20, -v5, v8, v60
    v_fma_f32 v60, v20, v9, v5
    v_sub_f32 v61, v61, v4
    v_cvt_pk_bf16_f32 v61, v61, v61
    v_lshlrev_b32 v61, 16, v61
    v_mul_f32 v5, v61, v9
    v_fma_f32 v20, -v5, v8, v61
    v_fma_f32 v61, v20, v9, v5
    v_sub_f32 v62, v62, v4
    v_cvt_pk_bf16_f32 v62, v62, v62
    v_lshlrev_b32 v62, 16, v62
    v_mul_f32 v5, v62, v9
    v_fma_f32 v20, -v5, v8, v62
    v_fma_f32 v62, v20, v9, v5
    v_sub_f32 v63, v63, v4
    v_cvt_pk_bf16_f32 v63, v63, v63
    v_lshlrev_b32 v63, 16, v63
    v_mul_f32 v5, v63, v9
    v_fma_f32 v20, -v5, v8, v63
    v_fma_f32 v63, v20, v9, v5
    v_cvt_pk_bf16_f32 v56, v56, v57
    v_cvt_pk_bf16_f32 v57, v58, v59
    v_cvt_pk_bf16_f32 v58, v60, v61
    v_cvt_pk_bf16_f32 v59, v62, v63
    s_mov_b32 s3, 4096
    buffer_store_dwordx4 v[56:59], v21, s[8:11], s3 offen sc0 sc1
    ds_write_b128 v23, v[56:59] offset:256
    v_sub_f32 v64, v64, v4
    v_cvt_pk_bf16_f32 v64, v64, v64
    v_lshlrev_b32 v64, 16, v64
    v_mul_f32 v5, v64, v9
    v_fma_f32 v20, -v5, v8, v64
    v_fma_f32 v64, v20, v9, v5
    v_sub_f32 v65, v65, v4
    v_cvt_pk_bf16_f32 v65, v65, v65
    v_lshlrev_b32 v65, 16, v65
    v_mul_f32 v5, v65, v9
    v_fma_f32 v20, -v5, v8, v65
    v_fma_f32 v65, v20, v9, v5
    v_sub_f32 v66, v66, v4
    v_cvt_pk_bf16_f32 v66, v66, v66
    v_lshlrev_b32 v66, 16, v66
    v_mul_f32 v5, v66, v9
    v_fma_f32 v20, -v5, v8, v66
    v_fma_f32 v66, v20, v9, v5
    v_sub_f32 v67, v67, v4
    v_cvt_pk_bf16_f32 v67, v67, v67
    v_lshlrev_b32 v67, 16, v67
    v_mul_f32 v5, v67, v9
    v_fma_f32 v20, -v5, v8, v67
    v_fma_f32 v67, v20, v9, v5
    v_sub_f32 v68, v68, v4
    v_cvt_pk_bf16_f32 v68, v68, v68
    v_lshlrev_b32 v68, 16, v68
    v_mul_f32 v5, v68, v9
    v_fma_f32 v20, -v5, v8, v68
    v_fma_f32 v68, v20, v9, v5
    v_sub_f32 v69, v69, v4
    v_cvt_pk_bf16_f32 v69, v69, v69
    v_lshlrev_b32 v69, 16, v69
    v_mul_f32 v5, v69, v9
    v_fma_f32 v20, -v5, v8, v69
    v_fma_f32 v69, v20, v9, v5
    v_sub_f32 v70, v70, v4
    v_cvt_pk_bf16_f32 v70, v70, v70
    v_lshlrev_b32 v70, 16, v70
    v_mul_f32 v5, v70, v9
    v_fma_f32 v20, -v5, v8, v70
    v_fma_f32 v70, v20, v9, v5
    v_sub_f32 v71, v71, v4
    v_cvt_pk_bf16_f32 v71, v71, v71
    v_lshlrev_b32 v71, 16, v71
    v_mul_f32 v5, v71, v9
    v_fma_f32 v20, -v5, v8, v71
    v_fma_f32 v71, v20, v9, v5
    v_cvt_pk_bf16_f32 v64, v64, v65
    v_cvt_pk_bf16_f32 v65, v66, v67
    v_cvt_pk_bf16_f32 v66, v68, v69
    v_cvt_pk_bf16_f32 v67, v70, v71
    s_mov_b32 s3, 6144
    buffer_store_dwordx4 v[64:67], v21, s[8:11], s3 offen sc0 sc1
    ds_write_b128 v23, v[64:67] offset:384
    v_sub_f32 v72, v72, v4
    v_cvt_pk_bf16_f32 v72, v72, v72
    v_lshlrev_b32 v72, 16, v72
    v_mul_f32 v5, v72, v9
    v_fma_f32 v20, -v5, v8, v72
    v_fma_f32 v72, v20, v9, v5
    v_sub_f32 v73, v73, v4
    v_cvt_pk_bf16_f32 v73, v73, v73
    v_lshlrev_b32 v73, 16, v73
    v_mul_f32 v5, v73, v9
    v_fma_f32 v20, -v5, v8, v73
    v_fma_f32 v73, v20, v9, v5
    v_sub_f32 v74, v74, v4
    v_cvt_pk_bf16_f32 v74, v74, v74
    v_lshlrev_b32 v74, 16, v74
    v_mul_f32 v5, v74, v9
    v_fma_f32 v20, -v5, v8, v74
    v_fma_f32 v74, v20, v9, v5
    v_sub_f32 v75, v75, v4
    v_cvt_pk_bf16_f32 v75, v75, v75
    v_lshlrev_b32 v75, 16, v75
    v_mul_f32 v5, v75, v9
    v_fma_f32 v20, -v5, v8, v75
    v_fma_f32 v75, v20, v9, v5
    v_sub_f32 v76, v76, v4
    v_cvt_pk_bf16_f32 v76, v76, v76
    v_lshlrev_b32 v76, 16, v76
    v_mul_f32 v5, v76, v9
    v_fma_f32 v20, -v5, v8, v76
    v_fma_f32 v76, v20, v9, v5
    v_sub_f32 v77, v77, v4
    v_cvt_pk_bf16_f32 v77, v77, v77
    v_lshlrev_b32 v77, 16, v77
    v_mul_f32 v5, v77, v9
    v_fma_f32 v20, -v5, v8, v77
    v_fma_f32 v77, v20, v9, v5
    v_sub_f32 v78, v78, v4
    v_cvt_pk_bf16_f32 v78, v78, v78
    v_lshlrev_b32 v78, 16, v78
    v_mul_f32 v5, v78, v9
    v_fma_f32 v20, -v5, v8, v78
    v_fma_f32 v78, v20, v9, v5
    v_sub_f32 v79, v79, v4
    v_cvt_pk_bf16_f32 v79, v79, v79
    v_lshlrev_b32 v79, 16, v79
    v_mul_f32 v5, v79, v9
    v_fma_f32 v20, -v5, v8, v79
    v_fma_f32 v79, v20, v9, v5
    v_cvt_pk_bf16_f32 v72, v72, v73
    v_cvt_pk_bf16_f32 v73, v74, v75
    v_cvt_pk_bf16_f32 v74, v76, v77
    v_cvt_pk_bf16_f32 v75, v78, v79
    s_mov_b32 s3, 8192
    buffer_store_dwordx4 v[72:75], v21, s[8:11], s3 offen sc0 sc1
    ds_write_b128 v23, v[72:75] offset:512
    v_sub_f32 v80, v80, v4
    v_cvt_pk_bf16_f32 v80, v80, v80
    v_lshlrev_b32 v80, 16, v80
    v_mul_f32 v5, v80, v9
    v_fma_f32 v20, -v5, v8, v80
    v_fma_f32 v80, v20, v9, v5
    v_sub_f32 v81, v81, v4
    v_cvt_pk_bf16_f32 v81, v81, v81
    v_lshlrev_b32 v81, 16, v81
    v_mul_f32 v5, v81, v9
    v_fma_f32 v20, -v5, v8, v81
    v_fma_f32 v81, v20, v9, v5
    v_sub_f32 v82, v82, v4
    v_cvt_pk_bf16_f32 v82, v82, v82
    v_lshlrev_b32 v82, 16, v82
    v_mul_f32 v5, v82, v9
    v_fma_f32 v20, -v5, v8, v82
    v_fma_f32 v82, v20, v9, v5
    v_sub_f32 v83, v83, v4
    v_cvt_pk_bf16_f32 v83, v83, v83
    v_lshlrev_b32 v83, 16, v83
    v_mul_f32 v5, v83, v9
    v_fma_f32 v20, -v5, v8, v83
    v_fma_f32 v83, v20, v9, v5
    v_sub_f32 v84, v84, v4
    v_cvt_pk_bf16_f32 v84, v84, v84
    v_lshlrev_b32 v84, 16, v84
    v_mul_f32 v5, v84, v9
    v_fma_f32 v20, -v5, v8, v84
    v_fma_f32 v84, v20, v9, v5
    v_sub_f32 v85, v85, v4
    v_cvt_pk_bf16_f32 v85, v85, v85
    v_lshlrev_b32 v85, 16, v85
    v_mul_f32 v5, v85, v9
    v_fma_f32 v20, -v5, v8, v85
    v_fma_f32 v85, v20, v9, v5
    v_sub_f32 v86, v86, v4
    v_cvt_pk_bf16_f32 v86, v86, v86
    v_lshlrev_b32 v86, 16, v86
    v_mul_f32 v5, v86, v9
    v_fma_f32 v20, -v5, v8, v86
    v_fma_f32 v86, v20, v9, v5
    v_sub_f32 v87, v87, v4
    v_cvt_pk_bf16_f32 v87, v87, v87
    v_lshlrev_b32 v87, 16, v87
    v_mul_f32 v5, v87, v9
    v_fma_f32 v20, -v5, v8, v87
    v_fma_f32 v87, v20, v9, v5
    v_cvt_pk_bf16_f32 v80, v80, v81
    v_cvt_pk_bf16_f32 v81, v82, v83
    v_cvt_pk_bf16_f32 v82, v84, v85
    v_cvt_pk_bf16_f32 v83, v86, v87
    s_mov_b32 s3, 10240
    buffer_store_dwordx4 v[80:83], v21, s[8:11], s3 offen sc0 sc1
    ds_write_b128 v23, v[80:83] offset:640
    v_sub_f32 v88, v88, v4
    v_cvt_pk_bf16_f32 v88, v88, v88
    v_lshlrev_b32 v88, 16, v88
    v_mul_f32 v5, v88, v9
    v_fma_f32 v20, -v5, v8, v88
    v_fma_f32 v88, v20, v9, v5
    v_sub_f32 v89, v89, v4
    v_cvt_pk_bf16_f32 v89, v89, v89
    v_lshlrev_b32 v89, 16, v89
    v_mul_f32 v5, v89, v9
    v_fma_f32 v20, -v5, v8, v89
    v_fma_f32 v89, v20, v9, v5
    v_sub_f32 v90, v90, v4
    v_cvt_pk_bf16_f32 v90, v90, v90
    v_lshlrev_b32 v90, 16, v90
    v_mul_f32 v5, v90, v9
    v_fma_f32 v20, -v5, v8, v90
    v_fma_f32 v90, v20, v9, v5
    v_sub_f32 v91, v91, v4
    v_cvt_pk_bf16_f32 v91, v91, v91
    v_lshlrev_b32 v91, 16, v91
    v_mul_f32 v5, v91, v9
    v_fma_f32 v20, -v5, v8, v91
    v_fma_f32 v91, v20, v9, v5
    v_sub_f32 v92, v92, v4
    v_cvt_pk_bf16_f32 v92, v92, v92
    v_lshlrev_b32 v92, 16, v92
    v_mul_f32 v5, v92, v9
    v_fma_f32 v20, -v5, v8, v92
    v_fma_f32 v92, v20, v9, v5
    v_sub_f32 v93, v93, v4
    v_cvt_pk_bf16_f32 v93, v93, v93
    v_lshlrev_b32 v93, 16, v93
    v_mul_f32 v5, v93, v9
    v_fma_f32 v20, -v5, v8, v93
    v_fma_f32 v93, v20, v9, v5
    v_sub_f32 v94, v94, v4
    v_cvt_pk_bf16_f32 v94, v94, v94
    v_lshlrev_b32 v94, 16, v94
    v_mul_f32 v5, v94, v9
    v_fma_f32 v20, -v5, v8, v94
    v_fma_f32 v94, v20, v9, v5
    v_sub_f32 v95, v95, v4
    v_cvt_pk_bf16_f32 v95, v95, v95
    v_lshlrev_b32 v95, 16, v95
    v_mul_f32 v5, v95, v9
    v_fma_f32 v20, -v5, v8, v95
    v_fma_f32 v95, v20, v9, v5
    v_cvt_pk_bf16_f32 v88, v88, v89
    v_cvt_pk_bf16_f32 v89, v90, v91
    v_cvt_pk_bf16_f32 v90, v92, v93
    v_cvt_pk_bf16_f32 v91, v94, v95
    s_mov_b32 s3, 12288
    buffer_store_dwordx4 v[88:91], v21, s[8:11], s3 offen sc0 sc1
    ds_write_b128 v23, v[88:91] offset:768
    v_sub_f32 v96, v96, v4
    v_cvt_pk_bf16_f32 v96, v96, v96
    v_lshlrev_b32 v96, 16, v96
    v_mul_f32 v5, v96, v9
    v_fma_f32 v20, -v5, v8, v96
    v_fma_f32 v96, v20, v9, v5
    v_sub_f32 v97, v97, v4
    v_cvt_pk_bf16_f32 v97, v97, v97
    v_lshlrev_b32 v97, 16, v97
    v_mul_f32 v5, v97, v9
    v_fma_f32 v20, -v5, v8, v97
    v_fma_f32 v97, v20, v9, v5
    v_sub_f32 v98, v98, v4
    v_cvt_pk_bf16_f32 v98, v98, v98
    v_lshlrev_b32 v98, 16, v98
    v_mul_f32 v5, v98, v9
    v_fma_f32 v20, -v5, v8, v98
    v_fma_f32 v98, v20, v9, v5
    v_sub_f32 v99, v99, v4
    v_cvt_pk_bf16_f32 v99, v99, v99
    v_lshlrev_b32 v99, 16, v99
    v_mul_f32 v5, v99, v9
    v_fma_f32 v20, -v5, v8, v99
    v_fma_f32 v99, v20, v9, v5
    v_sub_f32 v100, v100, v4
    v_cvt_pk_bf16_f32 v100, v100, v100
    v_lshlrev_b32 v100, 16, v100
    v_mul_f32 v5, v100, v9
    v_fma_f32 v20, -v5, v8, v100
    v_fma_f32 v100, v20, v9, v5
    v_sub_f32 v101, v101, v4
    v_cvt_pk_bf16_f32 v101, v101, v101
    v_lshlrev_b32 v101, 16, v101
    v_mul_f32 v5, v101, v9
    v_fma_f32 v20, -v5, v8, v101
    v_fma_f32 v101, v20, v9, v5
    v_sub_f32 v102, v102, v4
    v_cvt_pk_bf16_f32 v102, v102, v102
    v_lshlrev_b32 v102, 16, v102
    v_mul_f32 v5, v102, v9
    v_fma_f32 v20, -v5, v8, v102
    v_fma_f32 v102, v20, v9, v5
    v_sub_f32 v103, v103, v4
    v_cvt_pk_bf16_f32 v103, v103, v103
    v_lshlrev_b32 v103, 16, v103
    v_mul_f32 v5, v103, v9
    v_fma_f32 v20, -v5, v8, v103
    v_fma_f32 v103, v20, v9, v5
    v_cvt_pk_bf16_f32 v96, v96, v97
    v_cvt_pk_bf16_f32 v97, v98, v99
    v_cvt_pk_bf16_f32 v98, v100, v101
    v_cvt_pk_bf16_f32 v99, v102, v103
    s_mov_b32 s3, 14336
    buffer_store_dwordx4 v[96:99], v21, s[8:11], s3 offen sc0 sc1
    ds_write_b128 v23, v[96:99] offset:896
    v_sub_f32 v104, v104, v4
    v_cvt_pk_bf16_f32 v104, v104, v104
    v_lshlrev_b32 v104, 16, v104
    v_mul_f32 v5, v104, v9
    v_fma_f32 v20, -v5, v8, v104
    v_fma_f32 v104, v20, v9, v5
    v_sub_f32 v105, v105, v4
    v_cvt_pk_bf16_f32 v105, v105, v105
    v_lshlrev_b32 v105, 16, v105
    v_mul_f32 v5, v105, v9
    v_fma_f32 v20, -v5, v8, v105
    v_fma_f32 v105, v20, v9, v5
    v_sub_f32 v106, v106, v4
    v_cvt_pk_bf16_f32 v106, v106, v106
    v_lshlrev_b32 v106, 16, v106
    v_mul_f32 v5, v106, v9
    v_fma_f32 v20, -v5, v8, v106
    v_fma_f32 v106, v20, v9, v5
    v_sub_f32 v107, v107, v4
    v_cvt_pk_bf16_f32 v107, v107, v107
    v_lshlrev_b32 v107, 16, v107
    v_mul_f32 v5, v107, v9
    v_fma_f32 v20, -v5, v8, v107
    v_fma_f32 v107, v20, v9, v5
    v_sub_f32 v108, v108, v4
    v_cvt_pk_bf16_f32 v108, v108, v108
    v_lshlrev_b32 v108, 16, v108
    v_mul_f32 v5, v108, v9
    v_fma_f32 v20, -v5, v8, v108
    v_fma_f32 v108, v20, v9, v5
    v_sub_f32 v109, v109, v4
    v_cvt_pk_bf16_f32 v109, v109, v109
    v_lshlrev_b32 v109, 16, v109
    v_mul_f32 v5, v109, v9
    v_fma_f32 v20, -v5, v8, v109
    v_fma_f32 v109, v20, v9, v5
    v_sub_f32 v110, v110, v4
    v_cvt_pk_bf16_f32 v110, v110, v110
    v_lshlrev_b32 v110, 16, v110
    v_mul_f32 v5, v110, v9
    v_fma_f32 v20, -v5, v8, v110
    v_fma_f32 v110, v20, v9, v5
    v_sub_f32 v111, v111, v4
    v_cvt_pk_bf16_f32 v111, v111, v111
    v_lshlrev_b32 v111, 16, v111
    v_mul_f32 v5, v111, v9
    v_fma_f32 v20, -v5, v8, v111
    v_fma_f32 v111, v20, v9, v5
    v_cvt_pk_bf16_f32 v104, v104, v105
    v_cvt_pk_bf16_f32 v105, v106, v107
    v_cvt_pk_bf16_f32 v106, v108, v109
    v_cvt_pk_bf16_f32 v107, v110, v111
    s_mov_b32 s3, 16384
    buffer_store_dwordx4 v[104:107], v21, s[8:11], s3 offen sc0 sc1
    ds_write_b128 v23, v[104:107] offset:1024
    s_waitcnt lgkmcnt(0)
    s_barrier
    v_lshrrev_b32 v1, 2, v0
    v_and_b32 v2, 3, v0
    v_mul_u32_u24 v3, 9344, v2
    v_lshl_add_u32 v3, v1, 1, v3
    v_lshlrev_b32 v4, 12, v1
    v_lshl_add_u32 v4, v2, 4, v4
    s_lshl_b32 s3, s2, 6
    ds_read_u16 v40, v3 offset:0
    ds_read_u16 v41, v3 offset:1168
    ds_read_u16 v42, v3 offset:2336
    ds_read_u16 v43, v3 offset:3504
    ds_read_u16 v44, v3 offset:4672
    ds_read_u16 v45, v3 offset:5840
    ds_read_u16 v46, v3 offset:7008
    ds_read_u16 v47, v3 offset:8176
    ds_read_u16 v48, v3 offset:128
    ds_read_u16 v49, v3 offset:1296
    ds_read_u16 v50, v3 offset:2464
    ds_read_u16 v51, v3 offset:3632
    ds_read_u16 v52, v3 offset:4800
    ds_read_u16 v53, v3 offset:5968
    ds_read_u16 v54, v3 offset:7136
    ds_read_u16 v55, v3 offset:8304
    ds_read_u16 v56, v3 offset:256
    ds_read_u16 v57, v3 offset:1424
    ds_read_u16 v58, v3 offset:2592
    ds_read_u16 v59, v3 offset:3760
    ds_read_u16 v60, v3 offset:4928
    ds_read_u16 v61, v3 offset:6096
    ds_read_u16 v62, v3 offset:7264
    ds_read_u16 v63, v3 offset:8432
    ds_read_u16 v64, v3 offset:384
    ds_read_u16 v65, v3 offset:1552
    ds_read_u16 v66, v3 offset:2720
    ds_read_u16 v67, v3 offset:3888
    ds_read_u16 v68, v3 offset:5056
    ds_read_u16 v69, v3 offset:6224
    ds_read_u16 v70, v3 offset:7392
    ds_read_u16 v71, v3 offset:8560
    ds_read_u16 v72, v3 offset:512
    ds_read_u16 v73, v3 offset:1680
    ds_read_u16 v74, v3 offset:2848
    ds_read_u16 v75, v3 offset:4016
    ds_read_u16 v76, v3 offset:5184
    ds_read_u16 v77, v3 offset:6352
    ds_read_u16 v78, v3 offset:7520
    ds_read_u16 v79, v3 offset:8688
    ds_read_u16 v80, v3 offset:640
    ds_read_u16 v81, v3 offset:1808
    ds_read_u16 v82, v3 offset:2976
    ds_read_u16 v83, v3 offset:4144
    ds_read_u16 v84, v3 offset:5312
    ds_read_u16 v85, v3 offset:6480
    ds_read_u16 v86, v3 offset:7648
    ds_read_u16 v87, v3 offset:8816
    ds_read_u16 v88, v3 offset:768
    ds_read_u16 v89, v3 offset:1936
    ds_read_u16 v90, v3 offset:3104
    ds_read_u16 v91, v3 offset:4272
    ds_read_u16 v92, v3 offset:5440
    ds_read_u16 v93, v3 offset:6608
    ds_read_u16 v94, v3 offset:7776
    ds_read_u16 v95, v3 offset:8944
    ds_read_u16 v96, v3 offset:896
    ds_read_u16 v97, v3 offset:2064
    ds_read_u16 v98, v3 offset:3232
    ds_read_u16 v99, v3 offset:4400
    ds_read_u16 v100, v3 offset:5568
    ds_read_u16 v101, v3 offset:6736
    ds_read_u16 v102, v3 offset:7904
    ds_read_u16 v103, v3 offset:9072
    ds_read_u16 v104, v3 offset:1024
    ds_read_u16 v105, v3 offset:2192
    ds_read_u16 v106, v3 offset:3360
    ds_read_u16 v107, v3 offset:4528
    ds_read_u16 v108, v3 offset:5696
    ds_read_u16 v109, v3 offset:6864
    ds_read_u16 v110, v3 offset:8032
    ds_read_u16 v111, v3 offset:9200
    s_waitcnt lgkmcnt(15)
    v_lshl_or_b32 v40, v41, 16, v40
    v_lshl_or_b32 v41, v43, 16, v42
    v_lshl_or_b32 v42, v45, 16, v44
    v_lshl_or_b32 v43, v47, 16, v46
    s_add_u32 s57, s3, 0
    buffer_store_dwordx4 v[40:43], v4, s[12:15], s57 offen sc0 sc1
    s_waitcnt lgkmcnt(15)
    v_lshl_or_b32 v48, v49, 16, v48
    v_lshl_or_b32 v49, v51, 16, v50
    v_lshl_or_b32 v50, v53, 16, v52
    v_lshl_or_b32 v51, v55, 16, v54
    s_add_u32 s57, s3, 262144
    buffer_store_dwordx4 v[48:51], v4, s[12:15], s57 offen sc0 sc1
    s_waitcnt lgkmcnt(15)
    v_lshl_or_b32 v56, v57, 16, v56
    v_lshl_or_b32 v57, v59, 16, v58
    v_lshl_or_b32 v58, v61, 16, v60
    v_lshl_or_b32 v59, v63, 16, v62
    s_add_u32 s57, s3, 524288
    buffer_store_dwordx4 v[56:59], v4, s[12:15], s57 offen sc0 sc1
    s_waitcnt lgkmcnt(15)
    v_lshl_or_b32 v64, v65, 16, v64
    v_lshl_or_b32 v65, v67, 16, v66
    v_lshl_or_b32 v66, v69, 16, v68
    v_lshl_or_b32 v67, v71, 16, v70
    s_add_u32 s57, s3, 786432
    buffer_store_dwordx4 v[64:67], v4, s[12:15], s57 offen sc0 sc1
    s_waitcnt lgkmcnt(15)
    v_lshl_or_b32 v72, v73, 16, v72
    v_lshl_or_b32 v73, v75, 16, v74
    v_lshl_or_b32 v74, v77, 16, v76
    v_lshl_or_b32 v75, v79, 16, v78
    s_add_u32 s57, s3, 1048576
    buffer_store_dwordx4 v[72:75], v4, s[12:15], s57 offen sc0 sc1
    s_waitcnt lgkmcnt(15)
    v_lshl_or_b32 v80, v81, 16, v80
    v_lshl_or_b32 v81, v83, 16, v82
    v_lshl_or_b32 v82, v85, 16, v84
    v_lshl_or_b32 v83, v87, 16, v86
    s_add_u32 s57, s3, 1310720
    buffer_store_dwordx4 v[80:83], v4, s[12:15], s57 offen sc0 sc1
    s_waitcnt lgkmcnt(15)
    v_lshl_or_b32 v88, v89, 16, v88
    v_lshl_or_b32 v89, v91, 16, v90
    v_lshl_or_b32 v90, v93, 16, v92
    v_lshl_or_b32 v91, v95, 16, v94
    s_add_u32 s57, s3, 1572864
    buffer_store_dwordx4 v[88:91], v4, s[12:15], s57 offen sc0 sc1
    s_waitcnt lgkmcnt(8)
    v_lshl_or_b32 v96, v97, 16, v96
    v_lshl_or_b32 v97, v99, 16, v98
    v_lshl_or_b32 v98, v101, 16, v100
    v_lshl_or_b32 v99, v103, 16, v102
    s_add_u32 s57, s3, 1835008
    buffer_store_dwordx4 v[96:99], v4, s[12:15], s57 offen sc0 sc1
    s_waitcnt lgkmcnt(0)
    v_lshl_or_b32 v104, v105, 16, v104
    v_lshl_or_b32 v105, v107, 16, v106
    v_lshl_or_b32 v106, v109, 16, v108
    v_lshl_or_b32 v107, v111, 16, v110
    s_add_u32 s57, s3, 2097152
    buffer_store_dwordx4 v[104:107], v4, s[12:15], s57 offen sc0 sc1
    s_endpgm
P_NOTLN:
    s_cmp_ge_u32 s2, 640
    s_cbranch_scc1 P_TR0
    s_sub_u32 s3, s2, 64
    v_cmp_gt_u32 vcc, 128, v0
    s_and_saveexec_b64 s[48:49], vcc
    s_cbranch_execz KG_PW
    s_lshl_b32 s50, s3, 8
    v_lshl_add_u32 v1, v0, 1, s50
    s_mov_b32 s4, s18
    s_and_b32 s5, s19, 0xffff
    s_mov_b32 s6, 147456
    s_mov_b32 s7, 0x00020000
    buffer_load_ushort v10, v1, s[4:7], 0 offen
    s_mov_b32 s4, s20
    s_and_b32 s5, s21, 0xffff
    s_mov_b32 s6, 147456
    s_mov_b32 s7, 0x00020000
    buffer_load_ushort v11, v1, s[4:7], 0 offen
    s_mov_b32 s4, s22
    s_and_b32 s5, s23, 0xffff
    s_mov_b32 s6, 147456
    s_mov_b32 s7, 0x00020000
    buffer_load_ushort v12, v1, s[4:7], 0 offen
    s_mov_b32 s4, s24
    s_and_b32 s5, s25, 0xffff
    s_mov_b32 s6, 147456
    s_mov_b32 s7, 0x00020000
    buffer_load_ushort v13, v1, s[4:7], 0 offen
    s_mov_b32 s4, s26
    s_and_b32 s5, s27, 0xffff
    s_mov_b32 s6, 147456
    s_mov_b32 s7, 0x00020000
    buffer_load_ushort v14, v1, s[4:7], 0 offen
    s_mov_b32 s4, s28
    s_and_b32 s5, s29, 0xffff
    s_mov_b32 s6, 147456
    s_mov_b32 s7, 0x00020000
    buffer_load_ushort v15, v1, s[4:7], 0 offen
    s_mov_b32 s4, s30
    s_and_b32 s5, s31, 0xffff
    s_mov_b32 s6, 1152
    s_mov_b32 s7, 0x00020000
    s_lshl_b32 s50, s3, 1
    v_mov_b32 v2, s50
    buffer_load_ushort v16, v2, s[4:7], 0 offen
    s_waitcnt vmcnt(0)
    v_lshlrev_b32 v10, 16, v10
    v_lshlrev_b32 v11, 16, v11
    v_lshlrev_b32 v12, 16, v12
    v_lshlrev_b32 v13, 16, v13
    v_lshlrev_b32 v14, 16, v14
    v_lshlrev_b32 v15, 16, v15
    v_lshlrev_b32 v16, 16, v16
    v_mul_f32 v16, 0x3fb8aa3b, v16
    v_exp_f32 v16, v16
    s_nop 0
    v_cvt_pk_bf16_f32 v16, v16, v16
    v_lshlrev_b32 v16, 16, v16
    v_mul_f32 v20, v16, v10
    v_mul_f32 v21, v16, v11
    v_mul_f32 v12, v16, v12
    v_mul_f32 v13, v16, v13
    v_mul_f32 v22, v14, v12
    v_fma_f32 v22, -v15, v13, v22
    v_mul_f32 v23, v14, v13
    v_fma_f32 v23, v15, v12, v23
    v_mul_f32 v20, 0x3fb8aa3b, v20
    v_mul_f32 v21, 0x3e22f983, v21
    v_mul_f32 v10, 256.0, v20
    v_exp_f32 v10, v10
    v_mul_f32 v11, 256.0, v21
    v_fract_f32 v11, v11
    v_cos_f32 v12, v11
    v_sin_f32 v13, v11
    s_nop 0
    v_mul_f32 v12, v12, v10
    v_mul_f32 v13, v13, v10
    v_mul_f32 v24, v22, v12
    v_fma_f32 v24, -v23, v13, v24
    v_mul_f32 v25, v22, v13
    v_fma_f32 v25, v23, v12, v25
    v_mul_f32 v10, 512.0, v20
    v_exp_f32 v10, v10
    v_mul_f32 v11, 512.0, v21
    v_fract_f32 v11, v11
    v_cos_f32 v12, v11
    v_sin_f32 v13, v11
    s_nop 0
    v_mul_f32 v12, v12, v10
    v_mul_f32 v13, v13, v10
    v_mul_f32 v26, v22, v12
    v_fma_f32 v26, -v23, v13, v26
    v_mul_f32 v27, v22, v13
    v_fma_f32 v27, v23, v12, v27
    v_mul_f32 v10, 1024.0, v20
    v_exp_f32 v10, v10
    v_mul_f32 v11, 1024.0, v21
    v_fract_f32 v11, v11
    v_cos_f32 v12, v11
    v_sin_f32 v13, v11
    s_nop 0
    v_mul_f32 v12, v12, v10
    v_mul_f32 v13, v13, v10
    v_mul_f32 v28, v22, v12
    v_fma_f32 v28, -v23, v13, v28
    v_mul_f32 v29, v22, v13
    v_fma_f32 v29, v23, v12, v29
    v_mul_u32_u24 v2, 48, v0
    ds_write_b128 v2, v[20:23] offset:0
    ds_write_b128 v2, v[24:27] offset:16
    ds_write_b64 v2, v[28:29] offset:32
KG_PW:
    s_or_b64 exec, exec, s[48:49]
    s_waitcnt lgkmcnt(0)
    s_barrier
    v_lshrrev_b32 v1, 6, v0
    v_and_b32 v2, 15, v0
    v_lshlrev_b32 v4, 4, v2
    v_cvt_f32_u32 v30, v4
    v_cvt_f32_u32 v31, v2
    v_bfe_u32 v5, v0, 4, 2
    v_lshl_add_u32 v5, v1, 5, v5
    v_mul_u32_u24 v5, 48, v5
    v_mov_b32 v80, 0
    v_mov_b32 v81, 0
    v_mov_b32 v82, 0
    v_mov_b32 v83, 0
    v_mov_b32 v84, 0
    v_mov_b32 v85, 0
    v_mov_b32 v86, 0
    v_mov_b32 v87, 0
    v_mov_b32 v88, 0
    v_mov_b32 v89, 0
    v_mov_b32 v90, 0
    v_mov_b32 v91, 0
    v_mov_b32 v92, 0
    v_mov_b32 v93, 0
    v_mov_b32 v94, 0
    v_mov_b32 v95, 0
    ds_read_b128 v[32:35], v5 offset:0
    ds_read_b128 v[36:39], v5 offset:16
    ds_read_b64 v[40:41], v5 offset:32
    s_waitcnt lgkmcnt(0)
    ds_read_b128 v[44:47], v5 offset:192
    ds_read_b128 v[48:51], v5 offset:208
    ds_read_b64 v[52:53], v5 offset:224
    v_mul_f32 v10, v32, v30
    v_mul_f32 v11, v33, v30
    v_mul_f32 v14, v32, v31
    v_mul_f32 v15, v33, v31
    v_exp_f32 v10, v10
    v_fract_f32 v11, v11
    v_exp_f32 v14, v14
    v_fract_f32 v15, v15
    v_cos_f32 v12, v11
    v_sin_f32 v13, v11
    v_cos_f32 v16, v15
    v_sin_f32 v17, v15
    s_nop 0
    v_mul_f32 v12, v12, v10
    v_mul_f32 v13, v13, v10
    v_mul_f32 v56, v16, v14
    v_mul_f32 v57, v17, v14
    v_pk_mul_f32 v[58:59], v[34:35], v[12:13] op_sel_hi:[0,1] neg_hi:[1,0]
    v_pk_fma_f32 v[58:59], v[34:35], v[12:13], v[58:59] op_sel:[1,1,0] op_sel_hi:[1,0,1] neg_lo:[1,0,0] neg_hi:[1,0,0]
    v_pk_mul_f32 v[60:61], v[56:57], v[56:57] op_sel_hi:[0,1]
    v_pk_mul_f32 v[18:19], v[12:13], v[12:13] op_sel_hi:[0,1]
    v_pk_fma_f32 v[60:61], v[56:57], v[56:57], v[60:61] op_sel:[1,1,0] op_sel_hi:[0,1,1] neg_lo:[1,0,0]
    v_pk_fma_f32 v[12:13], v[12:13], v[12:13], v[18:19] op_sel:[1,1,0] op_sel_hi:[0,1,1] neg_lo:[1,0,0]
    v_cvt_pk_bf16_f32 v72, v56, v57
    v_cvt_pk_bf16_f32 v96, v58, v59
    v_pk_mul_f32 v[62:63], v[36:37], v[12:13] op_sel_hi:[0,1] neg_hi:[1,0]
    v_pk_fma_f32 v[62:63], v[36:37], v[12:13], v[62:63] op_sel:[1,1,0] op_sel_hi:[1,0,1] neg_lo:[1,0,0] neg_hi:[1,0,0]
    v_pk_mul_f32 v[64:65], v[60:61], v[60:61] op_sel_hi:[0,1]
    v_pk_mul_f32 v[18:19], v[12:13], v[12:13] op_sel_hi:[0,1]
    v_pk_fma_f32 v[64:65], v[60:61], v[60:61], v[64:65] op_sel:[1,1,0] op_sel_hi:[0,1,1] neg_lo:[1,0,0]
    v_pk_fma_f32 v[12:13], v[12:13], v[12:13], v[18:19] op_sel:[1,1,0] op_sel_hi:[0,1,1] neg_lo:[1,0,0]
    v_cvt_pk_bf16_f32 v76, v60, v61
    v_cvt_pk_bf16_f32 v100, v62, v63
    v_pk_mul_f32 v[66:67], v[38:39], v[12:13] op_sel_hi:[0,1] neg_hi:[1,0]
    v_pk_fma_f32 v[66:67], v[38:39], v[12:13], v[66:67] op_sel:[1,1,0] op_sel_hi:[1,0,1] neg_lo:[1,0,0] neg_hi:[1,0,0]
    v_pk_mul_f32 v[68:69], v[64:65], v[64:65] op_sel_hi:[0,1]
    v_pk_mul_f32 v[18:19], v[12:13], v[12:13] op_sel_hi:[0,1]
    v_pk_fma_f32 v[68:69], v[64:65], v[64:65], v[68:69] op_sel:[1,1,0] op_sel_hi:[0,1,1] neg_lo:[1,0,0]
    v_pk_fma_f32 v[12:13], v[12:13], v[12:13], v[18:19] op_sel:[1,1,0] op_sel_hi:[0,1,1] neg_lo:[1,0,0]
    v_cvt_pk_bf16_f32 v20, v64, v65
    v_cvt_pk_bf16_f32 v104, v66, v67
    v_pk_mul_f32 v[70:71], v[40:41], v[12:13] op_sel_hi:[0,1] neg_hi:[1,0]
    v_pk_fma_f32 v[70:71], v[40:41], v[12:13], v[70:71] op_sel:[1,1,0] op_sel_hi:[1,0,1] neg_lo:[1,0,0] neg_hi:[1,0,0]
    v_cvt_pk_bf16_f32 v24, v68, v69
    v_cvt_pk_bf16_f32 v108, v70, v71
    s_waitcnt lgkmcnt(0)
    ds_read_b128 v[32:35], v5 offset:384
    ds_read_b128 v[36:39], v5 offset:400
    ds_read_b64 v[40:41], v5 offset:416
    v_mul_f32 v10, v44, v30
    v_mul_f32 v11, v45, v30
    v_mul_f32 v14, v44, v31
    v_mul_f32 v15, v45, v31
    v_exp_f32 v10, v10
    v_fract_f32 v11, v11
    v_exp_f32 v14, v14
    v_fract_f32 v15, v15
    v_cos_f32 v12, v11
    v_sin_f32 v13, v11
    v_cos_f32 v16, v15
    v_sin_f32 v17, v15
    s_nop 0
    v_mul_f32 v12, v12, v10
    v_mul_f32 v13, v13, v10
    v_mul_f32 v56, v16, v14
    v_mul_f32 v57, v17, v14
    v_pk_mul_f32 v[58:59], v[46:47], v[12:13] op_sel_hi:[0,1] neg_hi:[1,0]
    v_pk_fma_f32 v[58:59], v[46:47], v[12:13], v[58:59] op_sel:[1,1,0] op_sel_hi:[1,0,1] neg_lo:[1,0,0] neg_hi:[1,0,0]
    v_pk_mul_f32 v[60:61], v[56:57], v[56:57] op_sel_hi:[0,1]
    v_pk_mul_f32 v[18:19], v[12:13], v[12:13] op_sel_hi:[0,1]
    v_pk_fma_f32 v[60:61], v[56:57], v[56:57], v[60:61] op_sel:[1,1,0] op_sel_hi:[0,1,1] neg_lo:[1,0,0]
    v_pk_fma_f32 v[12:13], v[12:13], v[12:13], v[18:19] op_sel:[1,1,0] op_sel_hi:[0,1,1] neg_lo:[1,0,0]
    v_cvt_pk_bf16_f32 v73, v56, v57
    v_cvt_pk_bf16_f32 v97, v58, v59
    v_pk_mul_f32 v[62:63], v[48:49], v[12:13] op_sel_hi:[0,1] neg_hi:[1,0]
    v_pk_fma_f32 v[62:63], v[48:49], v[12:13], v[62:63] op_sel:[1,1,0] op_sel_hi:[1,0,1] neg_lo:[1,0,0] neg_hi:[1,0,0]
    v_pk_mul_f32 v[64:65], v[60:61], v[60:61] op_sel_hi:[0,1]
    v_pk_mul_f32 v[18:19], v[12:13], v[12:13] op_sel_hi:[0,1]
    v_pk_fma_f32 v[64:65], v[60:61], v[60:61], v[64:65] op_sel:[1,1,0] op_sel_hi:[0,1,1] neg_lo:[1,0,0]
    v_pk_fma_f32 v[12:13], v[12:13], v[12:13], v[18:19] op_sel:[1,1,0] op_sel_hi:[0,1,1] neg_lo:[1,0,0]
    v_cvt_pk_bf16_f32 v77, v60, v61
    v_cvt_pk_bf16_f32 v101, v62, v63
    v_pk_mul_f32 v[66:67], v[50:51], v[12:13] op_sel_hi:[0,1] neg_hi:[1,0]
    v_pk_fma_f32 v[66:67], v[50:51], v[12:13], v[66:67] op_sel:[1,1,0] op_sel_hi:[1,0,1] neg_lo:[1,0,0] neg_hi:[1,0,0]
    v_pk_mul_f32 v[68:69], v[64:65], v[64:65] op_sel_hi:[0,1]
    v_pk_mul_f32 v[18:19], v[12:13], v[12:13] op_sel_hi:[0,1]
    v_pk_fma_f32 v[68:69], v[64:65], v[64:65], v[68:69] op_sel:[1,1,0] op_sel_hi:[0,1,1] neg_lo:[1,0,0]
    v_pk_fma_f32 v[12:13], v[12:13], v[12:13], v[18:19] op_sel:[1,1,0] op_sel_hi:[0,1,1] neg_lo:[1,0,0]
    v_cvt_pk_bf16_f32 v21, v64, v65
    v_cvt_pk_bf16_f32 v105, v66, v67
    v_pk_mul_f32 v[70:71], v[52:53], v[12:13] op_sel_hi:[0,1] neg_hi:[1,0]
    v_pk_fma_f32 v[70:71], v[52:53], v[12:13], v[70:71] op_sel:[1,1,0] op_sel_hi:[1,0,1] neg_lo:[1,0,0] neg_hi:[1,0,0]
    v_cvt_pk_bf16_f32 v25, v68, v69
    v_cvt_pk_bf16_f32 v109, v70, v71
    s_waitcnt lgkmcnt(0)
    ds_read_b128 v[44:47], v5 offset:576
    ds_read_b128 v[48:51], v5 offset:592
    ds_read_b64 v[52:53], v5 offset:608
    v_mul_f32 v10, v32, v30
    v_mul_f32 v11, v33, v30
    v_mul_f32 v14, v32, v31
    v_mul_f32 v15, v33, v31
    v_exp_f32 v10, v10
    v_fract_f32 v11, v11
    v_exp_f32 v14, v14
    v_fract_f32 v15, v15
    v_cos_f32 v12, v11
    v_sin_f32 v13, v11
    v_cos_f32 v16, v15
    v_sin_f32 v17, v15
    s_nop 0
    v_mul_f32 v12, v12, v10
    v_mul_f32 v13, v13, v10
    v_mul_f32 v56, v16, v14
    v_mul_f32 v57, v17, v14
    v_pk_mul_f32 v[58:59], v[34:35], v[12:13] op_sel_hi:[0,1] neg_hi:[1,0]
    v_pk_fma_f32 v[58:59], v[34:35], v[12:13], v[58:59] op_sel:[1,1,0] op_sel_hi:[1,0,1] neg_lo:[1,0,0] neg_hi:[1,0,0]
    v_pk_mul_f32 v[60:61], v[56:57], v[56:57] op_sel_hi:[0,1]
    v_pk_mul_f32 v[18:19], v[12:13], v[12:13] op_sel_hi:[0,1]
    v_pk_fma_f32 v[60:61], v[56:57], v[56:57], v[60:61] op_sel:[1,1,0] op_sel_hi:[0,1,1] neg_lo:[1,0,0]
    v_pk_fma_f32 v[12:13], v[12:13], v[12:13], v[18:19] op_sel:[1,1,0] op_sel_hi:[0,1,1] neg_lo:[1,0,0]
    v_cvt_pk_bf16_f32 v74, v56, v57
    v_cvt_pk_bf16_f32 v98, v58, v59
    v_pk_mul_f32 v[62:63], v[36:37], v[12:13] op_sel_hi:[0,1] neg_hi:[1,0]
    v_pk_fma_f32 v[62:63], v[36:37], v[12:13], v[62:63] op_sel:[1,1,0] op_sel_hi:[1,0,1] neg_lo:[1,0,0] neg_hi:[1,0,0]
    v_pk_mul_f32 v[64:65], v[60:61], v[60:61] op_sel_hi:[0,1]
    v_pk_mul_f32 v[18:19], v[12:13], v[12:13] op_sel_hi:[0,1]
    v_pk_fma_f32 v[64:65], v[60:61], v[60:61], v[64:65] op_sel:[1,1,0] op_sel_hi:[0,1,1] neg_lo:[1,0,0]
    v_pk_fma_f32 v[12:13], v[12:13], v[12:13], v[18:19] op_sel:[1,1,0] op_sel_hi:[0,1,1] neg_lo:[1,0,0]
    v_cvt_pk_bf16_f32 v78, v60, v61
    v_cvt_pk_bf16_f32 v102, v62, v63
    v_pk_mul_f32 v[66:67], v[38:39], v[12:13] op_sel_hi:[0,1] neg_hi:[1,0]
    v_pk_fma_f32 v[66:67], v[38:39], v[12:13], v[66:67] op_sel:[1,1,0] op_sel_hi:[1,0,1] neg_lo:[1,0,0] neg_hi:[1,0,0]
    v_pk_mul_f32 v[68:69], v[64:65], v[64:65] op_sel_hi:[0,1]
    v_pk_mul_f32 v[18:19], v[12:13], v[12:13] op_sel_hi:[0,1]
    v_pk_fma_f32 v[68:69], v[64:65], v[64:65], v[68:69] op_sel:[1,1,0] op_sel_hi:[0,1,1] neg_lo:[1,0,0]
    v_pk_fma_f32 v[12:13], v[12:13], v[12:13], v[18:19] op_sel:[1,1,0] op_sel_hi:[0,1,1] neg_lo:[1,0,0]
    v_cvt_pk_bf16_f32 v22, v64, v65
    v_cvt_pk_bf16_f32 v106, v66, v67
    v_pk_mul_f32 v[70:71], v[40:41], v[12:13] op_sel_hi:[0,1] neg_hi:[1,0]
    v_pk_fma_f32 v[70:71], v[40:41], v[12:13], v[70:71] op_sel:[1,1,0] op_sel_hi:[1,0,1] neg_lo:[1,0,0] neg_hi:[1,0,0]
    v_cvt_pk_bf16_f32 v26, v68, v69
    v_cvt_pk_bf16_f32 v110, v70, v71
    s_waitcnt lgkmcnt(0)
    ds_read_b128 v[32:35], v5 offset:768
    ds_read_b128 v[36:39], v5 offset:784
    ds_read_b64 v[40:41], v5 offset:800
    v_mul_f32 v10, v44, v30
    v_mul_f32 v11, v45, v30
    v_mul_f32 v14, v44, v31
    v_mul_f32 v15, v45, v31
    v_exp_f32 v10, v10
    v_fract_f32 v11, v11
    v_exp_f32 v14, v14
    v_fract_f32 v15, v15
    v_cos_f32 v12, v11
    v_sin_f32 v13, v11
    v_cos_f32 v16, v15
    v_sin_f32 v17, v15
    s_nop 0
    v_mul_f32 v12, v12, v10
    v_mul_f32 v13, v13, v10
    v_mul_f32 v56, v16, v14
    v_mul_f32 v57, v17, v14
    v_pk_mul_f32 v[58:59], v[46:47], v[12:13] op_sel_hi:[0,1] neg_hi:[1,0]
    v_pk_fma_f32 v[58:59], v[46:47], v[12:13], v[58:59] op_sel:[1,1,0] op_sel_hi:[1,0,1] neg_lo:[1,0,0] neg_hi:[1,0,0]
    v_pk_mul_f32 v[60:61], v[56:57], v[56:57] op_sel_hi:[0,1]
    v_pk_mul_f32 v[18:19], v[12:13], v[12:13] op_sel_hi:[0,1]
    v_pk_fma_f32 v[60:61], v[56:57], v[56:57], v[60:61] op_sel:[1,1,0] op_sel_hi:[0,1,1] neg_lo:[1,0,0]
    v_pk_fma_f32 v[12:13], v[12:13], v[12:13], v[18:19] op_sel:[1,1,0] op_sel_hi:[0,1,1] neg_lo:[1,0,0]
    v_cvt_pk_bf16_f32 v75, v56, v57
    v_cvt_pk_bf16_f32 v99, v58, v59
    v_pk_mul_f32 v[62:63], v[48:49], v[12:13] op_sel_hi:[0,1] neg_hi:[1,0]
    v_pk_fma_f32 v[62:63], v[48:49], v[12:13], v[62:63] op_sel:[1,1,0] op_sel_hi:[1,0,1] neg_lo:[1,0,0] neg_hi:[1,0,0]
    v_pk_mul_f32 v[64:65], v[60:61], v[60:61] op_sel_hi:[0,1]
    v_pk_mul_f32 v[18:19], v[12:13], v[12:13] op_sel_hi:[0,1]
    v_pk_fma_f32 v[64:65], v[60:61], v[60:61], v[64:65] op_sel:[1,1,0] op_sel_hi:[0,1,1] neg_lo:[1,0,0]
    v_pk_fma_f32 v[12:13], v[12:13], v[12:13], v[18:19] op_sel:[1,1,0] op_sel_hi:[0,1,1] neg_lo:[1,0,0]
    v_cvt_pk_bf16_f32 v79, v60, v61
    v_cvt_pk_bf16_f32 v103, v62, v63
    v_pk_mul_f32 v[66:67], v[50:51], v[12:13] op_sel_hi:[0,1] neg_hi:[1,0]
    v_pk_fma_f32 v[66:67], v[50:51], v[12:13], v[66:67] op_sel:[1,1,0] op_sel_hi:[1,0,1] neg_lo:[1,0,0] neg_hi:[1,0,0]
    v_pk_mul_f32 v[68:69], v[64:65], v[64:65] op_sel_hi:[0,1]
    v_pk_mul_f32 v[18:19], v[12:13], v[12:13] op_sel_hi:[0,1]
    v_pk_fma_f32 v[68:69], v[64:65], v[64:65], v[68:69] op_sel:[1,1,0] op_sel_hi:[0,1,1] neg_lo:[1,0,0]
    v_pk_fma_f32 v[12:13], v[12:13], v[12:13], v[18:19] op_sel:[1,1,0] op_sel_hi:[0,1,1] neg_lo:[1,0,0]
    v_cvt_pk_bf16_f32 v23, v64, v65
    v_cvt_pk_bf16_f32 v107, v66, v67
    v_pk_mul_f32 v[70:71], v[52:53], v[12:13] op_sel_hi:[0,1] neg_hi:[1,0]
    v_pk_fma_f32 v[70:71], v[52:53], v[12:13], v[70:71] op_sel:[1,1,0] op_sel_hi:[1,0,1] neg_lo:[1,0,0] neg_hi:[1,0,0]
    v_cvt_pk_bf16_f32 v27, v68, v69
    v_cvt_pk_bf16_f32 v111, v70, v71
    s_nop 1
    v_mfma_f32_16x16x32_bf16 v[80:83], v[96:99], v[72:75], v[80:83]
    v_mfma_f32_16x16x32_bf16 v[84:87], v[100:103], v[76:79], v[84:87]
    v_mfma_f32_16x16x32_bf16 v[88:91], v[104:107], v[20:23], v[88:91]
    v_mfma_f32_16x16x32_bf16 v[92:95], v[108:111], v[24:27], v[92:95]
    s_waitcnt lgkmcnt(0)
    ds_read_b128 v[44:47], v5 offset:960
    ds_read_b128 v[48:51], v5 offset:976
    ds_read_b64 v[52:53], v5 offset:992
    v_mul_f32 v10, v32, v30
    v_mul_f32 v11, v33, v30
    v_mul_f32 v14, v32, v31
    v_mul_f32 v15, v33, v31
    v_exp_f32 v10, v10
    v_fract_f32 v11, v11
    v_exp_f32 v14, v14
    v_fract_f32 v15, v15
    v_cos_f32 v12, v11
    v_sin_f32 v13, v11
    v_cos_f32 v16, v15
    v_sin_f32 v17, v15
    s_nop 0
    v_mul_f32 v12, v12, v10
    v_mul_f32 v13, v13, v10
    v_mul_f32 v56, v16, v14
    v_mul_f32 v57, v17, v14
    v_pk_mul_f32 v[58:59], v[34:35], v[12:13] op_sel_hi:[0,1] neg_hi:[1,0]
    v_pk_fma_f32 v[58:59], v[34:35], v[12:13], v[58:59] op_sel:[1,1,0] op_sel_hi:[1,0,1] neg_lo:[1,0,0] neg_hi:[1,0,0]
    v_pk_mul_f32 v[60:61], v[56:57], v[56:57] op_sel_hi:[0,1]
    v_pk_mul_f32 v[18:19], v[12:13], v[12:13] op_sel_hi:[0,1]
    v_pk_fma_f32 v[60:61], v[56:57], v[56:57], v[60:61] op_sel:[1,1,0] op_sel_hi:[0,1,1] neg_lo:[1,0,0]
    v_pk_fma_f32 v[12:13], v[12:13], v[12:13], v[18:19] op_sel:[1,1,0] op_sel_hi:[0,1,1] neg_lo:[1,0,0]
    v_cvt_pk_bf16_f32 v72, v56, v57
    v_cvt_pk_bf16_f32 v96, v58, v59
    v_pk_mul_f32 v[62:63], v[36:37], v[12:13] op_sel_hi:[0,1] neg_hi:[1,0]
    v_pk_fma_f32 v[62:63], v[36:37], v[12:13], v[62:63] op_sel:[1,1,0] op_sel_hi:[1,0,1] neg_lo:[1,0,0] neg_hi:[1,0,0]
    v_pk_mul_f32 v[64:65], v[60:61], v[60:61] op_sel_hi:[0,1]
    v_pk_mul_f32 v[18:19], v[12:13], v[12:13] op_sel_hi:[0,1]
    v_pk_fma_f32 v[64:65], v[60:61], v[60:61], v[64:65] op_sel:[1,1,0] op_sel_hi:[0,1,1] neg_lo:[1,0,0]
    v_pk_fma_f32 v[12:13], v[12:13], v[12:13], v[18:19] op_sel:[1,1,0] op_sel_hi:[0,1,1] neg_lo:[1,0,0]
    v_cvt_pk_bf16_f32 v76, v60, v61
    v_cvt_pk_bf16_f32 v100, v62, v63
    v_pk_mul_f32 v[66:67], v[38:39], v[12:13] op_sel_hi:[0,1] neg_hi:[1,0]
    v_pk_fma_f32 v[66:67], v[38:39], v[12:13], v[66:67] op_sel:[1,1,0] op_sel_hi:[1,0,1] neg_lo:[1,0,0] neg_hi:[1,0,0]
    v_pk_mul_f32 v[68:69], v[64:65], v[64:65] op_sel_hi:[0,1]
    v_pk_mul_f32 v[18:19], v[12:13], v[12:13] op_sel_hi:[0,1]
    v_pk_fma_f32 v[68:69], v[64:65], v[64:65], v[68:69] op_sel:[1,1,0] op_sel_hi:[0,1,1] neg_lo:[1,0,0]
    v_pk_fma_f32 v[12:13], v[12:13], v[12:13], v[18:19] op_sel:[1,1,0] op_sel_hi:[0,1,1] neg_lo:[1,0,0]
    v_cvt_pk_bf16_f32 v20, v64, v65
    v_cvt_pk_bf16_f32 v104, v66, v67
    v_pk_mul_f32 v[70:71], v[40:41], v[12:13] op_sel_hi:[0,1] neg_hi:[1,0]
    v_pk_fma_f32 v[70:71], v[40:41], v[12:13], v[70:71] op_sel:[1,1,0] op_sel_hi:[1,0,1] neg_lo:[1,0,0] neg_hi:[1,0,0]
    v_cvt_pk_bf16_f32 v24, v68, v69
    v_cvt_pk_bf16_f32 v108, v70, v71
    s_waitcnt lgkmcnt(0)
    ds_read_b128 v[32:35], v5 offset:1152
    ds_read_b128 v[36:39], v5 offset:1168
    ds_read_b64 v[40:41], v5 offset:1184
    v_mul_f32 v10, v44, v30
    v_mul_f32 v11, v45, v30
    v_mul_f32 v14, v44, v31
    v_mul_f32 v15, v45, v31
    v_exp_f32 v10, v10
    v_fract_f32 v11, v11
    v_exp_f32 v14, v14
    v_fract_f32 v15, v15
    v_cos_f32 v12, v11
    v_sin_f32 v13, v11
    v_cos_f32 v16, v15
    v_sin_f32 v17, v15
    s_nop 0
    v_mul_f32 v12, v12, v10
    v_mul_f32 v13, v13, v10
    v_mul_f32 v56, v16, v14
    v_mul_f32 v57, v17, v14
    v_pk_mul_f32 v[58:59], v[46:47], v[12:13] op_sel_hi:[0,1] neg_hi:[1,0]
    v_pk_fma_f32 v[58:59], v[46:47], v[12:13], v[58:59] op_sel:[1,1,0] op_sel_hi:[1,0,1] neg_lo:[1,0,0] neg_hi:[1,0,0]
    v_pk_mul_f32 v[60:61], v[56:57], v[56:57] op_sel_hi:[0,1]
    v_pk_mul_f32 v[18:19], v[12:13], v[12:13] op_sel_hi:[0,1]
    v_pk_fma_f32 v[60:61], v[56:57], v[56:57], v[60:61] op_sel:[1,1,0] op_sel_hi:[0,1,1] neg_lo:[1,0,0]
    v_pk_fma_f32 v[12:13], v[12:13], v[12:13], v[18:19] op_sel:[1,1,0] op_sel_hi:[0,1,1] neg_lo:[1,0,0]
    v_cvt_pk_bf16_f32 v73, v56, v57
    v_cvt_pk_bf16_f32 v97, v58, v59
    v_pk_mul_f32 v[62:63], v[48:49], v[12:13] op_sel_hi:[0,1] neg_hi:[1,0]
    v_pk_fma_f32 v[62:63], v[48:49], v[12:13], v[62:63] op_sel:[1,1,0] op_sel_hi:[1,0,1] neg_lo:[1,0,0] neg_hi:[1,0,0]
    v_pk_mul_f32 v[64:65], v[60:61], v[60:61] op_sel_hi:[0,1]
    v_pk_mul_f32 v[18:19], v[12:13], v[12:13] op_sel_hi:[0,1]
    v_pk_fma_f32 v[64:65], v[60:61], v[60:61], v[64:65] op_sel:[1,1,0] op_sel_hi:[0,1,1] neg_lo:[1,0,0]
    v_pk_fma_f32 v[12:13], v[12:13], v[12:13], v[18:19] op_sel:[1,1,0] op_sel_hi:[0,1,1] neg_lo:[1,0,0]
    v_cvt_pk_bf16_f32 v77, v60, v61
    v_cvt_pk_bf16_f32 v101, v62, v63
    v_pk_mul_f32 v[66:67], v[50:51], v[12:13] op_sel_hi:[0,1] neg_hi:[1,0]
    v_pk_fma_f32 v[66:67], v[50:51], v[12:13], v[66:67] op_sel:[1,1,0] op_sel_hi:[1,0,1] neg_lo:[1,0,0] neg_hi:[1,0,0]
    v_pk_mul_f32 v[68:69], v[64:65], v[64:65] op_sel_hi:[0,1]
    v_pk_mul_f32 v[18:19], v[12:13], v[12:13] op_sel_hi:[0,1]
    v_pk_fma_f32 v[68:69], v[64:65], v[64:65], v[68:69] op_sel:[1,1,0] op_sel_hi:[0,1,1] neg_lo:[1,0,0]
    v_pk_fma_f32 v[12:13], v[12:13], v[12:13], v[18:19] op_sel:[1,1,0] op_sel_hi:[0,1,1] neg_lo:[1,0,0]
    v_cvt_pk_bf16_f32 v21, v64, v65
    v_cvt_pk_bf16_f32 v105, v66, v67
    v_pk_mul_f32 v[70:71], v[52:53], v[12:13] op_sel_hi:[0,1] neg_hi:[1,0]
    v_pk_fma_f32 v[70:71], v[52:53], v[12:13], v[70:71] op_sel:[1,1,0] op_sel_hi:[1,0,1] neg_lo:[1,0,0] neg_hi:[1,0,0]
    v_cvt_pk_bf16_f32 v25, v68, v69
    v_cvt_pk_bf16_f32 v109, v70, v71
    s_waitcnt lgkmcnt(0)
    ds_read_b128 v[44:47], v5 offset:1344
    ds_read_b128 v[48:51], v5 offset:1360
    ds_read_b64 v[52:53], v5 offset:1376
    v_mul_f32 v10, v32, v30
    v_mul_f32 v11, v33, v30
    v_mul_f32 v14, v32, v31
    v_mul_f32 v15, v33, v31
    v_exp_f32 v10, v10
    v_fract_f32 v11, v11
    v_exp_f32 v14, v14
    v_fract_f32 v15, v15
    v_cos_f32 v12, v11
    v_sin_f32 v13, v11
    v_cos_f32 v16, v15
    v_sin_f32 v17, v15
    s_nop 0
    v_mul_f32 v12, v12, v10
    v_mul_f32 v13, v13, v10
    v_mul_f32 v56, v16, v14
    v_mul_f32 v57, v17, v14
    v_pk_mul_f32 v[58:59], v[34:35], v[12:13] op_sel_hi:[0,1] neg_hi:[1,0]
    v_pk_fma_f32 v[58:59], v[34:35], v[12:13], v[58:59] op_sel:[1,1,0] op_sel_hi:[1,0,1] neg_lo:[1,0,0] neg_hi:[1,0,0]
    v_pk_mul_f32 v[60:61], v[56:57], v[56:57] op_sel_hi:[0,1]
    v_pk_mul_f32 v[18:19], v[12:13], v[12:13] op_sel_hi:[0,1]
    v_pk_fma_f32 v[60:61], v[56:57], v[56:57], v[60:61] op_sel:[1,1,0] op_sel_hi:[0,1,1] neg_lo:[1,0,0]
    v_pk_fma_f32 v[12:13], v[12:13], v[12:13], v[18:19] op_sel:[1,1,0] op_sel_hi:[0,1,1] neg_lo:[1,0,0]
    v_cvt_pk_bf16_f32 v74, v56, v57
    v_cvt_pk_bf16_f32 v98, v58, v59
    v_pk_mul_f32 v[62:63], v[36:37], v[12:13] op_sel_hi:[0,1] neg_hi:[1,0]
    v_pk_fma_f32 v[62:63], v[36:37], v[12:13], v[62:63] op_sel:[1,1,0] op_sel_hi:[1,0,1] neg_lo:[1,0,0] neg_hi:[1,0,0]
    v_pk_mul_f32 v[64:65], v[60:61], v[60:61] op_sel_hi:[0,1]
    v_pk_mul_f32 v[18:19], v[12:13], v[12:13] op_sel_hi:[0,1]
    v_pk_fma_f32 v[64:65], v[60:61], v[60:61], v[64:65] op_sel:[1,1,0] op_sel_hi:[0,1,1] neg_lo:[1,0,0]
    v_pk_fma_f32 v[12:13], v[12:13], v[12:13], v[18:19] op_sel:[1,1,0] op_sel_hi:[0,1,1] neg_lo:[1,0,0]
    v_cvt_pk_bf16_f32 v78, v60, v61
    v_cvt_pk_bf16_f32 v102, v62, v63
    v_pk_mul_f32 v[66:67], v[38:39], v[12:13] op_sel_hi:[0,1] neg_hi:[1,0]
    v_pk_fma_f32 v[66:67], v[38:39], v[12:13], v[66:67] op_sel:[1,1,0] op_sel_hi:[1,0,1] neg_lo:[1,0,0] neg_hi:[1,0,0]
    v_pk_mul_f32 v[68:69], v[64:65], v[64:65] op_sel_hi:[0,1]
    v_pk_mul_f32 v[18:19], v[12:13], v[12:13] op_sel_hi:[0,1]
    v_pk_fma_f32 v[68:69], v[64:65], v[64:65], v[68:69] op_sel:[1,1,0] op_sel_hi:[0,1,1] neg_lo:[1,0,0]
    v_pk_fma_f32 v[12:13], v[12:13], v[12:13], v[18:19] op_sel:[1,1,0] op_sel_hi:[0,1,1] neg_lo:[1,0,0]
    v_cvt_pk_bf16_f32 v22, v64, v65
    v_cvt_pk_bf16_f32 v106, v66, v67
    v_pk_mul_f32 v[70:71], v[40:41], v[12:13] op_sel_hi:[0,1] neg_hi:[1,0]
    v_pk_fma_f32 v[70:71], v[40:41], v[12:13], v[70:71] op_sel:[1,1,0] op_sel_hi:[1,0,1] neg_lo:[1,0,0] neg_hi:[1,0,0]
    v_cvt_pk_bf16_f32 v26, v68, v69
    v_cvt_pk_bf16_f32 v110, v70, v71
    s_waitcnt lgkmcnt(0)
    v_mul_f32 v10, v44, v30
    v_mul_f32 v11, v45, v30
    v_mul_f32 v14, v44, v31
    v_mul_f32 v15, v45, v31
    v_exp_f32 v10, v10
    v_fract_f32 v11, v11
    v_exp_f32 v14, v14
    v_fract_f32 v15, v15
    v_cos_f32 v12, v11
    v_sin_f32 v13, v11
    v_cos_f32 v16, v15
    v_sin_f32 v17, v15
    s_nop 0
    v_mul_f32 v12, v12, v10
    v_mul_f32 v13, v13, v10
    v_mul_f32 v56, v16, v14
    v_mul_f32 v57, v17, v14
    v_pk_mul_f32 v[58:59], v[46:47], v[12:13] op_sel_hi:[0,1] neg_hi:[1,0]
    v_pk_fma_f32 v[58:59], v[46:47], v[12:13], v[58:59] op_sel:[1,1,0] op_sel_hi:[1,0,1] neg_lo:[1,0,0] neg_hi:[1,0,0]
    v_pk_mul_f32 v[60:61], v[56:57], v[56:57] op_sel_hi:[0,1]
    v_pk_mul_f32 v[18:19], v[12:13], v[12:13] op_sel_hi:[0,1]
    v_pk_fma_f32 v[60:61], v[56:57], v[56:57], v[60:61] op_sel:[1,1,0] op_sel_hi:[0,1,1] neg_lo:[1,0,0]
    v_pk_fma_f32 v[12:13], v[12:13], v[12:13], v[18:19] op_sel:[1,1,0] op_sel_hi:[0,1,1] neg_lo:[1,0,0]
    v_cvt_pk_bf16_f32 v75, v56, v57
    v_cvt_pk_bf16_f32 v99, v58, v59
    v_pk_mul_f32 v[62:63], v[48:49], v[12:13] op_sel_hi:[0,1] neg_hi:[1,0]
    v_pk_fma_f32 v[62:63], v[48:49], v[12:13], v[62:63] op_sel:[1,1,0] op_sel_hi:[1,0,1] neg_lo:[1,0,0] neg_hi:[1,0,0]
    v_pk_mul_f32 v[64:65], v[60:61], v[60:61] op_sel_hi:[0,1]
    v_pk_mul_f32 v[18:19], v[12:13], v[12:13] op_sel_hi:[0,1]
    v_pk_fma_f32 v[64:65], v[60:61], v[60:61], v[64:65] op_sel:[1,1,0] op_sel_hi:[0,1,1] neg_lo:[1,0,0]
    v_pk_fma_f32 v[12:13], v[12:13], v[12:13], v[18:19] op_sel:[1,1,0] op_sel_hi:[0,1,1] neg_lo:[1,0,0]
    v_cvt_pk_bf16_f32 v79, v60, v61
    v_cvt_pk_bf16_f32 v103, v62, v63
    v_pk_mul_f32 v[66:67], v[50:51], v[12:13] op_sel_hi:[0,1] neg_hi:[1,0]
    v_pk_fma_f32 v[66:67], v[50:51], v[12:13], v[66:67] op_sel:[1,1,0] op_sel_hi:[1,0,1] neg_lo:[1,0,0] neg_hi:[1,0,0]
    v_pk_mul_f32 v[68:69], v[64:65], v[64:65] op_sel_hi:[0,1]
    v_pk_mul_f32 v[18:19], v[12:13], v[12:13] op_sel_hi:[0,1]
    v_pk_fma_f32 v[68:69], v[64:65], v[64:65], v[68:69] op_sel:[1,1,0] op_sel_hi:[0,1,1] neg_lo:[1,0,0]
    v_pk_fma_f32 v[12:13], v[12:13], v[12:13], v[18:19] op_sel:[1,1,0] op_sel_hi:[0,1,1] neg_lo:[1,0,0]
    v_cvt_pk_bf16_f32 v23, v64, v65
    v_cvt_pk_bf16_f32 v107, v66, v67
    v_pk_mul_f32 v[70:71], v[52:53], v[12:13] op_sel_hi:[0,1] neg_hi:[1,0]
    v_pk_fma_f32 v[70:71], v[52:53], v[12:13], v[70:71] op_sel:[1,1,0] op_sel_hi:[1,0,1] neg_lo:[1,0,0] neg_hi:[1,0,0]
    v_cvt_pk_bf16_f32 v27, v68, v69
    v_cvt_pk_bf16_f32 v111, v70, v71
    s_nop 1
    v_mfma_f32_16x16x32_bf16 v[80:83], v[96:99], v[72:75], v[80:83]
    v_mfma_f32_16x16x32_bf16 v[84:87], v[100:103], v[76:79], v[84:87]
    v_mfma_f32_16x16x32_bf16 v[88:91], v[104:107], v[20:23], v[88:91]
    v_mfma_f32_16x16x32_bf16 v[92:95], v[108:111], v[24:27], v[92:95]
    s_nop 15
    v_bfe_u32 v6, v0, 4, 2
    v_mul_u32_u24 v8, 2816, v1
    v_and_b32 v7, 63, v0
    v_mul_u32_u24 v9, 256, v6
    v_mad_u32_u24 v9, v2, 4, v9
    v_add_u32 v9, v9, v8
    ds_write_b32 v9, v80 offset:6144
    ds_write_b32 v9, v81 offset:6208
    ds_write_b32 v9, v82 offset:6272
    ds_write_b32 v9, v83 offset:6336
    v_mul_u32_u24 v9, 256, v6
    v_mad_u32_u24 v9, v2, 4, v9
    v_add_u32 v9, v9, v8
    v_cmp_gt_u32 vcc, 32, v7
    s_and_saveexec_b64 s[48:49], vcc
    ds_write_b32 v9, v84 offset:7168
    ds_write_b32 v9, v85 offset:7232
    ds_write_b32 v9, v86 offset:7296
    ds_write_b32 v9, v87 offset:7360
    s_or_b64 exec, exec, s[48:49]
    v_mul_u32_u24 v9, 256, v6
    v_mad_u32_u24 v9, v2, 4, v9
    v_add_u32 v9, v9, v8
    v_cmp_gt_u32 vcc, 32, v7
    s_and_saveexec_b64 s[48:49], vcc
    ds_write_b32 v9, v88 offset:7680
    ds_write_b32 v9, v89 offset:7744
    ds_write_b32 v9, v90 offset:7808
    ds_write_b32 v9, v91 offset:7872
    s_or_b64 exec, exec, s[48:49]
    v_mul_u32_u24 v9, 256, v6
    v_mad_u32_u24 v9, v2, 4, v9
    v_add_u32 v9, v9, v8
    v_cmp_gt_u32 vcc, 48, v7
    s_and_saveexec_b64 s[48:49], vcc
    ds_write_b32 v9, v92 offset:8192
    ds_write_b32 v9, v93 offset:8256
    ds_write_b32 v9, v94 offset:8320
    ds_write_b32 v9, v95 offset:8384
    s_or_b64 exec, exec, s[48:49]
    s_waitcnt lgkmcnt(0)
    s_barrier
    v_lshlrev_b32 v1, 2, v0
    ds_read_b32 v32, v1 offset:6144
    ds_read_b32 v33, v1 offset:8960
    ds_read_b32 v34, v1 offset:11776
    ds_read_b32 v35, v1 offset:14592
    ds_read_b32 v36, v1 offset:7168
    ds_read_b32 v37, v1 offset:9984
    ds_read_b32 v38, v1 offset:12800
    ds_read_b32 v39, v1 offset:15616
    ds_read_b32 v40, v1 offset:8192
    ds_read_b32 v41, v1 offset:11008
    ds_read_b32 v42, v1 offset:13824
    ds_read_b32 v43, v1 offset:16640
    s_waitcnt lgkmcnt(8)
    v_add_f32 v32, v32, v33
    v_add_f32 v34, v34, v35
    v_add_f32 v32, v32, v34
    v_cvt_pk_bf16_f32 v5, v32, v32
    v_lshlrev_b32 v5, 16, v5
    v_sub_f32 v5, v32, v5
    v_cvt_pk_bf16_f32 v32, v32, v5
    ds_write_b32 v1, v32 offset:0
    s_waitcnt lgkmcnt(4)
    v_add_f32 v36, v36, v37
    v_add_f32 v38, v38, v39
    v_add_f32 v36, v36, v38
    v_cvt_pk_bf16_f32 v5, v36, v36
    v_lshlrev_b32 v5, 16, v5
    v_sub_f32 v5, v36, v5
    v_cvt_pk_bf16_f32 v36, v36, v5
    ds_write_b32 v1, v36 offset:1024
    s_waitcnt lgkmcnt(0)
    v_add_f32 v40, v40, v41
    v_add_f32 v42, v42, v43
    v_add_f32 v40, v40, v42
    v_cvt_pk_bf16_f32 v5, v40, v40
    v_lshlrev_b32 v5, 16, v5
    v_sub_f32 v5, v40, v5
    v_cvt_pk_bf16_f32 v40, v40, v5
    ds_write_b32 v1, v40 offset:2048
    s_waitcnt lgkmcnt(0)
    s_barrier
    v_lshlrev_b32 v1, 3, v0
    v_sub_u32 v1, 2048, v1
    v_subrev_u32 v2, 0, v1
    v_cvt_f32_u32 v2, v2
    v_cvt_pk_bf16_f32 v2, v2, v2
    v_lshlrev_b32 v2, 16, v2
    v_lshrrev_b32 v3, 23, v2
    v_subrev_u32 v3, 134, v3
    v_max_i32 v3, 0, v3
    v_min_i32 v3, 3, v3
    v_cvt_u32_f32 v2, v2
    v_lshrrev_b32 v2, v3, v2
    v_lshl_add_u32 v2, v3, 7, v2
    v_lshlrev_b32 v2, 2, v2
    ds_read_b32 v32, v2 offset:0
    v_subrev_u32 v2, 1, v1
    v_cvt_f32_u32 v2, v2
    v_cvt_pk_bf16_f32 v2, v2, v2
    v_lshlrev_b32 v2, 16, v2
    v_lshrrev_b32 v3, 23, v2
    v_subrev_u32 v3, 134, v3
    v_max_i32 v3, 0, v3
    v_min_i32 v3, 3, v3
    v_cvt_u32_f32 v2, v2
    v_lshrrev_b32 v2, v3, v2
    v_lshl_add_u32 v2, v3, 7, v2
    v_lshlrev_b32 v2, 2, v2
    ds_read_b32 v33, v2 offset:0
    v_subrev_u32 v2, 2, v1
    v_cvt_f32_u32 v2, v2
    v_cvt_pk_bf16_f32 v2, v2, v2
    v_lshlrev_b32 v2, 16, v2
    v_lshrrev_b32 v3, 23, v2
    v_subrev_u32 v3, 134, v3
    v_max_i32 v3, 0, v3
    v_min_i32 v3, 3, v3
    v_cvt_u32_f32 v2, v2
    v_lshrrev_b32 v2, v3, v2
    v_lshl_add_u32 v2, v3, 7, v2
    v_lshlrev_b32 v2, 2, v2
    ds_read_b32 v34, v2 offset:0
    v_subrev_u32 v2, 3, v1
    v_cvt_f32_u32 v2, v2
    v_cvt_pk_bf16_f32 v2, v2, v2
    v_lshlrev_b32 v2, 16, v2
    v_lshrrev_b32 v3, 23, v2
    v_subrev_u32 v3, 134, v3
    v_max_i32 v3, 0, v3
    v_min_i32 v3, 3, v3
    v_cvt_u32_f32 v2, v2
    v_lshrrev_b32 v2, v3, v2
    v_lshl_add_u32 v2, v3, 7, v2
    v_lshlrev_b32 v2, 2, v2
    ds_read_b32 v35, v2 offset:0
    v_subrev_u32 v2, 4, v1
    v_cvt_f32_u32 v2, v2
    v_cvt_pk_bf16_f32 v2, v2, v2
    v_lshlrev_b32 v2, 16, v2
    v_lshrrev_b32 v3, 23, v2
    v_subrev_u32 v3, 134, v3
    v_max_i32 v3, 0, v3
    v_min_i32 v3, 3, v3
    v_cvt_u32_f32 v2, v2
    v_lshrrev_b32 v2, v3, v2
    v_lshl_add_u32 v2, v3, 7, v2
    v_lshlrev_b32 v2, 2, v2
    ds_read_b32 v36, v2 offset:0
    v_subrev_u32 v2, 5, v1
    v_cvt_f32_u32 v2, v2
    v_cvt_pk_bf16_f32 v2, v2, v2
    v_lshlrev_b32 v2, 16, v2
    v_lshrrev_b32 v3, 23, v2
    v_subrev_u32 v3, 134, v3
    v_max_i32 v3, 0, v3
    v_min_i32 v3, 3, v3
    v_cvt_u32_f32 v2, v2
    v_lshrrev_b32 v2, v3, v2
    v_lshl_add_u32 v2, v3, 7, v2
    v_lshlrev_b32 v2, 2, v2
    ds_read_b32 v37, v2 offset:0
    v_subrev_u32 v2, 6, v1
    v_cvt_f32_u32 v2, v2
    v_cvt_pk_bf16_f32 v2, v2, v2
    v_lshlrev_b32 v2, 16, v2
    v_lshrrev_b32 v3, 23, v2
    v_subrev_u32 v3, 134, v3
    v_max_i32 v3, 0, v3
    v_min_i32 v3, 3, v3
    v_cvt_u32_f32 v2, v2
    v_lshrrev_b32 v2, v3, v2
    v_lshl_add_u32 v2, v3, 7, v2
    v_lshlrev_b32 v2, 2, v2
    ds_read_b32 v38, v2 offset:0
    v_subrev_u32 v2, 7, v1
    v_cvt_f32_u32 v2, v2
    v_cvt_pk_bf16_f32 v2, v2, v2
    v_lshlrev_b32 v2, 16, v2
    v_lshrrev_b32 v3, 23, v2
    v_subrev_u32 v3, 134, v3
    v_max_i32 v3, 0, v3
    v_min_i32 v3, 3, v3
    v_cvt_u32_f32 v2, v2
    v_lshrrev_b32 v2, v3, v2
    v_lshl_add_u32 v2, v3, 7, v2
    v_lshlrev_b32 v2, 2, v2
    ds_read_b32 v39, v2 offset:0
    v_subrev_u32 v2, 8, v1
    v_cvt_f32_u32 v2, v2
    v_cvt_pk_bf16_f32 v2, v2, v2
    v_lshlrev_b32 v2, 16, v2
    v_lshrrev_b32 v3, 23, v2
    v_subrev_u32 v3, 134, v3
    v_max_i32 v3, 0, v3
    v_min_i32 v3, 3, v3
    v_cvt_u32_f32 v2, v2
    v_lshrrev_b32 v2, v3, v2
    v_lshl_add_u32 v2, v3, 7, v2
    v_lshlrev_b32 v2, 2, v2
    ds_read_b32 v40, v2 offset:0
    v_mov_b32 v2, 0
    ds_read_b32 v41, v2 offset:0
    s_mov_b32 s50, 0x05040100
    s_mov_b32 s51, 0x07060302
    v_cmp_eq_u32 vcc, 0, v0
    v_lshlrev_b32 v1, 4, v0
    s_waitcnt lgkmcnt(0)
    v_cndmask_b32 v32, v32, v2, vcc
    v_cndmask_b32 v41, v2, v41, vcc
    v_perm_b32 v44, v33, v32, s50
    v_perm_b32 v48, v34, v33, s50
    v_perm_b32 v45, v35, v34, s50
    v_perm_b32 v49, v36, v35, s50
    v_perm_b32 v46, v37, v36, s50
    v_perm_b32 v50, v38, v37, s50
    v_perm_b32 v47, v39, v38, s50
    v_perm_b32 v51, v40, v39, s50
    s_add_u32 s8, s46, 41287680
    s_addc_u32 s9, s47, 0
    s_and_b32 s9, s9, 0xffff
    s_mov_b32 s10, 9732096
    s_mov_b32 s11, 0x00020000
    s_mul_i32 s55, s3, 8448
    s_add_u32 s56, s55, 0
    buffer_store_dwordx4 v[44:47], v1, s[8:11], s56 offen sc0 sc1
    s_add_u32 s57, s55, 4224
    buffer_store_dwordx4 v[48:51], v1, s[8:11], s57 offen sc0 sc1
    v_add_u32 v1, 4096, v1
    v_and_b32 v60, 0xffff, v41
    v_lshrrev_b32 v64, 16, v41
    v_mov_b32 v61, 0
    v_mov_b32 v62, 0
    v_mov_b32 v63, 0
    v_mov_b32 v65, 0
    v_mov_b32 v66, 0
    v_mov_b32 v67, 0
    v_mov_b32 v68, 0
    v_mov_b32 v69, 0
    v_mov_b32 v70, 0
    v_mov_b32 v71, 0
    v_cmp_gt_u32 vcc, 8, v0
    s_and_saveexec_b64 s[48:49], vcc
    s_cbranch_execz KG_DONE
    buffer_store_dwordx4 v[60:63], v1, s[8:11], s56 offen sc0 sc1
    buffer_store_dwordx4 v[68:71], v1, s[8:11], s57 offen sc0 sc1
KG_DONE:
    s_endpgm
P_TR0:
    s_sub_u32 s3, s2, 640
    s_cmp_ge_u32 s3, 15
    s_cbranch_scc1 P_TR
    s_add_u32 s4, s46, 20054016
    s_addc_u32 s5, s47, 0
    s_and_b32 s5, s5, 0xffff
    s_mov_b32 s6, 61440
    s_mov_b32 s7, 0x00020000
    v_lshlrev_b32 v1, 4, v0
    v_mov_b32 v2, 0
    v_mov_b32 v3, 0
    v_mov_b32 v4, 0
    v_mov_b32 v5, 0
    s_lshl_b32 s3, s3, 12
    buffer_store_dwordx4 v[2:5], v1, s[4:7], s3 offen sc0 sc1
P_TR:
    s_sub_u32 s3, s2, 640
    s_lshl_b32 s3, s3, 2
    s_cmp_ge_u32 s3, 648
    s_cbranch_scc1 P_TR2
    s_mov_b32 s4, s36
    s_and_b32 s5, s37, 0xffff
    s_mov_b32 s6, 5308416
    s_mov_b32 s7, 0x00020000
    s_add_u32 s8, s46, 4718592
    s_addc_u32 s9, s47, 0
    s_and_b32 s9, s9, 0xffff
    s_mov_b32 s10, 5308416
    s_mov_b32 s11, 0x00020000
    s_mov_b32 s12, 9216
    s_mov_b32 s13, 1152
    s_mov_b32 s14, 72
    s_mov_b32 s66, 1152
    s_mov_b32 s67, 576
    s_mov_b32 s68, 0
    s_branch P_TRC
P_TR2:
    s_sub_u32 s3, s3, 648
    s_mov_b32 s4, s40
    s_and_b32 s5, s41, 0xffff
    s_mov_b32 s6, 5308416
    s_mov_b32 s7, 0x00020000
    s_add_u32 s8, s46, 10027008
    s_addc_u32 s9, s47, 0
    s_and_b32 s9, s9, 0xffff
    s_mov_b32 s10, 5308416
    s_mov_b32 s11, 0x00020000
    s_mov_b32 s12, 1152
    s_mov_b32 s13, 9216
    s_mov_b32 s14, 9
    s_mov_b32 s66, 576
    s_mov_b32 s67, 2304
    s_mov_b32 s68, 0
P_TRC:
    v_lshrrev_b32 v1, 3, v0
    v_and_b32 v2, 7, v0
    v_mul_lo_u32 v3, v1, s12
    v_lshl_add_u32 v3, v2, 4, v3
    v_cvt_f32_u32 v6, s14
    v_rcp_f32 v6, v6
    s_lshl_b32 s53, s13, 4
    s_add_u32 s54, s3, 0
    v_cvt_f32_u32 v5, s54
    v_add_f32 v5, 0.5, v5
    v_mul_f32 v5, v5, v6
    v_cvt_u32_f32 v5, v5
    s_nop 0
    v_readfirstlane_b32 s15, v5
    s_mul_i32 s50, s15, s14
    s_sub_u32 s50, s54, s50
    s_lshl_b32 s15, s15, 6
    s_lshl_b32 s50, s50, 6
    s_mul_i32 s51, s15, s12
    s_lshl_b32 s52, s50, 1
    s_add_u32 s51, s51, s52
    buffer_load_dwordx4 v[40:43], v3, s[4:7], s51 offen
    s_lshl_b32 s52, s12, 5
    s_add_u32 s51, s51, s52
    buffer_load_dwordx4 v[44:47], v3, s[4:7], s51 offen
    s_lshr_b32 s51, s50, 4
    s_mul_i32 s51, s51, s53
    s_lshl_b32 s52, s15, 5
    s_add_u32 s60, s51, s52
    s_add_u32 s54, s3, 1
    v_cvt_f32_u32 v5, s54
    v_add_f32 v5, 0.5, v5
    v_mul_f32 v5, v5, v6
    v_cvt_u32_f32 v5, v5
    s_nop 0
    v_readfirstlane_b32 s15, v5
    s_mul_i32 s50, s15, s14
    s_sub_u32 s50, s54, s50
    s_lshl_b32 s15, s15, 6
    s_lshl_b32 s50, s50, 6
    s_mul_i32 s51, s15, s12
    s_lshl_b32 s52, s50, 1
    s_add_u32 s51, s51, s52
    buffer_load_dwordx4 v[48:51], v3, s[4:7], s51 offen
    s_lshl_b32 s52, s12, 5
    s_add_u32 s51, s51, s52
    buffer_load_dwordx4 v[52:55], v3, s[4:7], s51 offen
    s_lshr_b32 s51, s50, 4
    s_mul_i32 s51, s51, s53
    s_lshl_b32 s52, s15, 5
    s_add_u32 s61, s51, s52
    s_add_u32 s54, s3, 2
    v_cvt_f32_u32 v5, s54
    v_add_f32 v5, 0.5, v5
    v_mul_f32 v5, v5, v6
    v_cvt_u32_f32 v5, v5
    s_nop 0
    v_readfirstlane_b32 s15, v5
    s_mul_i32 s50, s15, s14
    s_sub_u32 s50, s54, s50
    s_lshl_b32 s15, s15, 6
    s_lshl_b32 s50, s50, 6
    s_mul_i32 s51, s15, s12
    s_lshl_b32 s52, s50, 1
    s_add_u32 s51, s51, s52
    buffer_load_dwordx4 v[56:59], v3, s[4:7], s51 offen
    s_lshl_b32 s52, s12, 5
    s_add_u32 s51, s51, s52
    buffer_load_dwordx4 v[60:63], v3, s[4:7], s51 offen
    s_lshr_b32 s51, s50, 4
    s_mul_i32 s51, s51, s53
    s_lshl_b32 s52, s15, 5
    s_add_u32 s62, s51, s52
    s_add_u32 s54, s3, 3
    v_cvt_f32_u32 v5, s54
    v_add_f32 v5, 0.5, v5
    v_mul_f32 v5, v5, v6
    v_cvt_u32_f32 v5, v5
    s_nop 0
    v_readfirstlane_b32 s15, v5
    s_mul_i32 s50, s15, s14
    s_sub_u32 s50, s54, s50
    s_lshl_b32 s15, s15, 6
    s_lshl_b32 s50, s50, 6
    s_mul_i32 s51, s15, s12
    s_lshl_b32 s52, s50, 1
    s_add_u32 s51, s51, s52
    buffer_load_dwordx4 v[64:67], v3, s[4:7], s51 offen
    s_lshl_b32 s52, s12, 5
    s_add_u32 s51, s51, s52
    buffer_load_dwordx4 v[68:71], v3, s[4:7], s51 offen
    s_lshr_b32 s51, s50, 4
    s_mul_i32 s51, s51, s53
    s_lshl_b32 s52, s15, 5
    s_add_u32 s63, s51, s52
    v_mul_u32_u24 v4, 144, v1
    v_lshl_add_u32 v4, v2, 4, v4
    s_waitcnt vmcnt(6)
    ds_write_b128 v4, v[40:43] offset:0
    ds_write_b128 v4, v[44:47] offset:4608
    s_waitcnt vmcnt(4)
    ds_write_b128 v4, v[48:51] offset:9216
    ds_write_b128 v4, v[52:55] offset:13824
    s_waitcnt vmcnt(2)
    ds_write_b128 v4, v[56:59] offset:18432
    ds_write_b128 v4, v[60:63] offset:23040
    s_waitcnt vmcnt(0)
    ds_write_b128 v4, v[64:67] offset:27648
    ds_write_b128 v4, v[68:71] offset:32256
    s_waitcnt lgkmcnt(0)
    s_barrier
    v_lshrrev_b32 v4, 2, v2
    v_mul_u32_u24 v4, 4608, v4
    v_and_b32 v5, 3, v2
    v_mul_lo_u32 v5, v5, s66
    v_add_u32 v4, v4, v5
    v_lshl_add_u32 v4, v1, 1, v4
    v_add_u32 v7, s67, v4
    v_lshrrev_b32 v3, 4, v1
    v_and_b32 v5, 15, v1
    v_bfe_u32 v8, v1, 2, 1
    v_lshrrev_b32 v9, 3, v1
    v_lshlrev_b32 v9, 2, v9
    v_and_b32 v6, 3, v1
    v_add_u32 v9, v9, v6
    s_cmp_eq_u32 s68, 0
    s_cselect_b64 vcc, -1, 0
    v_cndmask_b32 v3, v8, v3, vcc
    v_cndmask_b32 v5, v9, v5, vcc
    v_mul_lo_u32 v3, v3, s53
    v_lshl_add_u32 v3, v5, 4, v3
    v_lshrrev_b32 v5, 2, v2
    v_lshl_add_u32 v3, v5, 10, v3
    v_and_b32 v5, 3, v2
    v_lshl_add_u32 v3, v5, 8, v3
    s_lshl_b32 s52, s53, 1
    ds_read_u16 v40, v4 offset:0
    ds_read_u16 v41, v4 offset:144
    ds_read_u16 v42, v4 offset:288
    ds_read_u16 v43, v4 offset:432
    ds_read_u16 v44, v7 offset:0
    ds_read_u16 v45, v7 offset:144
    ds_read_u16 v46, v7 offset:288
    ds_read_u16 v47, v7 offset:432
    s_waitcnt lgkmcnt(0)
    ds_read_u16 v48, v4 offset:64
    ds_read_u16 v49, v4 offset:208
    ds_read_u16 v50, v4 offset:352
    ds_read_u16 v51, v4 offset:496
    ds_read_u16 v52, v7 offset:64
    ds_read_u16 v53, v7 offset:208
    ds_read_u16 v54, v7 offset:352
    ds_read_u16 v55, v7 offset:496
    v_lshl_or_b32 v10, v41, 16, v40
    v_lshl_or_b32 v11, v43, 16, v42
    v_lshl_or_b32 v12, v45, 16, v44
    v_lshl_or_b32 v13, v47, 16, v46
    buffer_store_dwordx4 v[10:13], v3, s[8:11], s60 offen sc0 sc1
    s_waitcnt lgkmcnt(0)
    ds_read_u16 v40, v4 offset:9216
    ds_read_u16 v41, v4 offset:9360
    ds_read_u16 v42, v4 offset:9504
    ds_read_u16 v43, v4 offset:9648
    ds_read_u16 v44, v7 offset:9216
    ds_read_u16 v45, v7 offset:9360
    ds_read_u16 v46, v7 offset:9504
    ds_read_u16 v47, v7 offset:9648
    v_lshl_or_b32 v14, v49, 16, v48
    v_lshl_or_b32 v15, v51, 16, v50
    v_lshl_or_b32 v16, v53, 16, v52
    v_lshl_or_b32 v17, v55, 16, v54
    s_add_u32 s60, s60, s52
    buffer_store_dwordx4 v[14:17], v3, s[8:11], s60 offen sc0 sc1
    s_waitcnt lgkmcnt(0)
    ds_read_u16 v48, v4 offset:9280
    ds_read_u16 v49, v4 offset:9424
    ds_read_u16 v50, v4 offset:9568
    ds_read_u16 v51, v4 offset:9712
    ds_read_u16 v52, v7 offset:9280
    ds_read_u16 v53, v7 offset:9424
    ds_read_u16 v54, v7 offset:9568
    ds_read_u16 v55, v7 offset:9712
    v_lshl_or_b32 v10, v41, 16, v40
    v_lshl_or_b32 v11, v43, 16, v42
    v_lshl_or_b32 v12, v45, 16, v44
    v_lshl_or_b32 v13, v47, 16, v46
    buffer_store_dwordx4 v[10:13], v3, s[8:11], s61 offen sc0 sc1
    s_waitcnt lgkmcnt(0)
    ds_read_u16 v40, v4 offset:18432
    ds_read_u16 v41, v4 offset:18576
    ds_read_u16 v42, v4 offset:18720
    ds_read_u16 v43, v4 offset:18864
    ds_read_u16 v44, v7 offset:18432
    ds_read_u16 v45, v7 offset:18576
    ds_read_u16 v46, v7 offset:18720
    ds_read_u16 v47, v7 offset:18864
    v_lshl_or_b32 v14, v49, 16, v48
    v_lshl_or_b32 v15, v51, 16, v50
    v_lshl_or_b32 v16, v53, 16, v52
    v_lshl_or_b32 v17, v55, 16, v54
    s_add_u32 s61, s61, s52
    buffer_store_dwordx4 v[14:17], v3, s[8:11], s61 offen sc0 sc1
    s_waitcnt lgkmcnt(0)
    ds_read_u16 v48, v4 offset:18496
    ds_read_u16 v49, v4 offset:18640
    ds_read_u16 v50, v4 offset:18784
    ds_read_u16 v51, v4 offset:18928
    ds_read_u16 v52, v7 offset:18496
    ds_read_u16 v53, v7 offset:18640
    ds_read_u16 v54, v7 offset:18784
    ds_read_u16 v55, v7 offset:18928
    v_lshl_or_b32 v10, v41, 16, v40
    v_lshl_or_b32 v11, v43, 16, v42
    v_lshl_or_b32 v12, v45, 16, v44
    v_lshl_or_b32 v13, v47, 16, v46
    buffer_store_dwordx4 v[10:13], v3, s[8:11], s62 offen sc0 sc1
    s_waitcnt lgkmcnt(0)
    ds_read_u16 v40, v4 offset:27648
    ds_read_u16 v41, v4 offset:27792
    ds_read_u16 v42, v4 offset:27936
    ds_read_u16 v43, v4 offset:28080
    ds_read_u16 v44, v7 offset:27648
    ds_read_u16 v45, v7 offset:27792
    ds_read_u16 v46, v7 offset:27936
    ds_read_u16 v47, v7 offset:28080
    v_lshl_or_b32 v14, v49, 16, v48
    v_lshl_or_b32 v15, v51, 16, v50
    v_lshl_or_b32 v16, v53, 16, v52
    v_lshl_or_b32 v17, v55, 16, v54
    s_add_u32 s62, s62, s52
    buffer_store_dwordx4 v[14:17], v3, s[8:11], s62 offen sc0 sc1
    s_waitcnt lgkmcnt(0)
    ds_read_u16 v48, v4 offset:27712
    ds_read_u16 v49, v4 offset:27856
    ds_read_u16 v50, v4 offset:28000
    ds_read_u16 v51, v4 offset:28144
    ds_read_u16 v52, v7 offset:27712
    ds_read_u16 v53, v7 offset:27856
    ds_read_u16 v54, v7 offset:28000
    ds_read_u16 v55, v7 offset:28144
    v_lshl_or_b32 v10, v41, 16, v40
    v_lshl_or_b32 v11, v43, 16, v42
    v_lshl_or_b32 v12, v45, 16, v44
    v_lshl_or_b32 v13, v47, 16, v46
    buffer_store_dwordx4 v[10:13], v3, s[8:11], s63 offen sc0 sc1
    s_waitcnt lgkmcnt(0)
    v_lshl_or_b32 v14, v49, 16, v48
    v_lshl_or_b32 v15, v51, 16, v50
    v_lshl_or_b32 v16, v53, 16, v52
    v_lshl_or_b32 v17, v55, 16, v54
    s_add_u32 s63, s63, s52
    buffer_store_dwordx4 v[14:17], v3, s[8:11], s63 offen sc0 sc1
P_END:
    s_endpgm
.globl gemm1_kernel
.p2align 8
.type gemm1_kernel,@function
gemm1_kernel:
    s_load_dwordx16 s[32:47], s[0:1], 64
    s_load_dwordx16 s[16:31], s[0:1], 0
    s_waitcnt lgkmcnt(0)
    s_cmp_ge_u32 s2, 256
    s_cbranch_scc1 CONV_ENTRY
    s_add_u32 s4, s46, 0
    s_addc_u32 s5, s47, 0
    s_and_b32 s5, s5, 0xffff
    s_mov_b32 s6, 2359296
    s_mov_b32 s7, 0x00020000
    s_add_u32 s8, s46, 4718592
    s_addc_u32 s9, s47, 0
    s_and_b32 s9, s9, 0xffff
    s_mov_b32 s10, 5308416
    s_mov_b32 s11, 0x00020000
    s_add_u32 s12, s46, 51019776
    s_addc_u32 s13, s47, 0
    s_and_b32 s13, s13, 0xffff
    s_mov_b32 s14, 18874368
    s_mov_b32 s15, 0x00020000
    s_mov_b32 s20, s38
    s_and_b32 s21, s39, 0xffff
    s_mov_b32 s22, 9216
    s_mov_b32 s23, 0x00020000
    s_add_u32 s24, s46, 10027008
    s_addc_u32 s25, s47, 0
    s_and_b32 s25, s25, 0xffff
    s_mov_b32 s26, 5308416
    s_mov_b32 s27, 0x00020000
    s_add_u32 s28, s46, 20054016
    s_addc_u32 s29, s47, 0
    s_and_b32 s29, s29, 0xffff
    s_mov_b32 s30, 61440
    s_mov_b32 s31, 0x00020000
    s_and_b32 s52, s2, 7
    s_lshr_b32 s3, s2, 3
    v_lshrrev_b32 v1, 6, v0
    s_nop 0
    v_readfirstlane_b32 s53, v1
    v_and_b32 v1, 63, v0
    v_lshlrev_b32 v2, 4, v1
    v_lshrrev_b32 v4, 4, v1
    s_mul_i32 s63, s52, 576
    s_mul_i32 s55, s53, 144
    s_add_u32 s63, s63, s55
    v_lshl_add_u32 v7, v4, 2, s63
    v_lshlrev_b32 v7, 1, v7
    buffer_load_dwordx2 v[80:81], v7, s[20:23], 0 offen offset:0
    buffer_load_dwordx2 v[82:83], v7, s[20:23], 0 offen offset:32
    buffer_load_dwordx2 v[84:85], v7, s[20:23], 0 offen offset:64
    buffer_load_dwordx2 v[86:87], v7, s[20:23], 0 offen offset:96
    buffer_load_dwordx2 v[88:89], v7, s[20:23], 0 offen offset:128
    buffer_load_dwordx2 v[90:91], v7, s[20:23], 0 offen offset:160
    buffer_load_dwordx2 v[92:93], v7, s[20:23], 0 offen offset:192
    buffer_load_dwordx2 v[94:95], v7, s[20:23], 0 offen offset:224
    buffer_load_dwordx2 v[96:97], v7, s[20:23], 0 offen offset:256
    s_mul_i32 s90, s52, 36
    s_mul_i32 s55, s53, 9
    s_add_u32 s90, s90, s55
    s_mul_i32 s90, s90, 18432
    s_mul_i32 s56, s53, 18432
    s_mul_i32 s59, s3, 73728
    s_add_u32 s59, s59, s56
    s_mov_b32 s62, s56
    s_add_u32 m0, s62, 0
    s_add_u32 s93, s59, 0
    buffer_load_dwordx4 v2, s[4:7], s93 offen lds
    s_add_u32 m0, s62, 1024
    s_add_u32 s93, s59, 1024
    buffer_load_dwordx4 v2, s[4:7], s93 offen lds
    s_add_u32 s93, s90, 0
    buffer_load_dwordx4 v[8:11], v2, s[8:11], s93 offen
    s_add_u32 s93, s90, 18432
    buffer_load_dwordx4 v[12:15], v2, s[8:11], s93 offen
    s_add_u32 s93, s90, 36864
    buffer_load_dwordx4 v[16:19], v2, s[8:11], s93 offen
    s_add_u32 s93, s90, 55296
    buffer_load_dwordx4 v[20:23], v2, s[8:11], s93 offen
    s_add_u32 s93, s90, 73728
    buffer_load_dwordx4 v[24:27], v2, s[8:11], s93 offen
    s_add_u32 s93, s90, 92160
    buffer_load_dwordx4 v[28:31], v2, s[8:11], s93 offen
    s_add_u32 s93, s90, 110592
    buffer_load_dwordx4 v[32:35], v2, s[8:11], s93 offen
    s_add_u32 s93, s90, 129024
    buffer_load_dwordx4 v[36:39], v2, s[8:11], s93 offen
    s_add_u32 s93, s90, 147456
    buffer_load_dwordx4 v[40:43], v2, s[8:11], s93 offen
    s_add_u32 m0, s62, 2048
    s_add_u32 s93, s59, 2048
    buffer_load_dwordx4 v2, s[4:7], s93 offen lds
    s_add_u32 s93, s90, 1024
    buffer_load_dwordx4 v[44:47], v2, s[8:11], s93 offen
    s_add_u32 s93, s90, 19456
    buffer_load_dwordx4 v[48:51], v2, s[8:11], s93 offen
    s_add_u32 s93, s90, 37888
    buffer_load_dwordx4 v[52:55], v2, s[8:11], s93 offen
    s_add_u32 s93, s90, 56320
    buffer_load_dwordx4 v[56:59], v2, s[8:11], s93 offen
    s_add_u32 s93, s90, 74752
    buffer_load_dwordx4 v[60:63], v2, s[8:11], s93 offen
    s_add_u32 s93, s90, 93184
    buffer_load_dwordx4 v[64:67], v2, s[8:11], s93 offen
    s_add_u32 s93, s90, 111616
    buffer_load_dwordx4 v[68:71], v2, s[8:11], s93 offen
    s_add_u32 s93, s90, 130048
    buffer_load_dwordx4 v[72:75], v2, s[8:11], s93 offen
    s_add_u32 s93, s90, 148480
    buffer_load_dwordx4 v[76:79], v2, s[8:11], s93 offen
    s_mul_i32 s91, s53, 1327104
    s_mul_i32 s55, s52, 18432
    s_add_u32 s91, s91, s55
    s_mul_i32 s92, s52, 2359296
    s_mul_i32 s55, s3, 73728
    s_add_u32 s92, s92, s55
    s_mul_i32 s55, s53, 9216
    s_add_u32 s92, s92, s55
    s_lshl_b32 s60, s3, 2
    s_add_u32 s60, s60, s53
    s_mul_i32 s60, s60, 192
    s_mul_i32 s55, s52, 4
    s_add_u32 s60, s60, s55
    s_mul_i32 s55, s53, 9
    s_lshr_b32 s56, s55, 1
    s_lshl_b32 s56, s56, 10
    s_and_b32 s57, s55, 1
    s_lshl_b32 s57, s57, 3
    s_add_u32 s56, s56, s57
    v_add_u32 v5, s56, v2
    s_add_u32 s55, s55, 1
    s_lshr_b32 s56, s55, 1
    s_lshl_b32 s56, s56, 10
    s_and_b32 s57, s55, 1
    s_lshl_b32 s57, s57, 3
    s_add_u32 s56, s56, s57
    v_add_u32 v6, s56, v2
    v_add_u32 v3, 36864, v2
    v_mov_b32 v4, 1
    v_mov_b32 v7, 0
    s_mov_b32 s58, 0xffff0000
    s_waitcnt vmcnt(21)
    v_lshlrev_b32 v112, 16, v80
    v_and_b32 v113, s58, v80
    v_lshlrev_b32 v116, 16, v80
    v_and_b32 v117, s58, v80
    v_lshlrev_b32 v120, 16, v80
    v_and_b32 v121, s58, v80
    v_lshlrev_b32 v124, 16, v80
    v_and_b32 v125, s58, v80
    v_lshlrev_b32 v114, 16, v81
    v_and_b32 v115, s58, v81
    v_lshlrev_b32 v118, 16, v81
    v_and_b32 v119, s58, v81
    v_lshlrev_b32 v122, 16, v81
    v_and_b32 v123, s58, v81
    v_lshlrev_b32 v126, 16, v81
    v_and_b32 v127, s58, v81
    v_lshlrev_b32 v128, 16, v82
    v_and_b32 v129, s58, v82
    v_lshlrev_b32 v132, 16, v82
    v_and_b32 v133, s58, v82
    v_lshlrev_b32 v136, 16, v82
    v_and_b32 v137, s58, v82
    v_lshlrev_b32 v140, 16, v82
    v_and_b32 v141, s58, v82
    v_lshlrev_b32 v130, 16, v83
    v_and_b32 v131, s58, v83
    v_lshlrev_b32 v134, 16, v83
    v_and_b32 v135, s58, v83
    v_lshlrev_b32 v138, 16, v83
    v_and_b32 v139, s58, v83
    v_lshlrev_b32 v142, 16, v83
    v_and_b32 v143, s58, v83
    v_lshlrev_b32 v144, 16, v84
    v_and_b32 v145, s58, v84
    v_lshlrev_b32 v148, 16, v84
    v_and_b32 v149, s58, v84
    v_lshlrev_b32 v152, 16, v84
    v_and_b32 v153, s58, v84
    v_lshlrev_b32 v156, 16, v84
    v_and_b32 v157, s58, v84
    v_lshlrev_b32 v146, 16, v85
    v_and_b32 v147, s58, v85
    v_lshlrev_b32 v150, 16, v85
    v_and_b32 v151, s58, v85
    v_lshlrev_b32 v154, 16, v85
    v_and_b32 v155, s58, v85
    v_lshlrev_b32 v158, 16, v85
    v_and_b32 v159, s58, v85
    v_lshlrev_b32 v160, 16, v86
    v_and_b32 v161, s58, v86
    v_lshlrev_b32 v164, 16, v86
    v_and_b32 v165, s58, v86
    v_lshlrev_b32 v168, 16, v86
    v_and_b32 v169, s58, v86
    v_lshlrev_b32 v172, 16, v86
    v_and_b32 v173, s58, v86
    v_lshlrev_b32 v162, 16, v87
    v_and_b32 v163, s58, v87
    v_lshlrev_b32 v166, 16, v87
    v_and_b32 v167, s58, v87
    v_lshlrev_b32 v170, 16, v87
    v_and_b32 v171, s58, v87
    v_lshlrev_b32 v174, 16, v87
    v_and_b32 v175, s58, v87
    v_lshlrev_b32 v176, 16, v88
    v_and_b32 v177, s58, v88
    v_lshlrev_b32 v180, 16, v88
    v_and_b32 v181, s58, v88
    v_lshlrev_b32 v184, 16, v88
    v_and_b32 v185, s58, v88
    v_lshlrev_b32 v188, 16, v88
    v_and_b32 v189, s58, v88
    v_lshlrev_b32 v178, 16, v89
    v_and_b32 v179, s58, v89
    v_lshlrev_b32 v182, 16, v89
    v_and_b32 v183, s58, v89
    v_lshlrev_b32 v186, 16, v89
    v_and_b32 v187, s58, v89
    v_lshlrev_b32 v190, 16, v89
    v_and_b32 v191, s58, v89
    v_lshlrev_b32 v192, 16, v90
    v_and_b32 v193, s58, v90
    v_lshlrev_b32 v196, 16, v90
    v_and_b32 v197, s58, v90
    v_lshlrev_b32 v200, 16, v90
    v_and_b32 v201, s58, v90
    v_lshlrev_b32 v204, 16, v90
    v_and_b32 v205, s58, v90
    v_lshlrev_b32 v194, 16, v91
    v_and_b32 v195, s58, v91
    v_lshlrev_b32 v198, 16, v91
    v_and_b32 v199, s58, v91
    v_lshlrev_b32 v202, 16, v91
    v_and_b32 v203, s58, v91
    v_lshlrev_b32 v206, 16, v91
    v_and_b32 v207, s58, v91
    v_lshlrev_b32 v208, 16, v92
    v_and_b32 v209, s58, v92
    v_lshlrev_b32 v212, 16, v92
    v_and_b32 v213, s58, v92
    v_lshlrev_b32 v216, 16, v92
    v_and_b32 v217, s58, v92
    v_lshlrev_b32 v220, 16, v92
    v_and_b32 v221, s58, v92
    v_lshlrev_b32 v210, 16, v93
    v_and_b32 v211, s58, v93
    v_lshlrev_b32 v214, 16, v93
    v_and_b32 v215, s58, v93
    v_lshlrev_b32 v218, 16, v93
    v_and_b32 v219, s58, v93
    v_lshlrev_b32 v222, 16, v93
    v_and_b32 v223, s58, v93
    v_lshlrev_b32 v224, 16, v94
    v_and_b32 v225, s58, v94
    v_lshlrev_b32 v228, 16, v94
    v_and_b32 v229, s58, v94
    v_lshlrev_b32 v232, 16, v94
    v_and_b32 v233, s58, v94
    v_lshlrev_b32 v236, 16, v94
    v_and_b32 v237, s58, v94
    v_lshlrev_b32 v226, 16, v95
    v_and_b32 v227, s58, v95
    v_lshlrev_b32 v230, 16, v95
    v_and_b32 v231, s58, v95
    v_lshlrev_b32 v234, 16, v95
    v_and_b32 v235, s58, v95
    v_lshlrev_b32 v238, 16, v95
    v_and_b32 v239, s58, v95
    v_lshlrev_b32 v240, 16, v96
    v_and_b32 v241, s58, v96
    v_lshlrev_b32 v244, 16, v96
    v_and_b32 v245, s58, v96
    v_lshlrev_b32 v248, 16, v96
    v_and_b32 v249, s58, v96
    v_lshlrev_b32 v252, 16, v96
    v_and_b32 v253, s58, v96
    v_lshlrev_b32 v242, 16, v97
    v_and_b32 v243, s58, v97
    v_lshlrev_b32 v246, 16, v97
    v_and_b32 v247, s58, v97
    v_lshlrev_b32 v250, 16, v97
    v_and_b32 v251, s58, v97
    v_lshlrev_b32 v254, 16, v97
    v_and_b32 v255, s58, v97
    s_waitcnt vmcnt(20)
    s_barrier
    ds_read_b128 v[80:83], v2 offset:0
    ds_read_b128 v[84:87], v2 offset:18432
    ds_read_b128 v[88:91], v3 offset:0
    ds_read_b128 v[92:95], v3 offset:18432
    s_waitcnt vmcnt(19) lgkmcnt(0)
    s_barrier
    ds_read_b128 v[96:99], v2 offset:1024
    ds_read_b128 v[100:103], v2 offset:19456
    ds_read_b128 v[104:107], v3 offset:1024
    ds_read_b128 v[108:111], v3 offset:19456
    s_add_u32 m0, s62, 3072
    s_add_u32 s93, s59, 3072
    buffer_load_dwordx4 v2, s[4:7], s93 offen lds
    s_waitcnt vmcnt(19)
    v_mfma_f32_16x16x32_bf16 v[112:115], v[8:11], v[80:83], v[112:115]
    v_mfma_f32_16x16x32_bf16 v[116:119], v[8:11], v[84:87], v[116:119]
    v_mfma_f32_16x16x32_bf16 v[120:123], v[8:11], v[88:91], v[120:123]
    v_mfma_f32_16x16x32_bf16 v[124:127], v[8:11], v[92:95], v[124:127]
    s_add_u32 s93, s90, 2048
    buffer_load_dwordx4 v[8:11], v2, s[8:11], s93 offen
    s_waitcnt vmcnt(19)
    v_mfma_f32_16x16x32_bf16 v[128:131], v[12:15], v[80:83], v[128:131]
    v_mfma_f32_16x16x32_bf16 v[132:135], v[12:15], v[84:87], v[132:135]
    v_mfma_f32_16x16x32_bf16 v[136:139], v[12:15], v[88:91], v[136:139]
    v_mfma_f32_16x16x32_bf16 v[140:143], v[12:15], v[92:95], v[140:143]
    s_add_u32 s93, s90, 20480
    buffer_load_dwordx4 v[12:15], v2, s[8:11], s93 offen
    s_waitcnt vmcnt(19)
    v_mfma_f32_16x16x32_bf16 v[144:147], v[16:19], v[80:83], v[144:147]
    v_mfma_f32_16x16x32_bf16 v[148:151], v[16:19], v[84:87], v[148:151]
    v_mfma_f32_16x16x32_bf16 v[152:155], v[16:19], v[88:91], v[152:155]
    v_mfma_f32_16x16x32_bf16 v[156:159], v[16:19], v[92:95], v[156:159]
    s_add_u32 s93, s90, 38912
    buffer_load_dwordx4 v[16:19], v2, s[8:11], s93 offen
    s_waitcnt vmcnt(19)
    v_mfma_f32_16x16x32_bf16 v[160:163], v[20:23], v[80:83], v[160:163]
    v_mfma_f32_16x16x32_bf16 v[164:167], v[20:23], v[84:87], v[164:167]
    v_mfma_f32_16x16x32_bf16 v[168:171], v[20:23], v[88:91], v[168:171]
    v_mfma_f32_16x16x32_bf16 v[172:175], v[20:23], v[92:95], v[172:175]
    s_add_u32 s93, s90, 57344
    buffer_load_dwordx4 v[20:23], v2, s[8:11], s93 offen
    s_waitcnt vmcnt(19)
    v_mfma_f32_16x16x32_bf16 v[176:179], v[24:27], v[80:83], v[176:179]
    v_mfma_f32_16x16x32_bf16 v[180:183], v[24:27], v[84:87], v[180:183]
    v_mfma_f32_16x16x32_bf16 v[184:187], v[24:27], v[88:91], v[184:187]
    v_mfma_f32_16x16x32_bf16 v[188:191], v[24:27], v[92:95], v[188:191]
    s_add_u32 s93, s90, 75776
    buffer_load_dwordx4 v[24:27], v2, s[8:11], s93 offen
    s_waitcnt vmcnt(19)
    v_mfma_f32_16x16x32_bf16 v[192:195], v[28:31], v[80:83], v[192:195]
    v_mfma_f32_16x16x32_bf16 v[196:199], v[28:31], v[84:87], v[196:199]
    v_mfma_f32_16x16x32_bf16 v[200:203], v[28:31], v[88:91], v[200:203]
    v_mfma_f32_16x16x32_bf16 v[204:207], v[28:31], v[92:95], v[204:207]
    s_add_u32 s93, s90, 94208
    buffer_load_dwordx4 v[28:31], v2, s[8:11], s93 offen
    s_waitcnt vmcnt(19)
    v_mfma_f32_16x16x32_bf16 v[208:211], v[32:35], v[80:83], v[208:211]
    v_mfma_f32_16x16x32_bf16 v[212:215], v[32:35], v[84:87], v[212:215]
    v_mfma_f32_16x16x32_bf16 v[216:219], v[32:35], v[88:91], v[216:219]
    v_mfma_f32_16x16x32_bf16 v[220:223], v[32:35], v[92:95], v[220:223]
    s_add_u32 s93, s90, 112640
    buffer_load_dwordx4 v[32:35], v2, s[8:11], s93 offen
    s_waitcnt vmcnt(19)
    v_mfma_f32_16x16x32_bf16 v[224:227], v[36:39], v[80:83], v[224:227]
    v_mfma_f32_16x16x32_bf16 v[228:231], v[36:39], v[84:87], v[228:231]
    v_mfma_f32_16x16x32_bf16 v[232:235], v[36:39], v[88:91], v[232:235]
    v_mfma_f32_16x16x32_bf16 v[236:239], v[36:39], v[92:95], v[236:239]
    s_add_u32 s93, s90, 131072
    buffer_load_dwordx4 v[36:39], v2, s[8:11], s93 offen
    s_waitcnt vmcnt(19)
    v_mfma_f32_16x16x32_bf16 v[240:243], v[40:43], v[80:83], v[240:243]
    v_mfma_f32_16x16x32_bf16 v[244:247], v[40:43], v[84:87], v[244:247]
    v_mfma_f32_16x16x32_bf16 v[248:251], v[40:43], v[88:91], v[248:251]
    v_mfma_f32_16x16x32_bf16 v[252:255], v[40:43], v[92:95], v[252:255]
    s_add_u32 s93, s90, 149504
    buffer_load_dwordx4 v[40:43], v2, s[8:11], s93 offen
    s_waitcnt vmcnt(19) lgkmcnt(0)
    s_barrier
    ds_read_b128 v[80:83], v2 offset:2048
    ds_read_b128 v[84:87], v2 offset:20480
    ds_read_b128 v[88:91], v3 offset:2048
    ds_read_b128 v[92:95], v3 offset:20480
    s_add_u32 m0, s62, 4096
    s_add_u32 s93, s59, 4096
    buffer_load_dwordx4 v2, s[4:7], s93 offen lds
    s_waitcnt vmcnt(19)
    v_mfma_f32_16x16x32_bf16 v[112:115], v[44:47], v[96:99], v[112:115]
    v_mfma_f32_16x16x32_bf16 v[116:119], v[44:47], v[100:103], v[116:119]
    v_mfma_f32_16x16x32_bf16 v[120:123], v[44:47], v[104:107], v[120:123]
    v_mfma_f32_16x16x32_bf16 v[124:127], v[44:47], v[108:111], v[124:127]
    s_add_u32 s93, s90, 3072
    buffer_load_dwordx4 v[44:47], v2, s[8:11], s93 offen
    s_waitcnt vmcnt(19)
    v_mfma_f32_16x16x32_bf16 v[128:131], v[48:51], v[96:99], v[128:131]
    v_mfma_f32_16x16x32_bf16 v[132:135], v[48:51], v[100:103], v[132:135]
    v_mfma_f32_16x16x32_bf16 v[136:139], v[48:51], v[104:107], v[136:139]
    v_mfma_f32_16x16x32_bf16 v[140:143], v[48:51], v[108:111], v[140:143]
    s_add_u32 s93, s90, 21504
    buffer_load_dwordx4 v[48:51], v2, s[8:11], s93 offen
    s_waitcnt vmcnt(19)
    v_mfma_f32_16x16x32_bf16 v[144:147], v[52:55], v[96:99], v[144:147]
    v_mfma_f32_16x16x32_bf16 v[148:151], v[52:55], v[100:103], v[148:151]
    v_mfma_f32_16x16x32_bf16 v[152:155], v[52:55], v[104:107], v[152:155]
    v_mfma_f32_16x16x32_bf16 v[156:159], v[52:55], v[108:111], v[156:159]
    s_add_u32 s93, s90, 39936
    buffer_load_dwordx4 v[52:55], v2, s[8:11], s93 offen
    s_waitcnt vmcnt(19)
    v_mfma_f32_16x16x32_bf16 v[160:163], v[56:59], v[96:99], v[160:163]
    v_mfma_f32_16x16x32_bf16 v[164:167], v[56:59], v[100:103], v[164:167]
    v_mfma_f32_16x16x32_bf16 v[168:171], v[56:59], v[104:107], v[168:171]
    v_mfma_f32_16x16x32_bf16 v[172:175], v[56:59], v[108:111], v[172:175]
    s_add_u32 s93, s90, 58368
    buffer_load_dwordx4 v[56:59], v2, s[8:11], s93 offen
    s_waitcnt vmcnt(19)
    v_mfma_f32_16x16x32_bf16 v[176:179], v[60:63], v[96:99], v[176:179]
    v_mfma_f32_16x16x32_bf16 v[180:183], v[60:63], v[100:103], v[180:183]
    v_mfma_f32_16x16x32_bf16 v[184:187], v[60:63], v[104:107], v[184:187]
    v_mfma_f32_16x16x32_bf16 v[188:191], v[60:63], v[108:111], v[188:191]
    s_add_u32 s93, s90, 76800
    buffer_load_dwordx4 v[60:63], v2, s[8:11], s93 offen
    s_waitcnt vmcnt(19)
    v_mfma_f32_16x16x32_bf16 v[192:195], v[64:67], v[96:99], v[192:195]
    v_mfma_f32_16x16x32_bf16 v[196:199], v[64:67], v[100:103], v[196:199]
    v_mfma_f32_16x16x32_bf16 v[200:203], v[64:67], v[104:107], v[200:203]
    v_mfma_f32_16x16x32_bf16 v[204:207], v[64:67], v[108:111], v[204:207]
    s_add_u32 s93, s90, 95232
    buffer_load_dwordx4 v[64:67], v2, s[8:11], s93 offen
    s_waitcnt vmcnt(19)
    v_mfma_f32_16x16x32_bf16 v[208:211], v[68:71], v[96:99], v[208:211]
    v_mfma_f32_16x16x32_bf16 v[212:215], v[68:71], v[100:103], v[212:215]
    v_mfma_f32_16x16x32_bf16 v[216:219], v[68:71], v[104:107], v[216:219]
    v_mfma_f32_16x16x32_bf16 v[220:223], v[68:71], v[108:111], v[220:223]
    s_add_u32 s93, s90, 113664
    buffer_load_dwordx4 v[68:71], v2, s[8:11], s93 offen
    s_waitcnt vmcnt(19)
    v_mfma_f32_16x16x32_bf16 v[224:227], v[72:75], v[96:99], v[224:227]
    v_mfma_f32_16x16x32_bf16 v[228:231], v[72:75], v[100:103], v[228:231]
    v_mfma_f32_16x16x32_bf16 v[232:235], v[72:75], v[104:107], v[232:235]
    v_mfma_f32_16x16x32_bf16 v[236:239], v[72:75], v[108:111], v[236:239]
    s_add_u32 s93, s90, 132096
    buffer_load_dwordx4 v[72:75], v2, s[8:11], s93 offen
    s_waitcnt vmcnt(19)
    v_mfma_f32_16x16x32_bf16 v[240:243], v[76:79], v[96:99], v[240:243]
    v_mfma_f32_16x16x32_bf16 v[244:247], v[76:79], v[100:103], v[244:247]
    v_mfma_f32_16x16x32_bf16 v[248:251], v[76:79], v[104:107], v[248:251]
    v_mfma_f32_16x16x32_bf16 v[252:255], v[76:79], v[108:111], v[252:255]
    s_add_u32 s93, s90, 150528
    buffer_load_dwordx4 v[76:79], v2, s[8:11], s93 offen
    s_waitcnt vmcnt(19) lgkmcnt(0)
    s_barrier
    ds_read_b128 v[96:99], v2 offset:3072
    ds_read_b128 v[100:103], v2 offset:21504
    ds_read_b128 v[104:107], v3 offset:3072
    ds_read_b128 v[108:111], v3 offset:21504
    s_add_u32 m0, s62, 5120
    s_add_u32 s93, s59, 5120
    buffer_load_dwordx4 v2, s[4:7], s93 offen lds
    s_waitcnt vmcnt(19)
    v_mfma_f32_16x16x32_bf16 v[112:115], v[8:11], v[80:83], v[112:115]
    v_mfma_f32_16x16x32_bf16 v[116:119], v[8:11], v[84:87], v[116:119]
    v_mfma_f32_16x16x32_bf16 v[120:123], v[8:11], v[88:91], v[120:123]
    v_mfma_f32_16x16x32_bf16 v[124:127], v[8:11], v[92:95], v[124:127]
    s_add_u32 s93, s90, 4096
    buffer_load_dwordx4 v[8:11], v2, s[8:11], s93 offen
    s_waitcnt vmcnt(19)
    v_mfma_f32_16x16x32_bf16 v[128:131], v[12:15], v[80:83], v[128:131]
    v_mfma_f32_16x16x32_bf16 v[132:135], v[12:15], v[84:87], v[132:135]
    v_mfma_f32_16x16x32_bf16 v[136:139], v[12:15], v[88:91], v[136:139]
    v_mfma_f32_16x16x32_bf16 v[140:143], v[12:15], v[92:95], v[140:143]
    s_add_u32 s93, s90, 22528
    buffer_load_dwordx4 v[12:15], v2, s[8:11], s93 offen
    s_waitcnt vmcnt(19)
    v_mfma_f32_16x16x32_bf16 v[144:147], v[16:19], v[80:83], v[144:147]
    v_mfma_f32_16x16x32_bf16 v[148:151], v[16:19], v[84:87], v[148:151]
    v_mfma_f32_16x16x32_bf16 v[152:155], v[16:19], v[88:91], v[152:155]
    v_mfma_f32_16x16x32_bf16 v[156:159], v[16:19], v[92:95], v[156:159]
    s_add_u32 s93, s90, 40960
    buffer_load_dwordx4 v[16:19], v2, s[8:11], s93 offen
    s_waitcnt vmcnt(19)
    v_mfma_f32_16x16x32_bf16 v[160:163], v[20:23], v[80:83], v[160:163]
    v_mfma_f32_16x16x32_bf16 v[164:167], v[20:23], v[84:87], v[164:167]
    v_mfma_f32_16x16x32_bf16 v[168:171], v[20:23], v[88:91], v[168:171]
    v_mfma_f32_16x16x32_bf16 v[172:175], v[20:23], v[92:95], v[172:175]
    s_add_u32 s93, s90, 59392
    buffer_load_dwordx4 v[20:23], v2, s[8:11], s93 offen
    s_waitcnt vmcnt(19)
    v_mfma_f32_16x16x32_bf16 v[176:179], v[24:27], v[80:83], v[176:179]
    v_mfma_f32_16x16x32_bf16 v[180:183], v[24:27], v[84:87], v[180:183]
    v_mfma_f32_16x16x32_bf16 v[184:187], v[24:27], v[88:91], v[184:187]
    v_mfma_f32_16x16x32_bf16 v[188:191], v[24:27], v[92:95], v[188:191]
    s_add_u32 s93, s90, 77824
    buffer_load_dwordx4 v[24:27], v2, s[8:11], s93 offen
    s_waitcnt vmcnt(19)
    v_mfma_f32_16x16x32_bf16 v[192:195], v[28:31], v[80:83], v[192:195]
    v_mfma_f32_16x16x32_bf16 v[196:199], v[28:31], v[84:87], v[196:199]
    v_mfma_f32_16x16x32_bf16 v[200:203], v[28:31], v[88:91], v[200:203]
    v_mfma_f32_16x16x32_bf16 v[204:207], v[28:31], v[92:95], v[204:207]
    s_add_u32 s93, s90, 96256
    buffer_load_dwordx4 v[28:31], v2, s[8:11], s93 offen
    s_waitcnt vmcnt(19)
    v_mfma_f32_16x16x32_bf16 v[208:211], v[32:35], v[80:83], v[208:211]
    v_mfma_f32_16x16x32_bf16 v[212:215], v[32:35], v[84:87], v[212:215]
    v_mfma_f32_16x16x32_bf16 v[216:219], v[32:35], v[88:91], v[216:219]
    v_mfma_f32_16x16x32_bf16 v[220:223], v[32:35], v[92:95], v[220:223]
    s_add_u32 s93, s90, 114688
    buffer_load_dwordx4 v[32:35], v2, s[8:11], s93 offen
    s_waitcnt vmcnt(19)
    v_mfma_f32_16x16x32_bf16 v[224:227], v[36:39], v[80:83], v[224:227]
    v_mfma_f32_16x16x32_bf16 v[228:231], v[36:39], v[84:87], v[228:231]
    v_mfma_f32_16x16x32_bf16 v[232:235], v[36:39], v[88:91], v[232:235]
    v_mfma_f32_16x16x32_bf16 v[236:239], v[36:39], v[92:95], v[236:239]
    s_add_u32 s93, s90, 133120
    buffer_load_dwordx4 v[36:39], v2, s[8:11], s93 offen
    s_waitcnt vmcnt(19)
    v_mfma_f32_16x16x32_bf16 v[240:243], v[40:43], v[80:83], v[240:243]
    v_mfma_f32_16x16x32_bf16 v[244:247], v[40:43], v[84:87], v[244:247]
    v_mfma_f32_16x16x32_bf16 v[248:251], v[40:43], v[88:91], v[248:251]
    v_mfma_f32_16x16x32_bf16 v[252:255], v[40:43], v[92:95], v[252:255]
    s_add_u32 s93, s90, 151552
    buffer_load_dwordx4 v[40:43], v2, s[8:11], s93 offen
    s_waitcnt vmcnt(19) lgkmcnt(0)
    s_barrier
    ds_read_b128 v[80:83], v2 offset:4096
    ds_read_b128 v[84:87], v2 offset:22528
    ds_read_b128 v[88:91], v3 offset:4096
    ds_read_b128 v[92:95], v3 offset:22528
    s_add_u32 m0, s62, 6144
    s_add_u32 s93, s59, 6144
    buffer_load_dwordx4 v2, s[4:7], s93 offen lds
    s_waitcnt vmcnt(19)
    v_mfma_f32_16x16x32_bf16 v[112:115], v[44:47], v[96:99], v[112:115]
    v_mfma_f32_16x16x32_bf16 v[116:119], v[44:47], v[100:103], v[116:119]
    v_mfma_f32_16x16x32_bf16 v[120:123], v[44:47], v[104:107], v[120:123]
    v_mfma_f32_16x16x32_bf16 v[124:127], v[44:47], v[108:111], v[124:127]
    s_add_u32 s93, s90, 5120
    buffer_load_dwordx4 v[44:47], v2, s[8:11], s93 offen
    s_waitcnt vmcnt(19)
    v_mfma_f32_16x16x32_bf16 v[128:131], v[48:51], v[96:99], v[128:131]
    v_mfma_f32_16x16x32_bf16 v[132:135], v[48:51], v[100:103], v[132:135]
    v_mfma_f32_16x16x32_bf16 v[136:139], v[48:51], v[104:107], v[136:139]
    v_mfma_f32_16x16x32_bf16 v[140:143], v[48:51], v[108:111], v[140:143]
    s_add_u32 s93, s90, 23552
    buffer_load_dwordx4 v[48:51], v2, s[8:11], s93 offen
    s_waitcnt vmcnt(19)
    v_mfma_f32_16x16x32_bf16 v[144:147], v[52:55], v[96:99], v[144:147]
    v_mfma_f32_16x16x32_bf16 v[148:151], v[52:55], v[100:103], v[148:151]
    v_mfma_f32_16x16x32_bf16 v[152:155], v[52:55], v[104:107], v[152:155]
    v_mfma_f32_16x16x32_bf16 v[156:159], v[52:55], v[108:111], v[156:159]
    s_add_u32 s93, s90, 41984
    buffer_load_dwordx4 v[52:55], v2, s[8:11], s93 offen
    s_waitcnt vmcnt(19)
    v_mfma_f32_16x16x32_bf16 v[160:163], v[56:59], v[96:99], v[160:163]
    v_mfma_f32_16x16x32_bf16 v[164:167], v[56:59], v[100:103], v[164:167]
    v_mfma_f32_16x16x32_bf16 v[168:171], v[56:59], v[104:107], v[168:171]
    v_mfma_f32_16x16x32_bf16 v[172:175], v[56:59], v[108:111], v[172:175]
    s_add_u32 s93, s90, 60416
    buffer_load_dwordx4 v[56:59], v2, s[8:11], s93 offen
    s_waitcnt vmcnt(19)
    v_mfma_f32_16x16x32_bf16 v[176:179], v[60:63], v[96:99], v[176:179]
    v_mfma_f32_16x16x32_bf16 v[180:183], v[60:63], v[100:103], v[180:183]
    v_mfma_f32_16x16x32_bf16 v[184:187], v[60:63], v[104:107], v[184:187]
    v_mfma_f32_16x16x32_bf16 v[188:191], v[60:63], v[108:111], v[188:191]
    s_add_u32 s93, s90, 78848
    buffer_load_dwordx4 v[60:63], v2, s[8:11], s93 offen
    s_waitcnt vmcnt(19)
    v_mfma_f32_16x16x32_bf16 v[192:195], v[64:67], v[96:99], v[192:195]
    v_mfma_f32_16x16x32_bf16 v[196:199], v[64:67], v[100:103], v[196:199]
    v_mfma_f32_16x16x32_bf16 v[200:203], v[64:67], v[104:107], v[200:203]
    v_mfma_f32_16x16x32_bf16 v[204:207], v[64:67], v[108:111], v[204:207]
    s_add_u32 s93, s90, 97280
    buffer_load_dwordx4 v[64:67], v2, s[8:11], s93 offen
    s_waitcnt vmcnt(19)
    v_mfma_f32_16x16x32_bf16 v[208:211], v[68:71], v[96:99], v[208:211]
    v_mfma_f32_16x16x32_bf16 v[212:215], v[68:71], v[100:103], v[212:215]
    v_mfma_f32_16x16x32_bf16 v[216:219], v[68:71], v[104:107], v[216:219]
    v_mfma_f32_16x16x32_bf16 v[220:223], v[68:71], v[108:111], v[220:223]
    s_add_u32 s93, s90, 115712
    buffer_load_dwordx4 v[68:71], v2, s[8:11], s93 offen
    s_waitcnt vmcnt(19)
    v_mfma_f32_16x16x32_bf16 v[224:227], v[72:75], v[96:99], v[224:227]
    v_mfma_f32_16x16x32_bf16 v[228:231], v[72:75], v[100:103], v[228:231]
    v_mfma_f32_16x16x32_bf16 v[232:235], v[72:75], v[104:107], v[232:235]
    v_mfma_f32_16x16x32_bf16 v[236:239], v[72:75], v[108:111], v[236:239]
    s_add_u32 s93, s90, 134144
    buffer_load_dwordx4 v[72:75], v2, s[8:11], s93 offen
    s_waitcnt vmcnt(19)
    v_mfma_f32_16x16x32_bf16 v[240:243], v[76:79], v[96:99], v[240:243]
    v_mfma_f32_16x16x32_bf16 v[244:247], v[76:79], v[100:103], v[244:247]
    v_mfma_f32_16x16x32_bf16 v[248:251], v[76:79], v[104:107], v[248:251]
    v_mfma_f32_16x16x32_bf16 v[252:255], v[76:79], v[108:111], v[252:255]
    s_add_u32 s93, s90, 152576
    buffer_load_dwordx4 v[76:79], v2, s[8:11], s93 offen
    s_waitcnt vmcnt(19) lgkmcnt(0)
    s_barrier
    ds_read_b128 v[96:99], v2 offset:5120
    ds_read_b128 v[100:103], v2 offset:23552
    ds_read_b128 v[104:107], v3 offset:5120
    ds_read_b128 v[108:111], v3 offset:23552
    s_add_u32 m0, s62, 7168
    s_add_u32 s93, s59, 7168
    buffer_load_dwordx4 v2, s[4:7], s93 offen lds
    s_waitcnt vmcnt(19)
    v_mfma_f32_16x16x32_bf16 v[112:115], v[8:11], v[80:83], v[112:115]
    v_mfma_f32_16x16x32_bf16 v[116:119], v[8:11], v[84:87], v[116:119]
    v_mfma_f32_16x16x32_bf16 v[120:123], v[8:11], v[88:91], v[120:123]
    v_mfma_f32_16x16x32_bf16 v[124:127], v[8:11], v[92:95], v[124:127]
    s_add_u32 s93, s90, 6144
    buffer_load_dwordx4 v[8:11], v2, s[8:11], s93 offen
    s_waitcnt vmcnt(19)
    v_mfma_f32_16x16x32_bf16 v[128:131], v[12:15], v[80:83], v[128:131]
    v_mfma_f32_16x16x32_bf16 v[132:135], v[12:15], v[84:87], v[132:135]
    v_mfma_f32_16x16x32_bf16 v[136:139], v[12:15], v[88:91], v[136:139]
    v_mfma_f32_16x16x32_bf16 v[140:143], v[12:15], v[92:95], v[140:143]
    s_add_u32 s93, s90, 24576
    buffer_load_dwordx4 v[12:15], v2, s[8:11], s93 offen
    s_waitcnt vmcnt(19)
    v_mfma_f32_16x16x32_bf16 v[144:147], v[16:19], v[80:83], v[144:147]
    v_mfma_f32_16x16x32_bf16 v[148:151], v[16:19], v[84:87], v[148:151]
    v_mfma_f32_16x16x32_bf16 v[152:155], v[16:19], v[88:91], v[152:155]
    v_mfma_f32_16x16x32_bf16 v[156:159], v[16:19], v[92:95], v[156:159]
    s_add_u32 s93, s90, 43008
    buffer_load_dwordx4 v[16:19], v2, s[8:11], s93 offen
    s_waitcnt vmcnt(19)
    v_mfma_f32_16x16x32_bf16 v[160:163], v[20:23], v[80:83], v[160:163]
    v_mfma_f32_16x16x32_bf16 v[164:167], v[20:23], v[84:87], v[164:167]
    v_mfma_f32_16x16x32_bf16 v[168:171], v[20:23], v[88:91], v[168:171]
    v_mfma_f32_16x16x32_bf16 v[172:175], v[20:23], v[92:95], v[172:175]
    s_add_u32 s93, s90, 61440
    buffer_load_dwordx4 v[20:23], v2, s[8:11], s93 offen
    s_waitcnt vmcnt(19)
    v_mfma_f32_16x16x32_bf16 v[176:179], v[24:27], v[80:83], v[176:179]
    v_mfma_f32_16x16x32_bf16 v[180:183], v[24:27], v[84:87], v[180:183]
    v_mfma_f32_16x16x32_bf16 v[184:187], v[24:27], v[88:91], v[184:187]
    v_mfma_f32_16x16x32_bf16 v[188:191], v[24:27], v[92:95], v[188:191]
    s_add_u32 s93, s90, 79872
    buffer_load_dwordx4 v[24:27], v2, s[8:11], s93 offen
    s_waitcnt vmcnt(19)
    v_mfma_f32_16x16x32_bf16 v[192:195], v[28:31], v[80:83], v[192:195]
    v_mfma_f32_16x16x32_bf16 v[196:199], v[28:31], v[84:87], v[196:199]
    v_mfma_f32_16x16x32_bf16 v[200:203], v[28:31], v[88:91], v[200:203]
    v_mfma_f32_16x16x32_bf16 v[204:207], v[28:31], v[92:95], v[204:207]
    s_add_u32 s93, s90, 98304
    buffer_load_dwordx4 v[28:31], v2, s[8:11], s93 offen
    s_waitcnt vmcnt(19)
    v_mfma_f32_16x16x32_bf16 v[208:211], v[32:35], v[80:83], v[208:211]
    v_mfma_f32_16x16x32_bf16 v[212:215], v[32:35], v[84:87], v[212:215]
    v_mfma_f32_16x16x32_bf16 v[216:219], v[32:35], v[88:91], v[216:219]
    v_mfma_f32_16x16x32_bf16 v[220:223], v[32:35], v[92:95], v[220:223]
    s_add_u32 s93, s90, 116736
    buffer_load_dwordx4 v[32:35], v2, s[8:11], s93 offen
    s_waitcnt vmcnt(19)
    v_mfma_f32_16x16x32_bf16 v[224:227], v[36:39], v[80:83], v[224:227]
    v_mfma_f32_16x16x32_bf16 v[228:231], v[36:39], v[84:87], v[228:231]
    v_mfma_f32_16x16x32_bf16 v[232:235], v[36:39], v[88:91], v[232:235]
    v_mfma_f32_16x16x32_bf16 v[236:239], v[36:39], v[92:95], v[236:239]
    s_add_u32 s93, s90, 135168
    buffer_load_dwordx4 v[36:39], v2, s[8:11], s93 offen
    s_waitcnt vmcnt(19)
    v_mfma_f32_16x16x32_bf16 v[240:243], v[40:43], v[80:83], v[240:243]
    v_mfma_f32_16x16x32_bf16 v[244:247], v[40:43], v[84:87], v[244:247]
    v_mfma_f32_16x16x32_bf16 v[248:251], v[40:43], v[88:91], v[248:251]
    v_mfma_f32_16x16x32_bf16 v[252:255], v[40:43], v[92:95], v[252:255]
    s_add_u32 s93, s90, 153600
    buffer_load_dwordx4 v[40:43], v2, s[8:11], s93 offen
    s_waitcnt vmcnt(19) lgkmcnt(0)
    s_barrier
    ds_read_b128 v[80:83], v2 offset:6144
    ds_read_b128 v[84:87], v2 offset:24576
    ds_read_b128 v[88:91], v3 offset:6144
    ds_read_b128 v[92:95], v3 offset:24576
    s_add_u32 m0, s62, 8192
    s_add_u32 s93, s59, 8192
    buffer_load_dwordx4 v2, s[4:7], s93 offen lds
    s_waitcnt vmcnt(19)
    v_mfma_f32_16x16x32_bf16 v[112:115], v[44:47], v[96:99], v[112:115]
    v_mfma_f32_16x16x32_bf16 v[116:119], v[44:47], v[100:103], v[116:119]
    v_mfma_f32_16x16x32_bf16 v[120:123], v[44:47], v[104:107], v[120:123]
    v_mfma_f32_16x16x32_bf16 v[124:127], v[44:47], v[108:111], v[124:127]
    s_add_u32 s93, s90, 7168
    buffer_load_dwordx4 v[44:47], v2, s[8:11], s93 offen
    s_waitcnt vmcnt(19)
    v_mfma_f32_16x16x32_bf16 v[128:131], v[48:51], v[96:99], v[128:131]
    v_mfma_f32_16x16x32_bf16 v[132:135], v[48:51], v[100:103], v[132:135]
    v_mfma_f32_16x16x32_bf16 v[136:139], v[48:51], v[104:107], v[136:139]
    v_mfma_f32_16x16x32_bf16 v[140:143], v[48:51], v[108:111], v[140:143]
    s_add_u32 s93, s90, 25600
    buffer_load_dwordx4 v[48:51], v2, s[8:11], s93 offen
    s_waitcnt vmcnt(19)
    v_mfma_f32_16x16x32_bf16 v[144:147], v[52:55], v[96:99], v[144:147]
    v_mfma_f32_16x16x32_bf16 v[148:151], v[52:55], v[100:103], v[148:151]
    v_mfma_f32_16x16x32_bf16 v[152:155], v[52:55], v[104:107], v[152:155]
    v_mfma_f32_16x16x32_bf16 v[156:159], v[52:55], v[108:111], v[156:159]
    s_add_u32 s93, s90, 44032
    buffer_load_dwordx4 v[52:55], v2, s[8:11], s93 offen
    s_waitcnt vmcnt(19)
    v_mfma_f32_16x16x32_bf16 v[160:163], v[56:59], v[96:99], v[160:163]
    v_mfma_f32_16x16x32_bf16 v[164:167], v[56:59], v[100:103], v[164:167]
    v_mfma_f32_16x16x32_bf16 v[168:171], v[56:59], v[104:107], v[168:171]
    v_mfma_f32_16x16x32_bf16 v[172:175], v[56:59], v[108:111], v[172:175]
    s_add_u32 s93, s90, 62464
    buffer_load_dwordx4 v[56:59], v2, s[8:11], s93 offen
    s_waitcnt vmcnt(19)
    v_mfma_f32_16x16x32_bf16 v[176:179], v[60:63], v[96:99], v[176:179]
    v_mfma_f32_16x16x32_bf16 v[180:183], v[60:63], v[100:103], v[180:183]
    v_mfma_f32_16x16x32_bf16 v[184:187], v[60:63], v[104:107], v[184:187]
    v_mfma_f32_16x16x32_bf16 v[188:191], v[60:63], v[108:111], v[188:191]
    s_add_u32 s93, s90, 80896
    buffer_load_dwordx4 v[60:63], v2, s[8:11], s93 offen
    s_waitcnt vmcnt(19)
    v_mfma_f32_16x16x32_bf16 v[192:195], v[64:67], v[96:99], v[192:195]
    v_mfma_f32_16x16x32_bf16 v[196:199], v[64:67], v[100:103], v[196:199]
    v_mfma_f32_16x16x32_bf16 v[200:203], v[64:67], v[104:107], v[200:203]
    v_mfma_f32_16x16x32_bf16 v[204:207], v[64:67], v[108:111], v[204:207]
    s_add_u32 s93, s90, 99328
    buffer_load_dwordx4 v[64:67], v2, s[8:11], s93 offen
    s_waitcnt vmcnt(19)
    v_mfma_f32_16x16x32_bf16 v[208:211], v[68:71], v[96:99], v[208:211]
    v_mfma_f32_16x16x32_bf16 v[212:215], v[68:71], v[100:103], v[212:215]
    v_mfma_f32_16x16x32_bf16 v[216:219], v[68:71], v[104:107], v[216:219]
    v_mfma_f32_16x16x32_bf16 v[220:223], v[68:71], v[108:111], v[220:223]
    s_add_u32 s93, s90, 117760
    buffer_load_dwordx4 v[68:71], v2, s[8:11], s93 offen
    s_waitcnt vmcnt(19)
    v_mfma_f32_16x16x32_bf16 v[224:227], v[72:75], v[96:99], v[224:227]
    v_mfma_f32_16x16x32_bf16 v[228:231], v[72:75], v[100:103], v[228:231]
    v_mfma_f32_16x16x32_bf16 v[232:235], v[72:75], v[104:107], v[232:235]
    v_mfma_f32_16x16x32_bf16 v[236:239], v[72:75], v[108:111], v[236:239]
    s_add_u32 s93, s90, 136192
    buffer_load_dwordx4 v[72:75], v2, s[8:11], s93 offen
    s_waitcnt vmcnt(19)
    v_mfma_f32_16x16x32_bf16 v[240:243], v[76:79], v[96:99], v[240:243]
    v_mfma_f32_16x16x32_bf16 v[244:247], v[76:79], v[100:103], v[244:247]
    v_mfma_f32_16x16x32_bf16 v[248:251], v[76:79], v[104:107], v[248:251]
    v_mfma_f32_16x16x32_bf16 v[252:255], v[76:79], v[108:111], v[252:255]
    s_add_u32 s93, s90, 154624
    buffer_load_dwordx4 v[76:79], v2, s[8:11], s93 offen
    s_waitcnt vmcnt(19) lgkmcnt(0)
    s_barrier
    ds_read_b128 v[96:99], v2 offset:7168
    ds_read_b128 v[100:103], v2 offset:25600
    ds_read_b128 v[104:107], v3 offset:7168
    ds_read_b128 v[108:111], v3 offset:25600
    s_add_u32 m0, s62, 9216
    s_add_u32 s93, s59, 9216
    buffer_load_dwordx4 v2, s[4:7], s93 offen lds
    s_waitcnt vmcnt(19)
    v_mfma_f32_16x16x32_bf16 v[112:115], v[8:11], v[80:83], v[112:115]
    v_mfma_f32_16x16x32_bf16 v[116:119], v[8:11], v[84:87], v[116:119]
    v_mfma_f32_16x16x32_bf16 v[120:123], v[8:11], v[88:91], v[120:123]
    v_mfma_f32_16x16x32_bf16 v[124:127], v[8:11], v[92:95], v[124:127]
    s_add_u32 s93, s90, 8192
    buffer_load_dwordx4 v[8:11], v2, s[8:11], s93 offen
    s_waitcnt vmcnt(19)
    v_mfma_f32_16x16x32_bf16 v[128:131], v[12:15], v[80:83], v[128:131]
    v_mfma_f32_16x16x32_bf16 v[132:135], v[12:15], v[84:87], v[132:135]
    v_mfma_f32_16x16x32_bf16 v[136:139], v[12:15], v[88:91], v[136:139]
    v_mfma_f32_16x16x32_bf16 v[140:143], v[12:15], v[92:95], v[140:143]
    s_add_u32 s93, s90, 26624
    buffer_load_dwordx4 v[12:15], v2, s[8:11], s93 offen
    s_waitcnt vmcnt(19)
    v_mfma_f32_16x16x32_bf16 v[144:147], v[16:19], v[80:83], v[144:147]
    v_mfma_f32_16x16x32_bf16 v[148:151], v[16:19], v[84:87], v[148:151]
    v_mfma_f32_16x16x32_bf16 v[152:155], v[16:19], v[88:91], v[152:155]
    v_mfma_f32_16x16x32_bf16 v[156:159], v[16:19], v[92:95], v[156:159]
    s_add_u32 s93, s90, 45056
    buffer_load_dwordx4 v[16:19], v2, s[8:11], s93 offen
    s_waitcnt vmcnt(19)
    v_mfma_f32_16x16x32_bf16 v[160:163], v[20:23], v[80:83], v[160:163]
    v_mfma_f32_16x16x32_bf16 v[164:167], v[20:23], v[84:87], v[164:167]
    v_mfma_f32_16x16x32_bf16 v[168:171], v[20:23], v[88:91], v[168:171]
    v_mfma_f32_16x16x32_bf16 v[172:175], v[20:23], v[92:95], v[172:175]
    s_add_u32 s93, s90, 63488
    buffer_load_dwordx4 v[20:23], v2, s[8:11], s93 offen
    s_waitcnt vmcnt(19)
    v_mfma_f32_16x16x32_bf16 v[176:179], v[24:27], v[80:83], v[176:179]
    v_mfma_f32_16x16x32_bf16 v[180:183], v[24:27], v[84:87], v[180:183]
    v_mfma_f32_16x16x32_bf16 v[184:187], v[24:27], v[88:91], v[184:187]
    v_mfma_f32_16x16x32_bf16 v[188:191], v[24:27], v[92:95], v[188:191]
    s_add_u32 s93, s90, 81920
    buffer_load_dwordx4 v[24:27], v2, s[8:11], s93 offen
    s_waitcnt vmcnt(19)
    v_mfma_f32_16x16x32_bf16 v[192:195], v[28:31], v[80:83], v[192:195]
    v_mfma_f32_16x16x32_bf16 v[196:199], v[28:31], v[84:87], v[196:199]
    v_mfma_f32_16x16x32_bf16 v[200:203], v[28:31], v[88:91], v[200:203]
    v_mfma_f32_16x16x32_bf16 v[204:207], v[28:31], v[92:95], v[204:207]
    s_add_u32 s93, s90, 100352
    buffer_load_dwordx4 v[28:31], v2, s[8:11], s93 offen
    s_waitcnt vmcnt(19)
    v_mfma_f32_16x16x32_bf16 v[208:211], v[32:35], v[80:83], v[208:211]
    v_mfma_f32_16x16x32_bf16 v[212:215], v[32:35], v[84:87], v[212:215]
    v_mfma_f32_16x16x32_bf16 v[216:219], v[32:35], v[88:91], v[216:219]
    v_mfma_f32_16x16x32_bf16 v[220:223], v[32:35], v[92:95], v[220:223]
    s_add_u32 s93, s90, 118784
    buffer_load_dwordx4 v[32:35], v2, s[8:11], s93 offen
    s_waitcnt vmcnt(19)
    v_mfma_f32_16x16x32_bf16 v[224:227], v[36:39], v[80:83], v[224:227]
    v_mfma_f32_16x16x32_bf16 v[228:231], v[36:39], v[84:87], v[228:231]
    v_mfma_f32_16x16x32_bf16 v[232:235], v[36:39], v[88:91], v[232:235]
    v_mfma_f32_16x16x32_bf16 v[236:239], v[36:39], v[92:95], v[236:239]
    s_add_u32 s93, s90, 137216
    buffer_load_dwordx4 v[36:39], v2, s[8:11], s93 offen
    s_waitcnt vmcnt(19)
    v_mfma_f32_16x16x32_bf16 v[240:243], v[40:43], v[80:83], v[240:243]
    v_mfma_f32_16x16x32_bf16 v[244:247], v[40:43], v[84:87], v[244:247]
    v_mfma_f32_16x16x32_bf16 v[248:251], v[40:43], v[88:91], v[248:251]
    v_mfma_f32_16x16x32_bf16 v[252:255], v[40:43], v[92:95], v[252:255]
    s_add_u32 s93, s90, 155648
    buffer_load_dwordx4 v[40:43], v2, s[8:11], s93 offen
    s_waitcnt vmcnt(19) lgkmcnt(0)
    s_barrier
    ds_read_b128 v[80:83], v2 offset:8192
    ds_read_b128 v[84:87], v2 offset:26624
    ds_read_b128 v[88:91], v3 offset:8192
    ds_read_b128 v[92:95], v3 offset:26624
    s_add_u32 m0, s62, 10240
    s_add_u32 s93, s59, 10240
    buffer_load_dwordx4 v2, s[4:7], s93 offen lds
    s_waitcnt vmcnt(19)
    v_mfma_f32_16x16x32_bf16 v[112:115], v[44:47], v[96:99], v[112:115]
    v_mfma_f32_16x16x32_bf16 v[116:119], v[44:47], v[100:103], v[116:119]
    v_mfma_f32_16x16x32_bf16 v[120:123], v[44:47], v[104:107], v[120:123]
    v_mfma_f32_16x16x32_bf16 v[124:127], v[44:47], v[108:111], v[124:127]
    s_add_u32 s93, s90, 9216
    buffer_load_dwordx4 v[44:47], v2, s[8:11], s93 offen
    s_waitcnt vmcnt(19)
    v_mfma_f32_16x16x32_bf16 v[128:131], v[48:51], v[96:99], v[128:131]
    v_mfma_f32_16x16x32_bf16 v[132:135], v[48:51], v[100:103], v[132:135]
    v_mfma_f32_16x16x32_bf16 v[136:139], v[48:51], v[104:107], v[136:139]
    v_mfma_f32_16x16x32_bf16 v[140:143], v[48:51], v[108:111], v[140:143]
    s_add_u32 s93, s90, 27648
    buffer_load_dwordx4 v[48:51], v2, s[8:11], s93 offen
    s_waitcnt vmcnt(19)
    v_mfma_f32_16x16x32_bf16 v[144:147], v[52:55], v[96:99], v[144:147]
    v_mfma_f32_16x16x32_bf16 v[148:151], v[52:55], v[100:103], v[148:151]
    v_mfma_f32_16x16x32_bf16 v[152:155], v[52:55], v[104:107], v[152:155]
    v_mfma_f32_16x16x32_bf16 v[156:159], v[52:55], v[108:111], v[156:159]
    s_add_u32 s93, s90, 46080
    buffer_load_dwordx4 v[52:55], v2, s[8:11], s93 offen
    s_waitcnt vmcnt(19)
    v_mfma_f32_16x16x32_bf16 v[160:163], v[56:59], v[96:99], v[160:163]
    v_mfma_f32_16x16x32_bf16 v[164:167], v[56:59], v[100:103], v[164:167]
    v_mfma_f32_16x16x32_bf16 v[168:171], v[56:59], v[104:107], v[168:171]
    v_mfma_f32_16x16x32_bf16 v[172:175], v[56:59], v[108:111], v[172:175]
    s_add_u32 s93, s90, 64512
    buffer_load_dwordx4 v[56:59], v2, s[8:11], s93 offen
    s_waitcnt vmcnt(19)
    v_mfma_f32_16x16x32_bf16 v[176:179], v[60:63], v[96:99], v[176:179]
    v_mfma_f32_16x16x32_bf16 v[180:183], v[60:63], v[100:103], v[180:183]
    v_mfma_f32_16x16x32_bf16 v[184:187], v[60:63], v[104:107], v[184:187]
    v_mfma_f32_16x16x32_bf16 v[188:191], v[60:63], v[108:111], v[188:191]
    s_add_u32 s93, s90, 82944
    buffer_load_dwordx4 v[60:63], v2, s[8:11], s93 offen
    s_waitcnt vmcnt(19)
    v_mfma_f32_16x16x32_bf16 v[192:195], v[64:67], v[96:99], v[192:195]
    v_mfma_f32_16x16x32_bf16 v[196:199], v[64:67], v[100:103], v[196:199]
    v_mfma_f32_16x16x32_bf16 v[200:203], v[64:67], v[104:107], v[200:203]
    v_mfma_f32_16x16x32_bf16 v[204:207], v[64:67], v[108:111], v[204:207]
    s_add_u32 s93, s90, 101376
    buffer_load_dwordx4 v[64:67], v2, s[8:11], s93 offen
    s_waitcnt vmcnt(19)
    v_mfma_f32_16x16x32_bf16 v[208:211], v[68:71], v[96:99], v[208:211]
    v_mfma_f32_16x16x32_bf16 v[212:215], v[68:71], v[100:103], v[212:215]
    v_mfma_f32_16x16x32_bf16 v[216:219], v[68:71], v[104:107], v[216:219]
    v_mfma_f32_16x16x32_bf16 v[220:223], v[68:71], v[108:111], v[220:223]
    s_add_u32 s93, s90, 119808
    buffer_load_dwordx4 v[68:71], v2, s[8:11], s93 offen
    s_waitcnt vmcnt(19)
    v_mfma_f32_16x16x32_bf16 v[224:227], v[72:75], v[96:99], v[224:227]
    v_mfma_f32_16x16x32_bf16 v[228:231], v[72:75], v[100:103], v[228:231]
    v_mfma_f32_16x16x32_bf16 v[232:235], v[72:75], v[104:107], v[232:235]
    v_mfma_f32_16x16x32_bf16 v[236:239], v[72:75], v[108:111], v[236:239]
    s_add_u32 s93, s90, 138240
    buffer_load_dwordx4 v[72:75], v2, s[8:11], s93 offen
    s_waitcnt vmcnt(19)
    v_mfma_f32_16x16x32_bf16 v[240:243], v[76:79], v[96:99], v[240:243]
    v_mfma_f32_16x16x32_bf16 v[244:247], v[76:79], v[100:103], v[244:247]
    v_mfma_f32_16x16x32_bf16 v[248:251], v[76:79], v[104:107], v[248:251]
    v_mfma_f32_16x16x32_bf16 v[252:255], v[76:79], v[108:111], v[252:255]
    s_add_u32 s93, s90, 156672
    buffer_load_dwordx4 v[76:79], v2, s[8:11], s93 offen
    s_waitcnt vmcnt(19) lgkmcnt(0)
    s_barrier
    ds_read_b128 v[96:99], v2 offset:9216
    ds_read_b128 v[100:103], v2 offset:27648
    ds_read_b128 v[104:107], v3 offset:9216
    ds_read_b128 v[108:111], v3 offset:27648
    s_add_u32 m0, s62, 11264
    s_add_u32 s93, s59, 11264
    buffer_load_dwordx4 v2, s[4:7], s93 offen lds
    s_waitcnt vmcnt(19)
    v_mfma_f32_16x16x32_bf16 v[112:115], v[8:11], v[80:83], v[112:115]
    v_mfma_f32_16x16x32_bf16 v[116:119], v[8:11], v[84:87], v[116:119]
    v_mfma_f32_16x16x32_bf16 v[120:123], v[8:11], v[88:91], v[120:123]
    v_mfma_f32_16x16x32_bf16 v[124:127], v[8:11], v[92:95], v[124:127]
    s_add_u32 s93, s90, 10240
    buffer_load_dwordx4 v[8:11], v2, s[8:11], s93 offen
    s_waitcnt vmcnt(19)
    v_mfma_f32_16x16x32_bf16 v[128:131], v[12:15], v[80:83], v[128:131]
    v_mfma_f32_16x16x32_bf16 v[132:135], v[12:15], v[84:87], v[132:135]
    v_mfma_f32_16x16x32_bf16 v[136:139], v[12:15], v[88:91], v[136:139]
    v_mfma_f32_16x16x32_bf16 v[140:143], v[12:15], v[92:95], v[140:143]
    s_add_u32 s93, s90, 28672
    buffer_load_dwordx4 v[12:15], v2, s[8:11], s93 offen
    s_waitcnt vmcnt(19)
    v_mfma_f32_16x16x32_bf16 v[144:147], v[16:19], v[80:83], v[144:147]
    v_mfma_f32_16x16x32_bf16 v[148:151], v[16:19], v[84:87], v[148:151]
    v_mfma_f32_16x16x32_bf16 v[152:155], v[16:19], v[88:91], v[152:155]
    v_mfma_f32_16x16x32_bf16 v[156:159], v[16:19], v[92:95], v[156:159]
    s_add_u32 s93, s90, 47104
    buffer_load_dwordx4 v[16:19], v2, s[8:11], s93 offen
    s_waitcnt vmcnt(19)
    v_mfma_f32_16x16x32_bf16 v[160:163], v[20:23], v[80:83], v[160:163]
    v_mfma_f32_16x16x32_bf16 v[164:167], v[20:23], v[84:87], v[164:167]
    v_mfma_f32_16x16x32_bf16 v[168:171], v[20:23], v[88:91], v[168:171]
    v_mfma_f32_16x16x32_bf16 v[172:175], v[20:23], v[92:95], v[172:175]
    s_add_u32 s93, s90, 65536
    buffer_load_dwordx4 v[20:23], v2, s[8:11], s93 offen
    s_waitcnt vmcnt(19)
    v_mfma_f32_16x16x32_bf16 v[176:179], v[24:27], v[80:83], v[176:179]
    v_mfma_f32_16x16x32_bf16 v[180:183], v[24:27], v[84:87], v[180:183]
    v_mfma_f32_16x16x32_bf16 v[184:187], v[24:27], v[88:91], v[184:187]
    v_mfma_f32_16x16x32_bf16 v[188:191], v[24:27], v[92:95], v[188:191]
    s_add_u32 s93, s90, 83968
    buffer_load_dwordx4 v[24:27], v2, s[8:11], s93 offen
    s_waitcnt vmcnt(19)
    v_mfma_f32_16x16x32_bf16 v[192:195], v[28:31], v[80:83], v[192:195]
    v_mfma_f32_16x16x32_bf16 v[196:199], v[28:31], v[84:87], v[196:199]
    v_mfma_f32_16x16x32_bf16 v[200:203], v[28:31], v[88:91], v[200:203]
    v_mfma_f32_16x16x32_bf16 v[204:207], v[28:31], v[92:95], v[204:207]
    s_add_u32 s93, s90, 102400
    buffer_load_dwordx4 v[28:31], v2, s[8:11], s93 offen
    s_waitcnt vmcnt(19)
    v_mfma_f32_16x16x32_bf16 v[208:211], v[32:35], v[80:83], v[208:211]
    v_mfma_f32_16x16x32_bf16 v[212:215], v[32:35], v[84:87], v[212:215]
    v_mfma_f32_16x16x32_bf16 v[216:219], v[32:35], v[88:91], v[216:219]
    v_mfma_f32_16x16x32_bf16 v[220:223], v[32:35], v[92:95], v[220:223]
    s_add_u32 s93, s90, 120832
    buffer_load_dwordx4 v[32:35], v2, s[8:11], s93 offen
    s_waitcnt vmcnt(19)
    v_mfma_f32_16x16x32_bf16 v[224:227], v[36:39], v[80:83], v[224:227]
    v_mfma_f32_16x16x32_bf16 v[228:231], v[36:39], v[84:87], v[228:231]
    v_mfma_f32_16x16x32_bf16 v[232:235], v[36:39], v[88:91], v[232:235]
    v_mfma_f32_16x16x32_bf16 v[236:239], v[36:39], v[92:95], v[236:239]
    s_add_u32 s93, s90, 139264
    buffer_load_dwordx4 v[36:39], v2, s[8:11], s93 offen
    s_waitcnt vmcnt(19)
    v_mfma_f32_16x16x32_bf16 v[240:243], v[40:43], v[80:83], v[240:243]
    v_mfma_f32_16x16x32_bf16 v[244:247], v[40:43], v[84:87], v[244:247]
    v_mfma_f32_16x16x32_bf16 v[248:251], v[40:43], v[88:91], v[248:251]
    v_mfma_f32_16x16x32_bf16 v[252:255], v[40:43], v[92:95], v[252:255]
    s_add_u32 s93, s90, 157696
    buffer_load_dwordx4 v[40:43], v2, s[8:11], s93 offen
    s_waitcnt vmcnt(19) lgkmcnt(0)
    s_barrier
    ds_read_b128 v[80:83], v2 offset:10240
    ds_read_b128 v[84:87], v2 offset:28672
    ds_read_b128 v[88:91], v3 offset:10240
    ds_read_b128 v[92:95], v3 offset:28672
    s_add_u32 m0, s62, 12288
    s_add_u32 s93, s59, 12288
    buffer_load_dwordx4 v2, s[4:7], s93 offen lds
    s_waitcnt vmcnt(19)
    v_mfma_f32_16x16x32_bf16 v[112:115], v[44:47], v[96:99], v[112:115]
    v_mfma_f32_16x16x32_bf16 v[116:119], v[44:47], v[100:103], v[116:119]
    v_mfma_f32_16x16x32_bf16 v[120:123], v[44:47], v[104:107], v[120:123]
    v_mfma_f32_16x16x32_bf16 v[124:127], v[44:47], v[108:111], v[124:127]
    s_add_u32 s93, s90, 11264
    buffer_load_dwordx4 v[44:47], v2, s[8:11], s93 offen
    s_waitcnt vmcnt(19)
    v_mfma_f32_16x16x32_bf16 v[128:131], v[48:51], v[96:99], v[128:131]
    v_mfma_f32_16x16x32_bf16 v[132:135], v[48:51], v[100:103], v[132:135]
    v_mfma_f32_16x16x32_bf16 v[136:139], v[48:51], v[104:107], v[136:139]
    v_mfma_f32_16x16x32_bf16 v[140:143], v[48:51], v[108:111], v[140:143]
    s_add_u32 s93, s90, 29696
    buffer_load_dwordx4 v[48:51], v2, s[8:11], s93 offen
    s_waitcnt vmcnt(19)
    v_mfma_f32_16x16x32_bf16 v[144:147], v[52:55], v[96:99], v[144:147]
    v_mfma_f32_16x16x32_bf16 v[148:151], v[52:55], v[100:103], v[148:151]
    v_mfma_f32_16x16x32_bf16 v[152:155], v[52:55], v[104:107], v[152:155]
    v_mfma_f32_16x16x32_bf16 v[156:159], v[52:55], v[108:111], v[156:159]
    s_add_u32 s93, s90, 48128
    buffer_load_dwordx4 v[52:55], v2, s[8:11], s93 offen
    s_waitcnt vmcnt(19)
    v_mfma_f32_16x16x32_bf16 v[160:163], v[56:59], v[96:99], v[160:163]
    v_mfma_f32_16x16x32_bf16 v[164:167], v[56:59], v[100:103], v[164:167]
    v_mfma_f32_16x16x32_bf16 v[168:171], v[56:59], v[104:107], v[168:171]
    v_mfma_f32_16x16x32_bf16 v[172:175], v[56:59], v[108:111], v[172:175]
    s_add_u32 s93, s90, 66560
    buffer_load_dwordx4 v[56:59], v2, s[8:11], s93 offen
    s_waitcnt vmcnt(19)
    v_mfma_f32_16x16x32_bf16 v[176:179], v[60:63], v[96:99], v[176:179]
    v_mfma_f32_16x16x32_bf16 v[180:183], v[60:63], v[100:103], v[180:183]
    v_mfma_f32_16x16x32_bf16 v[184:187], v[60:63], v[104:107], v[184:187]
    v_mfma_f32_16x16x32_bf16 v[188:191], v[60:63], v[108:111], v[188:191]
    s_add_u32 s93, s90, 84992
    buffer_load_dwordx4 v[60:63], v2, s[8:11], s93 offen
    s_waitcnt vmcnt(19)
    v_mfma_f32_16x16x32_bf16 v[192:195], v[64:67], v[96:99], v[192:195]
    v_mfma_f32_16x16x32_bf16 v[196:199], v[64:67], v[100:103], v[196:199]
    v_mfma_f32_16x16x32_bf16 v[200:203], v[64:67], v[104:107], v[200:203]
    v_mfma_f32_16x16x32_bf16 v[204:207], v[64:67], v[108:111], v[204:207]
    s_add_u32 s93, s90, 103424
    buffer_load_dwordx4 v[64:67], v2, s[8:11], s93 offen
    s_waitcnt vmcnt(19)
    v_mfma_f32_16x16x32_bf16 v[208:211], v[68:71], v[96:99], v[208:211]
    v_mfma_f32_16x16x32_bf16 v[212:215], v[68:71], v[100:103], v[212:215]
    v_mfma_f32_16x16x32_bf16 v[216:219], v[68:71], v[104:107], v[216:219]
    v_mfma_f32_16x16x32_bf16 v[220:223], v[68:71], v[108:111], v[220:223]
    s_add_u32 s93, s90, 121856
    buffer_load_dwordx4 v[68:71], v2, s[8:11], s93 offen
    s_waitcnt vmcnt(19)
    v_mfma_f32_16x16x32_bf16 v[224:227], v[72:75], v[96:99], v[224:227]
    v_mfma_f32_16x16x32_bf16 v[228:231], v[72:75], v[100:103], v[228:231]
    v_mfma_f32_16x16x32_bf16 v[232:235], v[72:75], v[104:107], v[232:235]
    v_mfma_f32_16x16x32_bf16 v[236:239], v[72:75], v[108:111], v[236:239]
    s_add_u32 s93, s90, 140288
    buffer_load_dwordx4 v[72:75], v2, s[8:11], s93 offen
    s_waitcnt vmcnt(19)
    v_mfma_f32_16x16x32_bf16 v[240:243], v[76:79], v[96:99], v[240:243]
    v_mfma_f32_16x16x32_bf16 v[244:247], v[76:79], v[100:103], v[244:247]
    v_mfma_f32_16x16x32_bf16 v[248:251], v[76:79], v[104:107], v[248:251]
    v_mfma_f32_16x16x32_bf16 v[252:255], v[76:79], v[108:111], v[252:255]
    s_add_u32 s93, s90, 158720
    buffer_load_dwordx4 v[76:79], v2, s[8:11], s93 offen
    s_waitcnt vmcnt(19) lgkmcnt(0)
    s_barrier
    ds_read_b128 v[96:99], v2 offset:11264
    ds_read_b128 v[100:103], v2 offset:29696
    ds_read_b128 v[104:107], v3 offset:11264
    ds_read_b128 v[108:111], v3 offset:29696
    s_add_u32 m0, s62, 13312
    s_add_u32 s93, s59, 13312
    buffer_load_dwordx4 v2, s[4:7], s93 offen lds
    s_waitcnt vmcnt(19)
    v_mfma_f32_16x16x32_bf16 v[112:115], v[8:11], v[80:83], v[112:115]
    v_mfma_f32_16x16x32_bf16 v[116:119], v[8:11], v[84:87], v[116:119]
    v_mfma_f32_16x16x32_bf16 v[120:123], v[8:11], v[88:91], v[120:123]
    v_mfma_f32_16x16x32_bf16 v[124:127], v[8:11], v[92:95], v[124:127]
    s_add_u32 s93, s90, 12288
    buffer_load_dwordx4 v[8:11], v2, s[8:11], s93 offen
    s_waitcnt vmcnt(19)
    v_mfma_f32_16x16x32_bf16 v[128:131], v[12:15], v[80:83], v[128:131]
    v_mfma_f32_16x16x32_bf16 v[132:135], v[12:15], v[84:87], v[132:135]
    v_mfma_f32_16x16x32_bf16 v[136:139], v[12:15], v[88:91], v[136:139]
    v_mfma_f32_16x16x32_bf16 v[140:143], v[12:15], v[92:95], v[140:143]
    s_add_u32 s93, s90, 30720
    buffer_load_dwordx4 v[12:15], v2, s[8:11], s93 offen
    s_waitcnt vmcnt(19)
    v_mfma_f32_16x16x32_bf16 v[144:147], v[16:19], v[80:83], v[144:147]
    v_mfma_f32_16x16x32_bf16 v[148:151], v[16:19], v[84:87], v[148:151]
    v_mfma_f32_16x16x32_bf16 v[152:155], v[16:19], v[88:91], v[152:155]
    v_mfma_f32_16x16x32_bf16 v[156:159], v[16:19], v[92:95], v[156:159]
    s_add_u32 s93, s90, 49152
    buffer_load_dwordx4 v[16:19], v2, s[8:11], s93 offen
    s_waitcnt vmcnt(19)
    v_mfma_f32_16x16x32_bf16 v[160:163], v[20:23], v[80:83], v[160:163]
    v_mfma_f32_16x16x32_bf16 v[164:167], v[20:23], v[84:87], v[164:167]
    v_mfma_f32_16x16x32_bf16 v[168:171], v[20:23], v[88:91], v[168:171]
    v_mfma_f32_16x16x32_bf16 v[172:175], v[20:23], v[92:95], v[172:175]
    s_add_u32 s93, s90, 67584
    buffer_load_dwordx4 v[20:23], v2, s[8:11], s93 offen
    s_waitcnt vmcnt(19)
    v_mfma_f32_16x16x32_bf16 v[176:179], v[24:27], v[80:83], v[176:179]
    v_mfma_f32_16x16x32_bf16 v[180:183], v[24:27], v[84:87], v[180:183]
    v_mfma_f32_16x16x32_bf16 v[184:187], v[24:27], v[88:91], v[184:187]
    v_mfma_f32_16x16x32_bf16 v[188:191], v[24:27], v[92:95], v[188:191]
    s_add_u32 s93, s90, 86016
    buffer_load_dwordx4 v[24:27], v2, s[8:11], s93 offen
    s_waitcnt vmcnt(19)
    v_mfma_f32_16x16x32_bf16 v[192:195], v[28:31], v[80:83], v[192:195]
    v_mfma_f32_16x16x32_bf16 v[196:199], v[28:31], v[84:87], v[196:199]
    v_mfma_f32_16x16x32_bf16 v[200:203], v[28:31], v[88:91], v[200:203]
    v_mfma_f32_16x16x32_bf16 v[204:207], v[28:31], v[92:95], v[204:207]
    s_add_u32 s93, s90, 104448
    buffer_load_dwordx4 v[28:31], v2, s[8:11], s93 offen
    s_waitcnt vmcnt(19)
    v_mfma_f32_16x16x32_bf16 v[208:211], v[32:35], v[80:83], v[208:211]
    v_mfma_f32_16x16x32_bf16 v[212:215], v[32:35], v[84:87], v[212:215]
    v_mfma_f32_16x16x32_bf16 v[216:219], v[32:35], v[88:91], v[216:219]
    v_mfma_f32_16x16x32_bf16 v[220:223], v[32:35], v[92:95], v[220:223]
    s_add_u32 s93, s90, 122880
    buffer_load_dwordx4 v[32:35], v2, s[8:11], s93 offen
    s_waitcnt vmcnt(19)
    v_mfma_f32_16x16x32_bf16 v[224:227], v[36:39], v[80:83], v[224:227]
    v_mfma_f32_16x16x32_bf16 v[228:231], v[36:39], v[84:87], v[228:231]
    v_mfma_f32_16x16x32_bf16 v[232:235], v[36:39], v[88:91], v[232:235]
    v_mfma_f32_16x16x32_bf16 v[236:239], v[36:39], v[92:95], v[236:239]
    s_add_u32 s93, s90, 141312
    buffer_load_dwordx4 v[36:39], v2, s[8:11], s93 offen
    s_waitcnt vmcnt(19)
    v_mfma_f32_16x16x32_bf16 v[240:243], v[40:43], v[80:83], v[240:243]
    v_mfma_f32_16x16x32_bf16 v[244:247], v[40:43], v[84:87], v[244:247]
    v_mfma_f32_16x16x32_bf16 v[248:251], v[40:43], v[88:91], v[248:251]
    v_mfma_f32_16x16x32_bf16 v[252:255], v[40:43], v[92:95], v[252:255]
    s_add_u32 s93, s90, 159744
    buffer_load_dwordx4 v[40:43], v2, s[8:11], s93 offen
    s_waitcnt vmcnt(19) lgkmcnt(0)
    s_barrier
    ds_read_b128 v[80:83], v2 offset:12288
    ds_read_b128 v[84:87], v2 offset:30720
    ds_read_b128 v[88:91], v3 offset:12288
    ds_read_b128 v[92:95], v3 offset:30720
    s_add_u32 m0, s62, 14336
    s_add_u32 s93, s59, 14336
    buffer_load_dwordx4 v2, s[4:7], s93 offen lds
    s_waitcnt vmcnt(19)
    v_mfma_f32_16x16x32_bf16 v[112:115], v[44:47], v[96:99], v[112:115]
    v_mfma_f32_16x16x32_bf16 v[116:119], v[44:47], v[100:103], v[116:119]
    v_mfma_f32_16x16x32_bf16 v[120:123], v[44:47], v[104:107], v[120:123]
    v_mfma_f32_16x16x32_bf16 v[124:127], v[44:47], v[108:111], v[124:127]
    s_add_u32 s93, s90, 13312
    buffer_load_dwordx4 v[44:47], v2, s[8:11], s93 offen
    s_waitcnt vmcnt(19)
    v_mfma_f32_16x16x32_bf16 v[128:131], v[48:51], v[96:99], v[128:131]
    v_mfma_f32_16x16x32_bf16 v[132:135], v[48:51], v[100:103], v[132:135]
    v_mfma_f32_16x16x32_bf16 v[136:139], v[48:51], v[104:107], v[136:139]
    v_mfma_f32_16x16x32_bf16 v[140:143], v[48:51], v[108:111], v[140:143]
    s_add_u32 s93, s90, 31744
    buffer_load_dwordx4 v[48:51], v2, s[8:11], s93 offen
    s_waitcnt vmcnt(19)
    v_mfma_f32_16x16x32_bf16 v[144:147], v[52:55], v[96:99], v[144:147]
    v_mfma_f32_16x16x32_bf16 v[148:151], v[52:55], v[100:103], v[148:151]
    v_mfma_f32_16x16x32_bf16 v[152:155], v[52:55], v[104:107], v[152:155]
    v_mfma_f32_16x16x32_bf16 v[156:159], v[52:55], v[108:111], v[156:159]
    s_add_u32 s93, s90, 50176
    buffer_load_dwordx4 v[52:55], v2, s[8:11], s93 offen
    s_waitcnt vmcnt(19)
    v_mfma_f32_16x16x32_bf16 v[160:163], v[56:59], v[96:99], v[160:163]
    v_mfma_f32_16x16x32_bf16 v[164:167], v[56:59], v[100:103], v[164:167]
    v_mfma_f32_16x16x32_bf16 v[168:171], v[56:59], v[104:107], v[168:171]
    v_mfma_f32_16x16x32_bf16 v[172:175], v[56:59], v[108:111], v[172:175]
    s_add_u32 s93, s90, 68608
    buffer_load_dwordx4 v[56:59], v2, s[8:11], s93 offen
    s_waitcnt vmcnt(19)
    v_mfma_f32_16x16x32_bf16 v[176:179], v[60:63], v[96:99], v[176:179]
    v_mfma_f32_16x16x32_bf16 v[180:183], v[60:63], v[100:103], v[180:183]
    v_mfma_f32_16x16x32_bf16 v[184:187], v[60:63], v[104:107], v[184:187]
    v_mfma_f32_16x16x32_bf16 v[188:191], v[60:63], v[108:111], v[188:191]
    s_add_u32 s93, s90, 87040
    buffer_load_dwordx4 v[60:63], v2, s[8:11], s93 offen
    s_waitcnt vmcnt(19)
    v_mfma_f32_16x16x32_bf16 v[192:195], v[64:67], v[96:99], v[192:195]
    v_mfma_f32_16x16x32_bf16 v[196:199], v[64:67], v[100:103], v[196:199]
    v_mfma_f32_16x16x32_bf16 v[200:203], v[64:67], v[104:107], v[200:203]
    v_mfma_f32_16x16x32_bf16 v[204:207], v[64:67], v[108:111], v[204:207]
    s_add_u32 s93, s90, 105472
    buffer_load_dwordx4 v[64:67], v2, s[8:11], s93 offen
    s_waitcnt vmcnt(19)
    v_mfma_f32_16x16x32_bf16 v[208:211], v[68:71], v[96:99], v[208:211]
    v_mfma_f32_16x16x32_bf16 v[212:215], v[68:71], v[100:103], v[212:215]
    v_mfma_f32_16x16x32_bf16 v[216:219], v[68:71], v[104:107], v[216:219]
    v_mfma_f32_16x16x32_bf16 v[220:223], v[68:71], v[108:111], v[220:223]
    s_add_u32 s93, s90, 123904
    buffer_load_dwordx4 v[68:71], v2, s[8:11], s93 offen
    s_waitcnt vmcnt(19)
    v_mfma_f32_16x16x32_bf16 v[224:227], v[72:75], v[96:99], v[224:227]
    v_mfma_f32_16x16x32_bf16 v[228:231], v[72:75], v[100:103], v[228:231]
    v_mfma_f32_16x16x32_bf16 v[232:235], v[72:75], v[104:107], v[232:235]
    v_mfma_f32_16x16x32_bf16 v[236:239], v[72:75], v[108:111], v[236:239]
    s_add_u32 s93, s90, 142336
    buffer_load_dwordx4 v[72:75], v2, s[8:11], s93 offen
    s_waitcnt vmcnt(19)
    v_mfma_f32_16x16x32_bf16 v[240:243], v[76:79], v[96:99], v[240:243]
    v_mfma_f32_16x16x32_bf16 v[244:247], v[76:79], v[100:103], v[244:247]
    v_mfma_f32_16x16x32_bf16 v[248:251], v[76:79], v[104:107], v[248:251]
    v_mfma_f32_16x16x32_bf16 v[252:255], v[76:79], v[108:111], v[252:255]
    s_add_u32 s93, s90, 160768
    buffer_load_dwordx4 v[76:79], v2, s[8:11], s93 offen
    s_waitcnt vmcnt(19) lgkmcnt(0)
    s_barrier
    ds_read_b128 v[96:99], v2 offset:13312
    ds_read_b128 v[100:103], v2 offset:31744
    ds_read_b128 v[104:107], v3 offset:13312
    ds_read_b128 v[108:111], v3 offset:31744
    s_add_u32 m0, s62, 15360
    s_add_u32 s93, s59, 15360
    buffer_load_dwordx4 v2, s[4:7], s93 offen lds
    s_waitcnt vmcnt(19)
    v_mfma_f32_16x16x32_bf16 v[112:115], v[8:11], v[80:83], v[112:115]
    v_mfma_f32_16x16x32_bf16 v[116:119], v[8:11], v[84:87], v[116:119]
    v_mfma_f32_16x16x32_bf16 v[120:123], v[8:11], v[88:91], v[120:123]
    v_mfma_f32_16x16x32_bf16 v[124:127], v[8:11], v[92:95], v[124:127]
    s_add_u32 s93, s90, 14336
    buffer_load_dwordx4 v[8:11], v2, s[8:11], s93 offen
    s_waitcnt vmcnt(19)
    v_mfma_f32_16x16x32_bf16 v[128:131], v[12:15], v[80:83], v[128:131]
    v_mfma_f32_16x16x32_bf16 v[132:135], v[12:15], v[84:87], v[132:135]
    v_mfma_f32_16x16x32_bf16 v[136:139], v[12:15], v[88:91], v[136:139]
    v_mfma_f32_16x16x32_bf16 v[140:143], v[12:15], v[92:95], v[140:143]
    s_add_u32 s93, s90, 32768
    buffer_load_dwordx4 v[12:15], v2, s[8:11], s93 offen
    s_waitcnt vmcnt(19)
    v_mfma_f32_16x16x32_bf16 v[144:147], v[16:19], v[80:83], v[144:147]
    v_mfma_f32_16x16x32_bf16 v[148:151], v[16:19], v[84:87], v[148:151]
    v_mfma_f32_16x16x32_bf16 v[152:155], v[16:19], v[88:91], v[152:155]
    v_mfma_f32_16x16x32_bf16 v[156:159], v[16:19], v[92:95], v[156:159]
    s_add_u32 s93, s90, 51200
    buffer_load_dwordx4 v[16:19], v2, s[8:11], s93 offen
    s_waitcnt vmcnt(19)
    v_mfma_f32_16x16x32_bf16 v[160:163], v[20:23], v[80:83], v[160:163]
    v_mfma_f32_16x16x32_bf16 v[164:167], v[20:23], v[84:87], v[164:167]
    v_mfma_f32_16x16x32_bf16 v[168:171], v[20:23], v[88:91], v[168:171]
    v_mfma_f32_16x16x32_bf16 v[172:175], v[20:23], v[92:95], v[172:175]
    s_add_u32 s93, s90, 69632
    buffer_load_dwordx4 v[20:23], v2, s[8:11], s93 offen
    s_waitcnt vmcnt(19)
    v_mfma_f32_16x16x32_bf16 v[176:179], v[24:27], v[80:83], v[176:179]
    v_mfma_f32_16x16x32_bf16 v[180:183], v[24:27], v[84:87], v[180:183]
    v_mfma_f32_16x16x32_bf16 v[184:187], v[24:27], v[88:91], v[184:187]
    v_mfma_f32_16x16x32_bf16 v[188:191], v[24:27], v[92:95], v[188:191]
    s_add_u32 s93, s90, 88064
    buffer_load_dwordx4 v[24:27], v2, s[8:11], s93 offen
    s_waitcnt vmcnt(19)
    v_mfma_f32_16x16x32_bf16 v[192:195], v[28:31], v[80:83], v[192:195]
    v_mfma_f32_16x16x32_bf16 v[196:199], v[28:31], v[84:87], v[196:199]
    v_mfma_f32_16x16x32_bf16 v[200:203], v[28:31], v[88:91], v[200:203]
    v_mfma_f32_16x16x32_bf16 v[204:207], v[28:31], v[92:95], v[204:207]
    s_add_u32 s93, s90, 106496
    buffer_load_dwordx4 v[28:31], v2, s[8:11], s93 offen
    s_waitcnt vmcnt(19)
    v_mfma_f32_16x16x32_bf16 v[208:211], v[32:35], v[80:83], v[208:211]
    v_mfma_f32_16x16x32_bf16 v[212:215], v[32:35], v[84:87], v[212:215]
    v_mfma_f32_16x16x32_bf16 v[216:219], v[32:35], v[88:91], v[216:219]
    v_mfma_f32_16x16x32_bf16 v[220:223], v[32:35], v[92:95], v[220:223]
    s_add_u32 s93, s90, 124928
    buffer_load_dwordx4 v[32:35], v2, s[8:11], s93 offen
    s_waitcnt vmcnt(19)
    v_mfma_f32_16x16x32_bf16 v[224:227], v[36:39], v[80:83], v[224:227]
    v_mfma_f32_16x16x32_bf16 v[228:231], v[36:39], v[84:87], v[228:231]
    v_mfma_f32_16x16x32_bf16 v[232:235], v[36:39], v[88:91], v[232:235]
    v_mfma_f32_16x16x32_bf16 v[236:239], v[36:39], v[92:95], v[236:239]
    s_add_u32 s93, s90, 143360
    buffer_load_dwordx4 v[36:39], v2, s[8:11], s93 offen
    s_waitcnt vmcnt(19)
    v_mfma_f32_16x16x32_bf16 v[240:243], v[40:43], v[80:83], v[240:243]
    v_mfma_f32_16x16x32_bf16 v[244:247], v[40:43], v[84:87], v[244:247]
    v_mfma_f32_16x16x32_bf16 v[248:251], v[40:43], v[88:91], v[248:251]
    v_mfma_f32_16x16x32_bf16 v[252:255], v[40:43], v[92:95], v[252:255]
    s_add_u32 s93, s90, 161792
    buffer_load_dwordx4 v[40:43], v2, s[8:11], s93 offen
    s_waitcnt vmcnt(19) lgkmcnt(0)
    s_barrier
    ds_read_b128 v[80:83], v2 offset:14336
    ds_read_b128 v[84:87], v2 offset:32768
    ds_read_b128 v[88:91], v3 offset:14336
    ds_read_b128 v[92:95], v3 offset:32768
    s_add_u32 m0, s62, 16384
    s_add_u32 s93, s59, 16384
    buffer_load_dwordx4 v2, s[4:7], s93 offen lds
    s_waitcnt vmcnt(19)
    v_mfma_f32_16x16x32_bf16 v[112:115], v[44:47], v[96:99], v[112:115]
    v_mfma_f32_16x16x32_bf16 v[116:119], v[44:47], v[100:103], v[116:119]
    v_mfma_f32_16x16x32_bf16 v[120:123], v[44:47], v[104:107], v[120:123]
    v_mfma_f32_16x16x32_bf16 v[124:127], v[44:47], v[108:111], v[124:127]
    s_add_u32 s93, s90, 15360
    buffer_load_dwordx4 v[44:47], v2, s[8:11], s93 offen
    s_waitcnt vmcnt(19)
    v_mfma_f32_16x16x32_bf16 v[128:131], v[48:51], v[96:99], v[128:131]
    v_mfma_f32_16x16x32_bf16 v[132:135], v[48:51], v[100:103], v[132:135]
    v_mfma_f32_16x16x32_bf16 v[136:139], v[48:51], v[104:107], v[136:139]
    v_mfma_f32_16x16x32_bf16 v[140:143], v[48:51], v[108:111], v[140:143]
    s_add_u32 s93, s90, 33792
    buffer_load_dwordx4 v[48:51], v2, s[8:11], s93 offen
    s_waitcnt vmcnt(19)
    v_mfma_f32_16x16x32_bf16 v[144:147], v[52:55], v[96:99], v[144:147]
    v_mfma_f32_16x16x32_bf16 v[148:151], v[52:55], v[100:103], v[148:151]
    v_mfma_f32_16x16x32_bf16 v[152:155], v[52:55], v[104:107], v[152:155]
    v_mfma_f32_16x16x32_bf16 v[156:159], v[52:55], v[108:111], v[156:159]
    s_add_u32 s93, s90, 52224
    buffer_load_dwordx4 v[52:55], v2, s[8:11], s93 offen
    s_waitcnt vmcnt(19)
    v_mfma_f32_16x16x32_bf16 v[160:163], v[56:59], v[96:99], v[160:163]
    v_mfma_f32_16x16x32_bf16 v[164:167], v[56:59], v[100:103], v[164:167]
    v_mfma_f32_16x16x32_bf16 v[168:171], v[56:59], v[104:107], v[168:171]
    v_mfma_f32_16x16x32_bf16 v[172:175], v[56:59], v[108:111], v[172:175]
    s_add_u32 s93, s90, 70656
    buffer_load_dwordx4 v[56:59], v2, s[8:11], s93 offen
    s_waitcnt vmcnt(19)
    v_mfma_f32_16x16x32_bf16 v[176:179], v[60:63], v[96:99], v[176:179]
    v_mfma_f32_16x16x32_bf16 v[180:183], v[60:63], v[100:103], v[180:183]
    v_mfma_f32_16x16x32_bf16 v[184:187], v[60:63], v[104:107], v[184:187]
    v_mfma_f32_16x16x32_bf16 v[188:191], v[60:63], v[108:111], v[188:191]
    s_add_u32 s93, s90, 89088
    buffer_load_dwordx4 v[60:63], v2, s[8:11], s93 offen
    s_waitcnt vmcnt(19)
    v_mfma_f32_16x16x32_bf16 v[192:195], v[64:67], v[96:99], v[192:195]
    v_mfma_f32_16x16x32_bf16 v[196:199], v[64:67], v[100:103], v[196:199]
    v_mfma_f32_16x16x32_bf16 v[200:203], v[64:67], v[104:107], v[200:203]
    v_mfma_f32_16x16x32_bf16 v[204:207], v[64:67], v[108:111], v[204:207]
    s_add_u32 s93, s90, 107520
    buffer_load_dwordx4 v[64:67], v2, s[8:11], s93 offen
    s_waitcnt vmcnt(19)
    v_mfma_f32_16x16x32_bf16 v[208:211], v[68:71], v[96:99], v[208:211]
    v_mfma_f32_16x16x32_bf16 v[212:215], v[68:71], v[100:103], v[212:215]
    v_mfma_f32_16x16x32_bf16 v[216:219], v[68:71], v[104:107], v[216:219]
    v_mfma_f32_16x16x32_bf16 v[220:223], v[68:71], v[108:111], v[220:223]
    s_add_u32 s93, s90, 125952
    buffer_load_dwordx4 v[68:71], v2, s[8:11], s93 offen
    s_waitcnt vmcnt(19)
    v_mfma_f32_16x16x32_bf16 v[224:227], v[72:75], v[96:99], v[224:227]
    v_mfma_f32_16x16x32_bf16 v[228:231], v[72:75], v[100:103], v[228:231]
    v_mfma_f32_16x16x32_bf16 v[232:235], v[72:75], v[104:107], v[232:235]
    v_mfma_f32_16x16x32_bf16 v[236:239], v[72:75], v[108:111], v[236:239]
    s_add_u32 s93, s90, 144384
    buffer_load_dwordx4 v[72:75], v2, s[8:11], s93 offen
    s_waitcnt vmcnt(19)
    v_mfma_f32_16x16x32_bf16 v[240:243], v[76:79], v[96:99], v[240:243]
    v_mfma_f32_16x16x32_bf16 v[244:247], v[76:79], v[100:103], v[244:247]
    v_mfma_f32_16x16x32_bf16 v[248:251], v[76:79], v[104:107], v[248:251]
    v_mfma_f32_16x16x32_bf16 v[252:255], v[76:79], v[108:111], v[252:255]
    s_add_u32 s93, s90, 162816
    buffer_load_dwordx4 v[76:79], v2, s[8:11], s93 offen
    s_waitcnt vmcnt(19) lgkmcnt(0)
    s_barrier
    ds_read_b128 v[96:99], v2 offset:15360
    ds_read_b128 v[100:103], v2 offset:33792
    ds_read_b128 v[104:107], v3 offset:15360
    ds_read_b128 v[108:111], v3 offset:33792
    s_add_u32 m0, s62, 17408
    s_add_u32 s93, s59, 17408
    buffer_load_dwordx4 v2, s[4:7], s93 offen lds
    s_waitcnt vmcnt(19)
    v_mfma_f32_16x16x32_bf16 v[112:115], v[8:11], v[80:83], v[112:115]
    v_mfma_f32_16x16x32_bf16 v[116:119], v[8:11], v[84:87], v[116:119]
    v_mfma_f32_16x16x32_bf16 v[120:123], v[8:11], v[88:91], v[120:123]
    v_mfma_f32_16x16x32_bf16 v[124:127], v[8:11], v[92:95], v[124:127]
    s_add_u32 s93, s90, 16384
    buffer_load_dwordx4 v[8:11], v2, s[8:11], s93 offen
    s_waitcnt vmcnt(19)
    v_mfma_f32_16x16x32_bf16 v[128:131], v[12:15], v[80:83], v[128:131]
    v_mfma_f32_16x16x32_bf16 v[132:135], v[12:15], v[84:87], v[132:135]
    v_mfma_f32_16x16x32_bf16 v[136:139], v[12:15], v[88:91], v[136:139]
    v_mfma_f32_16x16x32_bf16 v[140:143], v[12:15], v[92:95], v[140:143]
    s_add_u32 s93, s90, 34816
    buffer_load_dwordx4 v[12:15], v2, s[8:11], s93 offen
    s_waitcnt vmcnt(19)
    v_mfma_f32_16x16x32_bf16 v[144:147], v[16:19], v[80:83], v[144:147]
    v_mfma_f32_16x16x32_bf16 v[148:151], v[16:19], v[84:87], v[148:151]
    v_mfma_f32_16x16x32_bf16 v[152:155], v[16:19], v[88:91], v[152:155]
    v_mfma_f32_16x16x32_bf16 v[156:159], v[16:19], v[92:95], v[156:159]
    s_add_u32 s93, s90, 53248
    buffer_load_dwordx4 v[16:19], v2, s[8:11], s93 offen
    s_waitcnt vmcnt(19)
    v_mfma_f32_16x16x32_bf16 v[160:163], v[20:23], v[80:83], v[160:163]
    v_mfma_f32_16x16x32_bf16 v[164:167], v[20:23], v[84:87], v[164:167]
    v_mfma_f32_16x16x32_bf16 v[168:171], v[20:23], v[88:91], v[168:171]
    v_mfma_f32_16x16x32_bf16 v[172:175], v[20:23], v[92:95], v[172:175]
    s_add_u32 s93, s90, 71680
    buffer_load_dwordx4 v[20:23], v2, s[8:11], s93 offen
    s_waitcnt vmcnt(19)
    v_mfma_f32_16x16x32_bf16 v[176:179], v[24:27], v[80:83], v[176:179]
    v_mfma_f32_16x16x32_bf16 v[180:183], v[24:27], v[84:87], v[180:183]
    v_mfma_f32_16x16x32_bf16 v[184:187], v[24:27], v[88:91], v[184:187]
    v_mfma_f32_16x16x32_bf16 v[188:191], v[24:27], v[92:95], v[188:191]
    s_add_u32 s93, s90, 90112
    buffer_load_dwordx4 v[24:27], v2, s[8:11], s93 offen
    s_waitcnt vmcnt(19)
    v_mfma_f32_16x16x32_bf16 v[192:195], v[28:31], v[80:83], v[192:195]
    v_mfma_f32_16x16x32_bf16 v[196:199], v[28:31], v[84:87], v[196:199]
    v_mfma_f32_16x16x32_bf16 v[200:203], v[28:31], v[88:91], v[200:203]
    v_mfma_f32_16x16x32_bf16 v[204:207], v[28:31], v[92:95], v[204:207]
    s_add_u32 s93, s90, 108544
    buffer_load_dwordx4 v[28:31], v2, s[8:11], s93 offen
    s_waitcnt vmcnt(19)
    v_mfma_f32_16x16x32_bf16 v[208:211], v[32:35], v[80:83], v[208:211]
    v_mfma_f32_16x16x32_bf16 v[212:215], v[32:35], v[84:87], v[212:215]
    v_mfma_f32_16x16x32_bf16 v[216:219], v[32:35], v[88:91], v[216:219]
    v_mfma_f32_16x16x32_bf16 v[220:223], v[32:35], v[92:95], v[220:223]
    s_add_u32 s93, s90, 126976
    buffer_load_dwordx4 v[32:35], v2, s[8:11], s93 offen
    s_waitcnt vmcnt(19)
    v_mfma_f32_16x16x32_bf16 v[224:227], v[36:39], v[80:83], v[224:227]
    v_mfma_f32_16x16x32_bf16 v[228:231], v[36:39], v[84:87], v[228:231]
    v_mfma_f32_16x16x32_bf16 v[232:235], v[36:39], v[88:91], v[232:235]
    v_mfma_f32_16x16x32_bf16 v[236:239], v[36:39], v[92:95], v[236:239]
    s_add_u32 s93, s90, 145408
    buffer_load_dwordx4 v[36:39], v2, s[8:11], s93 offen
    s_waitcnt vmcnt(19)
    v_mfma_f32_16x16x32_bf16 v[240:243], v[40:43], v[80:83], v[240:243]
    v_mfma_f32_16x16x32_bf16 v[244:247], v[40:43], v[84:87], v[244:247]
    v_mfma_f32_16x16x32_bf16 v[248:251], v[40:43], v[88:91], v[248:251]
    v_mfma_f32_16x16x32_bf16 v[252:255], v[40:43], v[92:95], v[252:255]
    s_add_u32 s93, s90, 163840
    buffer_load_dwordx4 v[40:43], v2, s[8:11], s93 offen
    s_waitcnt vmcnt(19) lgkmcnt(0)
    s_barrier
    ds_read_b128 v[80:83], v2 offset:16384
    ds_read_b128 v[84:87], v2 offset:34816
    ds_read_b128 v[88:91], v3 offset:16384
    ds_read_b128 v[92:95], v3 offset:34816
    s_waitcnt vmcnt(18)
    v_mfma_f32_16x16x32_bf16 v[112:115], v[44:47], v[96:99], v[112:115]
    v_mfma_f32_16x16x32_bf16 v[116:119], v[44:47], v[100:103], v[116:119]
    v_mfma_f32_16x16x32_bf16 v[120:123], v[44:47], v[104:107], v[120:123]
    v_mfma_f32_16x16x32_bf16 v[124:127], v[44:47], v[108:111], v[124:127]
    s_add_u32 s93, s90, 17408
    buffer_load_dwordx4 v[44:47], v2, s[8:11], s93 offen
    s_waitcnt vmcnt(18)
    v_mfma_f32_16x16x32_bf16 v[128:131], v[48:51], v[96:99], v[128:131]
    v_mfma_f32_16x16x32_bf16 v[132:135], v[48:51], v[100:103], v[132:135]
    v_mfma_f32_16x16x32_bf16 v[136:139], v[48:51], v[104:107], v[136:139]
    v_mfma_f32_16x16x32_bf16 v[140:143], v[48:51], v[108:111], v[140:143]
    s_add_u32 s93, s90, 35840
    buffer_load_dwordx4 v[48:51], v2, s[8:11], s93 offen
    s_waitcnt vmcnt(18)
    v_mfma_f32_16x16x32_bf16 v[144:147], v[52:55], v[96:99], v[144:147]
    v_mfma_f32_16x16x32_bf16 v[148:151], v[52:55], v[100:103], v[148:151]
    v_mfma_f32_16x16x32_bf16 v[152:155], v[52:55], v[104:107], v[152:155]
    v_mfma_f32_16x16x32_bf16 v[156:159], v[52:55], v[108:111], v[156:159]
    s_add_u32 s93, s90, 54272
    buffer_load_dwordx4 v[52:55], v2, s[8:11], s93 offen
    s_waitcnt vmcnt(18)
    v_mfma_f32_16x16x32_bf16 v[160:163], v[56:59], v[96:99], v[160:163]
    v_mfma_f32_16x16x32_bf16 v[164:167], v[56:59], v[100:103], v[164:167]
    v_mfma_f32_16x16x32_bf16 v[168:171], v[56:59], v[104:107], v[168:171]
    v_mfma_f32_16x16x32_bf16 v[172:175], v[56:59], v[108:111], v[172:175]
    s_add_u32 s93, s90, 72704
    buffer_load_dwordx4 v[56:59], v2, s[8:11], s93 offen
    s_waitcnt vmcnt(18)
    v_mfma_f32_16x16x32_bf16 v[176:179], v[60:63], v[96:99], v[176:179]
    v_mfma_f32_16x16x32_bf16 v[180:183], v[60:63], v[100:103], v[180:183]
    v_mfma_f32_16x16x32_bf16 v[184:187], v[60:63], v[104:107], v[184:187]
    v_mfma_f32_16x16x32_bf16 v[188:191], v[60:63], v[108:111], v[188:191]
    s_add_u32 s93, s90, 91136
    buffer_load_dwordx4 v[60:63], v2, s[8:11], s93 offen
    s_waitcnt vmcnt(18)
    v_mfma_f32_16x16x32_bf16 v[192:195], v[64:67], v[96:99], v[192:195]
    v_mfma_f32_16x16x32_bf16 v[196:199], v[64:67], v[100:103], v[196:199]
    v_mfma_f32_16x16x32_bf16 v[200:203], v[64:67], v[104:107], v[200:203]
    v_mfma_f32_16x16x32_bf16 v[204:207], v[64:67], v[108:111], v[204:207]
    s_add_u32 s93, s90, 109568
    buffer_load_dwordx4 v[64:67], v2, s[8:11], s93 offen
    s_waitcnt vmcnt(18)
    v_mfma_f32_16x16x32_bf16 v[208:211], v[68:71], v[96:99], v[208:211]
    v_mfma_f32_16x16x32_bf16 v[212:215], v[68:71], v[100:103], v[212:215]
    v_mfma_f32_16x16x32_bf16 v[216:219], v[68:71], v[104:107], v[216:219]
    v_mfma_f32_16x16x32_bf16 v[220:223], v[68:71], v[108:111], v[220:223]
    s_add_u32 s93, s90, 128000
    buffer_load_dwordx4 v[68:71], v2, s[8:11], s93 offen
    s_waitcnt vmcnt(18)
    v_mfma_f32_16x16x32_bf16 v[224:227], v[72:75], v[96:99], v[224:227]
    v_mfma_f32_16x16x32_bf16 v[228:231], v[72:75], v[100:103], v[228:231]
    v_mfma_f32_16x16x32_bf16 v[232:235], v[72:75], v[104:107], v[232:235]
    v_mfma_f32_16x16x32_bf16 v[236:239], v[72:75], v[108:111], v[236:239]
    s_add_u32 s93, s90, 146432
    buffer_load_dwordx4 v[72:75], v2, s[8:11], s93 offen
    s_waitcnt vmcnt(18)
    v_mfma_f32_16x16x32_bf16 v[240:243], v[76:79], v[96:99], v[240:243]
    v_mfma_f32_16x16x32_bf16 v[244:247], v[76:79], v[100:103], v[244:247]
    v_mfma_f32_16x16x32_bf16 v[248:251], v[76:79], v[104:107], v[248:251]
    v_mfma_f32_16x16x32_bf16 v[252:255], v[76:79], v[108:111], v[252:255]
    s_add_u32 s93, s90, 164864
    buffer_load_dwordx4 v[76:79], v2, s[8:11], s93 offen
    s_waitcnt vmcnt(18) lgkmcnt(0)
    s_barrier
    ds_read_b128 v[96:99], v2 offset:17408
    ds_read_b128 v[100:103], v2 offset:35840
    ds_read_b128 v[104:107], v3 offset:17408
    ds_read_b128 v[108:111], v3 offset:35840
    s_waitcnt vmcnt(17)
    v_mfma_f32_16x16x32_bf16 v[112:115], v[8:11], v[80:83], v[112:115]
    v_mfma_f32_16x16x32_bf16 v[116:119], v[8:11], v[84:87], v[116:119]
    v_mfma_f32_16x16x32_bf16 v[120:123], v[8:11], v[88:91], v[120:123]
    v_mfma_f32_16x16x32_bf16 v[124:127], v[8:11], v[92:95], v[124:127]
    s_waitcnt vmcnt(16)
    v_mfma_f32_16x16x32_bf16 v[128:131], v[12:15], v[80:83], v[128:131]
    v_mfma_f32_16x16x32_bf16 v[132:135], v[12:15], v[84:87], v[132:135]
    v_mfma_f32_16x16x32_bf16 v[136:139], v[12:15], v[88:91], v[136:139]
    v_mfma_f32_16x16x32_bf16 v[140:143], v[12:15], v[92:95], v[140:143]
    s_waitcnt vmcnt(15)
    v_mfma_f32_16x16x32_bf16 v[144:147], v[16:19], v[80:83], v[144:147]
    v_mfma_f32_16x16x32_bf16 v[148:151], v[16:19], v[84:87], v[148:151]
    v_mfma_f32_16x16x32_bf16 v[152:155], v[16:19], v[88:91], v[152:155]
    v_mfma_f32_16x16x32_bf16 v[156:159], v[16:19], v[92:95], v[156:159]
    s_waitcnt vmcnt(14)
    v_mfma_f32_16x16x32_bf16 v[160:163], v[20:23], v[80:83], v[160:163]
    v_mfma_f32_16x16x32_bf16 v[164:167], v[20:23], v[84:87], v[164:167]
    v_mfma_f32_16x16x32_bf16 v[168:171], v[20:23], v[88:91], v[168:171]
    v_mfma_f32_16x16x32_bf16 v[172:175], v[20:23], v[92:95], v[172:175]
    s_waitcnt vmcnt(13)
    v_mfma_f32_16x16x32_bf16 v[176:179], v[24:27], v[80:83], v[176:179]
    v_mfma_f32_16x16x32_bf16 v[180:183], v[24:27], v[84:87], v[180:183]
    v_mfma_f32_16x16x32_bf16 v[184:187], v[24:27], v[88:91], v[184:187]
    v_mfma_f32_16x16x32_bf16 v[188:191], v[24:27], v[92:95], v[188:191]
    s_waitcnt vmcnt(12)
    v_mfma_f32_16x16x32_bf16 v[192:195], v[28:31], v[80:83], v[192:195]
    v_mfma_f32_16x16x32_bf16 v[196:199], v[28:31], v[84:87], v[196:199]
    v_mfma_f32_16x16x32_bf16 v[200:203], v[28:31], v[88:91], v[200:203]
    v_mfma_f32_16x16x32_bf16 v[204:207], v[28:31], v[92:95], v[204:207]
    s_waitcnt vmcnt(11)
    v_mfma_f32_16x16x32_bf16 v[208:211], v[32:35], v[80:83], v[208:211]
    v_mfma_f32_16x16x32_bf16 v[212:215], v[32:35], v[84:87], v[212:215]
    v_mfma_f32_16x16x32_bf16 v[216:219], v[32:35], v[88:91], v[216:219]
    v_mfma_f32_16x16x32_bf16 v[220:223], v[32:35], v[92:95], v[220:223]
    s_waitcnt vmcnt(10)
    v_mfma_f32_16x16x32_bf16 v[224:227], v[36:39], v[80:83], v[224:227]
    v_mfma_f32_16x16x32_bf16 v[228:231], v[36:39], v[84:87], v[228:231]
    v_mfma_f32_16x16x32_bf16 v[232:235], v[36:39], v[88:91], v[232:235]
    v_mfma_f32_16x16x32_bf16 v[236:239], v[36:39], v[92:95], v[236:239]
    s_waitcnt vmcnt(9)
    v_mfma_f32_16x16x32_bf16 v[240:243], v[40:43], v[80:83], v[240:243]
    v_mfma_f32_16x16x32_bf16 v[244:247], v[40:43], v[84:87], v[244:247]
    v_mfma_f32_16x16x32_bf16 v[248:251], v[40:43], v[88:91], v[248:251]
    v_mfma_f32_16x16x32_bf16 v[252:255], v[40:43], v[92:95], v[252:255]
    s_waitcnt lgkmcnt(0)
    s_waitcnt vmcnt(8)
    v_mfma_f32_16x16x32_bf16 v[112:115], v[44:47], v[96:99], v[112:115]
    v_mfma_f32_16x16x32_bf16 v[116:119], v[44:47], v[100:103], v[116:119]
    v_mfma_f32_16x16x32_bf16 v[120:123], v[44:47], v[104:107], v[120:123]
    v_mfma_f32_16x16x32_bf16 v[124:127], v[44:47], v[108:111], v[124:127]
    s_waitcnt vmcnt(7)
    v_mfma_f32_16x16x32_bf16 v[128:131], v[48:51], v[96:99], v[128:131]
    v_mfma_f32_16x16x32_bf16 v[132:135], v[48:51], v[100:103], v[132:135]
    v_mfma_f32_16x16x32_bf16 v[136:139], v[48:51], v[104:107], v[136:139]
    v_mfma_f32_16x16x32_bf16 v[140:143], v[48:51], v[108:111], v[140:143]
    s_waitcnt vmcnt(6)
    v_mfma_f32_16x16x32_bf16 v[144:147], v[52:55], v[96:99], v[144:147]
    v_mfma_f32_16x16x32_bf16 v[148:151], v[52:55], v[100:103], v[148:151]
    v_mfma_f32_16x16x32_bf16 v[152:155], v[52:55], v[104:107], v[152:155]
    v_mfma_f32_16x16x32_bf16 v[156:159], v[52:55], v[108:111], v[156:159]
    s_waitcnt vmcnt(5)
    v_mfma_f32_16x16x32_bf16 v[160:163], v[56:59], v[96:99], v[160:163]
    v_mfma_f32_16x16x32_bf16 v[164:167], v[56:59], v[100:103], v[164:167]
    v_mfma_f32_16x16x32_bf16 v[168:171], v[56:59], v[104:107], v[168:171]
    v_mfma_f32_16x16x32_bf16 v[172:175], v[56:59], v[108:111], v[172:175]
    s_waitcnt vmcnt(4)
    v_mfma_f32_16x16x32_bf16 v[176:179], v[60:63], v[96:99], v[176:179]
    v_mfma_f32_16x16x32_bf16 v[180:183], v[60:63], v[100:103], v[180:183]
    v_mfma_f32_16x16x32_bf16 v[184:187], v[60:63], v[104:107], v[184:187]
    v_mfma_f32_16x16x32_bf16 v[188:191], v[60:63], v[108:111], v[188:191]
    s_waitcnt vmcnt(3)
    v_mfma_f32_16x16x32_bf16 v[192:195], v[64:67], v[96:99], v[192:195]
    v_mfma_f32_16x16x32_bf16 v[196:199], v[64:67], v[100:103], v[196:199]
    v_mfma_f32_16x16x32_bf16 v[200:203], v[64:67], v[104:107], v[200:203]
    v_mfma_f32_16x16x32_bf16 v[204:207], v[64:67], v[108:111], v[204:207]
    s_waitcnt vmcnt(2)
    v_mfma_f32_16x16x32_bf16 v[208:211], v[68:71], v[96:99], v[208:211]
    v_mfma_f32_16x16x32_bf16 v[212:215], v[68:71], v[100:103], v[212:215]
    v_mfma_f32_16x16x32_bf16 v[216:219], v[68:71], v[104:107], v[216:219]
    v_mfma_f32_16x16x32_bf16 v[220:223], v[68:71], v[108:111], v[220:223]
    s_waitcnt vmcnt(1)
    v_mfma_f32_16x16x32_bf16 v[224:227], v[72:75], v[96:99], v[224:227]
    v_mfma_f32_16x16x32_bf16 v[228:231], v[72:75], v[100:103], v[228:231]
    v_mfma_f32_16x16x32_bf16 v[232:235], v[72:75], v[104:107], v[232:235]
    v_mfma_f32_16x16x32_bf16 v[236:239], v[72:75], v[108:111], v[236:239]
    s_waitcnt vmcnt(0)
    v_mfma_f32_16x16x32_bf16 v[240:243], v[76:79], v[96:99], v[240:243]
    v_mfma_f32_16x16x32_bf16 v[244:247], v[76:79], v[100:103], v[244:247]
    v_mfma_f32_16x16x32_bf16 v[248:251], v[76:79], v[104:107], v[248:251]
    v_mfma_f32_16x16x32_bf16 v[252:255], v[76:79], v[108:111], v[252:255]
    s_nop 3
    s_add_u32 s93, s91, 0
    buffer_load_dwordx4 v[8:11], v2, s[24:27], s93 offen
    s_add_u32 s93, s91, 147456
    buffer_load_dwordx4 v[12:15], v2, s[24:27], s93 offen
    s_add_u32 s93, s91, 294912
    buffer_load_dwordx4 v[16:19], v2, s[24:27], s93 offen
    s_add_u32 s93, s91, 1024
    buffer_load_dwordx4 v[20:23], v2, s[24:27], s93 offen
    s_add_u32 s93, s91, 148480
    buffer_load_dwordx4 v[24:27], v2, s[24:27], s93 offen
    s_add_u32 s93, s91, 295936
    buffer_load_dwordx4 v[28:31], v2, s[24:27], s93 offen
    s_add_u32 s93, s91, 2048
    buffer_load_dwordx4 v[32:35], v2, s[24:27], s93 offen
    s_add_u32 s93, s91, 149504
    buffer_load_dwordx4 v[36:39], v2, s[24:27], s93 offen
    s_add_u32 s93, s91, 296960
    buffer_load_dwordx4 v[40:43], v2, s[24:27], s93 offen
    s_add_u32 s93, s91, 3072
    buffer_load_dwordx4 v[44:47], v2, s[24:27], s93 offen
    s_add_u32 s93, s91, 150528
    buffer_load_dwordx4 v[48:51], v2, s[24:27], s93 offen
    s_add_u32 s93, s91, 297984
    buffer_load_dwordx4 v[52:55], v2, s[24:27], s93 offen
    s_add_u32 s93, s91, 4096
    buffer_load_dwordx4 v[56:59], v2, s[24:27], s93 offen
    s_add_u32 s93, s91, 151552
    buffer_load_dwordx4 v[60:63], v2, s[24:27], s93 offen
    s_add_u32 s93, s91, 299008
    buffer_load_dwordx4 v[64:67], v2, s[24:27], s93 offen
    s_add_u32 s93, s91, 5120
    buffer_load_dwordx4 v[68:71], v2, s[24:27], s93 offen
    s_add_u32 s93, s91, 152576
    buffer_load_dwordx4 v[72:75], v2, s[24:27], s93 offen
    s_add_u32 s93, s91, 300032
    buffer_load_dwordx4 v[76:79], v2, s[24:27], s93 offen
    s_mov_b32 s94, 0x3fb8aa3b
    s_mov_b32 s95, 0x3fb8aa3b
    s_mov_b32 s96, 2.0
    s_mov_b32 s97, 2.0
    s_mov_b32 s98, -2.0
    s_mov_b32 s99, -2.0
    s_barrier
    s_nop 7
    v_pk_mul_f32 v[80:81], v[240:241], s[94:95]
    v_pk_mul_f32 v[84:85], v[242:243], s[94:95]
    v_pk_mul_f32 v[88:89], v[244:245], s[94:95]
    v_pk_mul_f32 v[92:93], v[246:247], s[94:95]
    v_exp_f32 v80, v80
    v_exp_f32 v81, v81
    v_exp_f32 v84, v84
    v_exp_f32 v85, v85
    v_exp_f32 v88, v88
    v_exp_f32 v89, v89
    v_exp_f32 v92, v92
    v_exp_f32 v93, v93
    v_pk_add_f32 v[82:83], v[80:81], s[96:97]
    v_pk_add_f32 v[86:87], v[84:85], s[96:97]
    v_pk_add_f32 v[90:91], v[88:89], s[96:97]
    v_pk_add_f32 v[94:95], v[92:93], s[96:97]
    v_pk_fma_f32 v[82:83], v[80:81], v[82:83], s[96:97]
    v_pk_fma_f32 v[86:87], v[84:85], v[86:87], s[96:97]
    v_pk_fma_f32 v[90:91], v[88:89], v[90:91], s[96:97]
    v_pk_fma_f32 v[94:95], v[92:93], v[94:95], s[96:97]
    v_rcp_f32 v82, v82
    v_rcp_f32 v83, v83
    v_rcp_f32 v86, v86
    v_rcp_f32 v87, v87
    v_rcp_f32 v90, v90
    v_rcp_f32 v91, v91
    v_rcp_f32 v94, v94
    v_rcp_f32 v95, v95
    v_pk_mul_f32 v[82:83], v[82:83], v[240:241]
    v_pk_mul_f32 v[86:87], v[86:87], v[242:243]
    v_pk_mul_f32 v[90:91], v[90:91], v[244:245]
    v_pk_mul_f32 v[94:95], v[94:95], v[246:247]
    v_pk_fma_f32 v[82:83], v[82:83], s[98:99], v[240:241]
    v_pk_fma_f32 v[86:87], v[86:87], s[98:99], v[242:243]
    v_pk_fma_f32 v[90:91], v[90:91], s[98:99], v[244:245]
    v_pk_fma_f32 v[94:95], v[94:95], s[98:99], v[246:247]
    v_cvt_pk_bf16_f32 v80, v82, v83
    v_cvt_pk_bf16_f32 v81, v86, v87
    v_cvt_pk_bf16_f32 v88, v90, v91
    v_cvt_pk_bf16_f32 v89, v94, v95
    ds_write_b64 v5, v[80:81] offset:4096
    ds_write_b64 v5, v[88:89] offset:22528
    v_pk_mul_f32 v[96:97], v[248:249], s[94:95]
    v_pk_mul_f32 v[100:101], v[250:251], s[94:95]
    v_pk_mul_f32 v[104:105], v[252:253], s[94:95]
    v_pk_mul_f32 v[108:109], v[254:255], s[94:95]
    v_exp_f32 v96, v96
    v_exp_f32 v97, v97
    v_exp_f32 v100, v100
    v_exp_f32 v101, v101
    v_exp_f32 v104, v104
    v_exp_f32 v105, v105
    v_exp_f32 v108, v108
    v_exp_f32 v109, v109
    v_pk_add_f32 v[98:99], v[96:97], s[96:97]
    v_pk_add_f32 v[102:103], v[100:101], s[96:97]
    v_pk_add_f32 v[106:107], v[104:105], s[96:97]
    v_pk_add_f32 v[110:111], v[108:109], s[96:97]
    v_pk_fma_f32 v[98:99], v[96:97], v[98:99], s[96:97]
    v_pk_fma_f32 v[102:103], v[100:101], v[102:103], s[96:97]
    v_pk_fma_f32 v[106:107], v[104:105], v[106:107], s[96:97]
    v_pk_fma_f32 v[110:111], v[108:109], v[110:111], s[96:97]
    v_rcp_f32 v98, v98
    v_rcp_f32 v99, v99
    v_rcp_f32 v102, v102
    v_rcp_f32 v103, v103
    v_rcp_f32 v106, v106
    v_rcp_f32 v107, v107
    v_rcp_f32 v110, v110
    v_rcp_f32 v111, v111
    v_pk_mul_f32 v[98:99], v[98:99], v[248:249]
    v_pk_mul_f32 v[102:103], v[102:103], v[250:251]
    v_pk_mul_f32 v[106:107], v[106:107], v[252:253]
    v_pk_mul_f32 v[110:111], v[110:111], v[254:255]
    v_pk_fma_f32 v[98:99], v[98:99], s[98:99], v[248:249]
    v_pk_fma_f32 v[102:103], v[102:103], s[98:99], v[250:251]
    v_pk_fma_f32 v[106:107], v[106:107], s[98:99], v[252:253]
    v_pk_fma_f32 v[110:111], v[110:111], s[98:99], v[254:255]
    v_cvt_pk_bf16_f32 v96, v98, v99
    v_cvt_pk_bf16_f32 v97, v102, v103
    v_cvt_pk_bf16_f32 v104, v106, v107
    v_cvt_pk_bf16_f32 v105, v110, v111
    ds_write_b64 v5, v[96:97] offset:40960
    ds_write_b64 v5, v[104:105] offset:59392
    v_pk_mul_f32 v[80:81], v[224:225], s[94:95]
    v_pk_mul_f32 v[84:85], v[226:227], s[94:95]
    v_pk_mul_f32 v[88:89], v[228:229], s[94:95]
    v_pk_mul_f32 v[92:93], v[230:231], s[94:95]
    v_exp_f32 v80, v80
    v_exp_f32 v81, v81
    v_exp_f32 v84, v84
    v_exp_f32 v85, v85
    v_exp_f32 v88, v88
    v_exp_f32 v89, v89
    v_exp_f32 v92, v92
    v_exp_f32 v93, v93
    v_pk_add_f32 v[82:83], v[80:81], s[96:97]
    v_pk_add_f32 v[86:87], v[84:85], s[96:97]
    v_pk_add_f32 v[90:91], v[88:89], s[96:97]
    v_pk_add_f32 v[94:95], v[92:93], s[96:97]
    v_pk_fma_f32 v[82:83], v[80:81], v[82:83], s[96:97]
    v_pk_fma_f32 v[86:87], v[84:85], v[86:87], s[96:97]
    v_pk_fma_f32 v[90:91], v[88:89], v[90:91], s[96:97]
    v_pk_fma_f32 v[94:95], v[92:93], v[94:95], s[96:97]
    v_rcp_f32 v82, v82
    v_rcp_f32 v83, v83
    v_rcp_f32 v86, v86
    v_rcp_f32 v87, v87
    v_rcp_f32 v90, v90
    v_rcp_f32 v91, v91
    v_rcp_f32 v94, v94
    v_rcp_f32 v95, v95
    v_pk_mul_f32 v[82:83], v[82:83], v[224:225]
    v_pk_mul_f32 v[86:87], v[86:87], v[226:227]
    v_pk_mul_f32 v[90:91], v[90:91], v[228:229]
    v_pk_mul_f32 v[94:95], v[94:95], v[230:231]
    v_pk_fma_f32 v[82:83], v[82:83], s[98:99], v[224:225]
    v_pk_fma_f32 v[86:87], v[86:87], s[98:99], v[226:227]
    v_pk_fma_f32 v[90:91], v[90:91], s[98:99], v[228:229]
    v_pk_fma_f32 v[94:95], v[94:95], s[98:99], v[230:231]
    v_cvt_pk_bf16_f32 v80, v82, v83
    v_cvt_pk_bf16_f32 v81, v86, v87
    v_cvt_pk_bf16_f32 v88, v90, v91
    v_cvt_pk_bf16_f32 v89, v94, v95
    ds_write_b64 v6, v[80:81] offset:3072
    ds_write_b64 v6, v[88:89] offset:21504
    v_pk_mul_f32 v[96:97], v[232:233], s[94:95]
    v_pk_mul_f32 v[100:101], v[234:235], s[94:95]
    v_pk_mul_f32 v[104:105], v[236:237], s[94:95]
    v_pk_mul_f32 v[108:109], v[238:239], s[94:95]
    v_exp_f32 v96, v96
    v_exp_f32 v97, v97
    v_exp_f32 v100, v100
    v_exp_f32 v101, v101
    v_exp_f32 v104, v104
    v_exp_f32 v105, v105
    v_exp_f32 v108, v108
    v_exp_f32 v109, v109
    v_pk_add_f32 v[98:99], v[96:97], s[96:97]
    v_pk_add_f32 v[102:103], v[100:101], s[96:97]
    v_pk_add_f32 v[106:107], v[104:105], s[96:97]
    v_pk_add_f32 v[110:111], v[108:109], s[96:97]
    v_pk_fma_f32 v[98:99], v[96:97], v[98:99], s[96:97]
    v_pk_fma_f32 v[102:103], v[100:101], v[102:103], s[96:97]
    v_pk_fma_f32 v[106:107], v[104:105], v[106:107], s[96:97]
    v_pk_fma_f32 v[110:111], v[108:109], v[110:111], s[96:97]
    v_rcp_f32 v98, v98
    v_rcp_f32 v99, v99
    v_rcp_f32 v102, v102
    v_rcp_f32 v103, v103
    v_rcp_f32 v106, v106
    v_rcp_f32 v107, v107
    v_rcp_f32 v110, v110
    v_rcp_f32 v111, v111
    v_pk_mul_f32 v[98:99], v[98:99], v[232:233]
    v_pk_mul_f32 v[102:103], v[102:103], v[234:235]
    v_pk_mul_f32 v[106:107], v[106:107], v[236:237]
    v_pk_mul_f32 v[110:111], v[110:111], v[238:239]
    v_pk_fma_f32 v[98:99], v[98:99], s[98:99], v[232:233]
    v_pk_fma_f32 v[102:103], v[102:103], s[98:99], v[234:235]
    v_pk_fma_f32 v[106:107], v[106:107], s[98:99], v[236:237]
    v_pk_fma_f32 v[110:111], v[110:111], s[98:99], v[238:239]
    v_cvt_pk_bf16_f32 v96, v98, v99
    v_cvt_pk_bf16_f32 v97, v102, v103
    v_cvt_pk_bf16_f32 v104, v106, v107
    v_cvt_pk_bf16_f32 v105, v110, v111
    ds_write_b64 v6, v[96:97] offset:39936
    ds_write_b64 v6, v[104:105] offset:58368
    v_pk_mul_f32 v[80:81], v[208:209], s[94:95]
    v_pk_mul_f32 v[84:85], v[210:211], s[94:95]
    v_pk_mul_f32 v[88:89], v[212:213], s[94:95]
    v_pk_mul_f32 v[92:93], v[214:215], s[94:95]
    v_exp_f32 v80, v80
    v_exp_f32 v81, v81
    v_exp_f32 v84, v84
    v_exp_f32 v85, v85
    v_exp_f32 v88, v88
    v_exp_f32 v89, v89
    v_exp_f32 v92, v92
    v_exp_f32 v93, v93
    v_pk_add_f32 v[82:83], v[80:81], s[96:97]
    v_pk_add_f32 v[86:87], v[84:85], s[96:97]
    v_pk_add_f32 v[90:91], v[88:89], s[96:97]
    v_pk_add_f32 v[94:95], v[92:93], s[96:97]
    v_pk_fma_f32 v[82:83], v[80:81], v[82:83], s[96:97]
    v_pk_fma_f32 v[86:87], v[84:85], v[86:87], s[96:97]
    v_pk_fma_f32 v[90:91], v[88:89], v[90:91], s[96:97]
    v_pk_fma_f32 v[94:95], v[92:93], v[94:95], s[96:97]
    v_rcp_f32 v82, v82
    v_rcp_f32 v83, v83
    v_rcp_f32 v86, v86
    v_rcp_f32 v87, v87
    v_rcp_f32 v90, v90
    v_rcp_f32 v91, v91
    v_rcp_f32 v94, v94
    v_rcp_f32 v95, v95
    v_pk_mul_f32 v[82:83], v[82:83], v[208:209]
    v_pk_mul_f32 v[86:87], v[86:87], v[210:211]
    v_pk_mul_f32 v[90:91], v[90:91], v[212:213]
    v_pk_mul_f32 v[94:95], v[94:95], v[214:215]
    v_pk_fma_f32 v[82:83], v[82:83], s[98:99], v[208:209]
    v_pk_fma_f32 v[86:87], v[86:87], s[98:99], v[210:211]
    v_pk_fma_f32 v[90:91], v[90:91], s[98:99], v[212:213]
    v_pk_fma_f32 v[94:95], v[94:95], s[98:99], v[214:215]
    v_cvt_pk_bf16_f32 v80, v82, v83
    v_cvt_pk_bf16_f32 v81, v86, v87
    v_cvt_pk_bf16_f32 v88, v90, v91
    v_cvt_pk_bf16_f32 v89, v94, v95
    ds_write_b64 v5, v[80:81] offset:3072
    ds_write_b64 v5, v[88:89] offset:21504
    v_pk_mul_f32 v[96:97], v[216:217], s[94:95]
    v_pk_mul_f32 v[100:101], v[218:219], s[94:95]
    v_pk_mul_f32 v[104:105], v[220:221], s[94:95]
    v_pk_mul_f32 v[108:109], v[222:223], s[94:95]
    v_exp_f32 v96, v96
    v_exp_f32 v97, v97
    v_exp_f32 v100, v100
    v_exp_f32 v101, v101
    v_exp_f32 v104, v104
    v_exp_f32 v105, v105
    v_exp_f32 v108, v108
    v_exp_f32 v109, v109
    v_pk_add_f32 v[98:99], v[96:97], s[96:97]
    v_pk_add_f32 v[102:103], v[100:101], s[96:97]
    v_pk_add_f32 v[106:107], v[104:105], s[96:97]
    v_pk_add_f32 v[110:111], v[108:109], s[96:97]
    v_pk_fma_f32 v[98:99], v[96:97], v[98:99], s[96:97]
    v_pk_fma_f32 v[102:103], v[100:101], v[102:103], s[96:97]
    v_pk_fma_f32 v[106:107], v[104:105], v[106:107], s[96:97]
    v_pk_fma_f32 v[110:111], v[108:109], v[110:111], s[96:97]
    v_rcp_f32 v98, v98
    v_rcp_f32 v99, v99
    v_rcp_f32 v102, v102
    v_rcp_f32 v103, v103
    v_rcp_f32 v106, v106
    v_rcp_f32 v107, v107
    v_rcp_f32 v110, v110
    v_rcp_f32 v111, v111
    v_pk_mul_f32 v[98:99], v[98:99], v[216:217]
    v_pk_mul_f32 v[102:103], v[102:103], v[218:219]
    v_pk_mul_f32 v[106:107], v[106:107], v[220:221]
    v_pk_mul_f32 v[110:111], v[110:111], v[222:223]
    v_pk_fma_f32 v[98:99], v[98:99], s[98:99], v[216:217]
    v_pk_fma_f32 v[102:103], v[102:103], s[98:99], v[218:219]
    v_pk_fma_f32 v[106:107], v[106:107], s[98:99], v[220:221]
    v_pk_fma_f32 v[110:111], v[110:111], s[98:99], v[222:223]
    v_cvt_pk_bf16_f32 v96, v98, v99
    v_cvt_pk_bf16_f32 v97, v102, v103
    v_cvt_pk_bf16_f32 v104, v106, v107
    v_cvt_pk_bf16_f32 v105, v110, v111
    ds_write_b64 v5, v[96:97] offset:39936
    ds_write_b64 v5, v[104:105] offset:58368
    s_add_u32 s93, s91, 6144
    buffer_load_dwordx4 v[208:211], v2, s[24:27], s93 offen
    s_add_u32 s93, s91, 153600
    buffer_load_dwordx4 v[212:215], v2, s[24:27], s93 offen
    s_add_u32 s93, s91, 301056
    buffer_load_dwordx4 v[216:219], v2, s[24:27], s93 offen
    s_add_u32 s93, s91, 7168
    buffer_load_dwordx4 v[220:223], v2, s[24:27], s93 offen
    s_add_u32 s93, s91, 154624
    buffer_load_dwordx4 v[224:227], v2, s[24:27], s93 offen
    s_add_u32 s93, s91, 302080
    buffer_load_dwordx4 v[228:231], v2, s[24:27], s93 offen
    s_add_u32 s93, s91, 8192
    buffer_load_dwordx4 v[232:235], v2, s[24:27], s93 offen
    s_add_u32 s93, s91, 155648
    buffer_load_dwordx4 v[236:239], v2, s[24:27], s93 offen
    s_add_u32 s93, s91, 303104
    buffer_load_dwordx4 v[240:243], v2, s[24:27], s93 offen
    s_add_u32 s93, s91, 9216
    buffer_load_dwordx4 v[244:247], v2, s[24:27], s93 offen
    s_add_u32 s93, s91, 156672
    buffer_load_dwordx4 v[248:251], v2, s[24:27], s93 offen
    s_add_u32 s93, s91, 304128
    buffer_load_dwordx4 v[252:255], v2, s[24:27], s93 offen
    v_pk_mul_f32 v[80:81], v[192:193], s[94:95]
    v_pk_mul_f32 v[84:85], v[194:195], s[94:95]
    v_pk_mul_f32 v[88:89], v[196:197], s[94:95]
    v_pk_mul_f32 v[92:93], v[198:199], s[94:95]
    v_exp_f32 v80, v80
    v_exp_f32 v81, v81
    v_exp_f32 v84, v84
    v_exp_f32 v85, v85
    v_exp_f32 v88, v88
    v_exp_f32 v89, v89
    v_exp_f32 v92, v92
    v_exp_f32 v93, v93
    v_pk_add_f32 v[82:83], v[80:81], s[96:97]
    v_pk_add_f32 v[86:87], v[84:85], s[96:97]
    v_pk_add_f32 v[90:91], v[88:89], s[96:97]
    v_pk_add_f32 v[94:95], v[92:93], s[96:97]
    v_pk_fma_f32 v[82:83], v[80:81], v[82:83], s[96:97]
    v_pk_fma_f32 v[86:87], v[84:85], v[86:87], s[96:97]
    v_pk_fma_f32 v[90:91], v[88:89], v[90:91], s[96:97]
    v_pk_fma_f32 v[94:95], v[92:93], v[94:95], s[96:97]
    v_rcp_f32 v82, v82
    v_rcp_f32 v83, v83
    v_rcp_f32 v86, v86
    v_rcp_f32 v87, v87
    v_rcp_f32 v90, v90
    v_rcp_f32 v91, v91
    v_rcp_f32 v94, v94
    v_rcp_f32 v95, v95
    v_pk_mul_f32 v[82:83], v[82:83], v[192:193]
    v_pk_mul_f32 v[86:87], v[86:87], v[194:195]
    v_pk_mul_f32 v[90:91], v[90:91], v[196:197]
    v_pk_mul_f32 v[94:95], v[94:95], v[198:199]
    v_pk_fma_f32 v[82:83], v[82:83], s[98:99], v[192:193]
    v_pk_fma_f32 v[86:87], v[86:87], s[98:99], v[194:195]
    v_pk_fma_f32 v[90:91], v[90:91], s[98:99], v[196:197]
    v_pk_fma_f32 v[94:95], v[94:95], s[98:99], v[198:199]
    v_cvt_pk_bf16_f32 v80, v82, v83
    v_cvt_pk_bf16_f32 v81, v86, v87
    v_cvt_pk_bf16_f32 v88, v90, v91
    v_cvt_pk_bf16_f32 v89, v94, v95
    ds_write_b64 v6, v[80:81] offset:2048
    ds_write_b64 v6, v[88:89] offset:20480
    v_pk_mul_f32 v[96:97], v[200:201], s[94:95]
    v_pk_mul_f32 v[100:101], v[202:203], s[94:95]
    v_pk_mul_f32 v[104:105], v[204:205], s[94:95]
    v_pk_mul_f32 v[108:109], v[206:207], s[94:95]
    v_exp_f32 v96, v96
    v_exp_f32 v97, v97
    v_exp_f32 v100, v100
    v_exp_f32 v101, v101
    v_exp_f32 v104, v104
    v_exp_f32 v105, v105
    v_exp_f32 v108, v108
    v_exp_f32 v109, v109
    v_pk_add_f32 v[98:99], v[96:97], s[96:97]
    v_pk_add_f32 v[102:103], v[100:101], s[96:97]
    v_pk_add_f32 v[106:107], v[104:105], s[96:97]
    v_pk_add_f32 v[110:111], v[108:109], s[96:97]
    v_pk_fma_f32 v[98:99], v[96:97], v[98:99], s[96:97]
    v_pk_fma_f32 v[102:103], v[100:101], v[102:103], s[96:97]
    v_pk_fma_f32 v[106:107], v[104:105], v[106:107], s[96:97]
    v_pk_fma_f32 v[110:111], v[108:109], v[110:111], s[96:97]
    v_rcp_f32 v98, v98
    v_rcp_f32 v99, v99
    v_rcp_f32 v102, v102
    v_rcp_f32 v103, v103
    v_rcp_f32 v106, v106
    v_rcp_f32 v107, v107
    v_rcp_f32 v110, v110
    v_rcp_f32 v111, v111
    v_pk_mul_f32 v[98:99], v[98:99], v[200:201]
    v_pk_mul_f32 v[102:103], v[102:103], v[202:203]
    v_pk_mul_f32 v[106:107], v[106:107], v[204:205]
    v_pk_mul_f32 v[110:111], v[110:111], v[206:207]
    v_pk_fma_f32 v[98:99], v[98:99], s[98:99], v[200:201]
    v_pk_fma_f32 v[102:103], v[102:103], s[98:99], v[202:203]
    v_pk_fma_f32 v[106:107], v[106:107], s[98:99], v[204:205]
    v_pk_fma_f32 v[110:111], v[110:111], s[98:99], v[206:207]
    v_cvt_pk_bf16_f32 v96, v98, v99
    v_cvt_pk_bf16_f32 v97, v102, v103
    v_cvt_pk_bf16_f32 v104, v106, v107
    v_cvt_pk_bf16_f32 v105, v110, v111
    ds_write_b64 v6, v[96:97] offset:38912
    ds_write_b64 v6, v[104:105] offset:57344
    v_pk_mul_f32 v[80:81], v[176:177], s[94:95]
    v_pk_mul_f32 v[84:85], v[178:179], s[94:95]
    v_pk_mul_f32 v[88:89], v[180:181], s[94:95]
    v_pk_mul_f32 v[92:93], v[182:183], s[94:95]
    v_exp_f32 v80, v80
    v_exp_f32 v81, v81
    v_exp_f32 v84, v84
    v_exp_f32 v85, v85
    v_exp_f32 v88, v88
    v_exp_f32 v89, v89
    v_exp_f32 v92, v92
    v_exp_f32 v93, v93
    v_pk_add_f32 v[82:83], v[80:81], s[96:97]
    v_pk_add_f32 v[86:87], v[84:85], s[96:97]
    v_pk_add_f32 v[90:91], v[88:89], s[96:97]
    v_pk_add_f32 v[94:95], v[92:93], s[96:97]
    v_pk_fma_f32 v[82:83], v[80:81], v[82:83], s[96:97]
    v_pk_fma_f32 v[86:87], v[84:85], v[86:87], s[96:97]
    v_pk_fma_f32 v[90:91], v[88:89], v[90:91], s[96:97]
    v_pk_fma_f32 v[94:95], v[92:93], v[94:95], s[96:97]
    v_rcp_f32 v82, v82
    v_rcp_f32 v83, v83
    v_rcp_f32 v86, v86
    v_rcp_f32 v87, v87
    v_rcp_f32 v90, v90
    v_rcp_f32 v91, v91
    v_rcp_f32 v94, v94
    v_rcp_f32 v95, v95
    v_pk_mul_f32 v[82:83], v[82:83], v[176:177]
    v_pk_mul_f32 v[86:87], v[86:87], v[178:179]
    v_pk_mul_f32 v[90:91], v[90:91], v[180:181]
    v_pk_mul_f32 v[94:95], v[94:95], v[182:183]
    v_pk_fma_f32 v[82:83], v[82:83], s[98:99], v[176:177]
    v_pk_fma_f32 v[86:87], v[86:87], s[98:99], v[178:179]
    v_pk_fma_f32 v[90:91], v[90:91], s[98:99], v[180:181]
    v_pk_fma_f32 v[94:95], v[94:95], s[98:99], v[182:183]
    v_cvt_pk_bf16_f32 v80, v82, v83
    v_cvt_pk_bf16_f32 v81, v86, v87
    v_cvt_pk_bf16_f32 v88, v90, v91
    v_cvt_pk_bf16_f32 v89, v94, v95
    ds_write_b64 v5, v[80:81] offset:2048
    ds_write_b64 v5, v[88:89] offset:20480
    v_pk_mul_f32 v[96:97], v[184:185], s[94:95]
    v_pk_mul_f32 v[100:101], v[186:187], s[94:95]
    v_pk_mul_f32 v[104:105], v[188:189], s[94:95]
    v_pk_mul_f32 v[108:109], v[190:191], s[94:95]
    v_exp_f32 v96, v96
    v_exp_f32 v97, v97
    v_exp_f32 v100, v100
    v_exp_f32 v101, v101
    v_exp_f32 v104, v104
    v_exp_f32 v105, v105
    v_exp_f32 v108, v108
    v_exp_f32 v109, v109
    v_pk_add_f32 v[98:99], v[96:97], s[96:97]
    v_pk_add_f32 v[102:103], v[100:101], s[96:97]
    v_pk_add_f32 v[106:107], v[104:105], s[96:97]
    v_pk_add_f32 v[110:111], v[108:109], s[96:97]
    v_pk_fma_f32 v[98:99], v[96:97], v[98:99], s[96:97]
    v_pk_fma_f32 v[102:103], v[100:101], v[102:103], s[96:97]
    v_pk_fma_f32 v[106:107], v[104:105], v[106:107], s[96:97]
    v_pk_fma_f32 v[110:111], v[108:109], v[110:111], s[96:97]
    v_rcp_f32 v98, v98
    v_rcp_f32 v99, v99
    v_rcp_f32 v102, v102
    v_rcp_f32 v103, v103
    v_rcp_f32 v106, v106
    v_rcp_f32 v107, v107
    v_rcp_f32 v110, v110
    v_rcp_f32 v111, v111
    v_pk_mul_f32 v[98:99], v[98:99], v[184:185]
    v_pk_mul_f32 v[102:103], v[102:103], v[186:187]
    v_pk_mul_f32 v[106:107], v[106:107], v[188:189]
    v_pk_mul_f32 v[110:111], v[110:111], v[190:191]
    v_pk_fma_f32 v[98:99], v[98:99], s[98:99], v[184:185]
    v_pk_fma_f32 v[102:103], v[102:103], s[98:99], v[186:187]
    v_pk_fma_f32 v[106:107], v[106:107], s[98:99], v[188:189]
    v_pk_fma_f32 v[110:111], v[110:111], s[98:99], v[190:191]
    v_cvt_pk_bf16_f32 v96, v98, v99
    v_cvt_pk_bf16_f32 v97, v102, v103
    v_cvt_pk_bf16_f32 v104, v106, v107
    v_cvt_pk_bf16_f32 v105, v110, v111
    ds_write_b64 v5, v[96:97] offset:38912
    ds_write_b64 v5, v[104:105] offset:57344
    v_pk_mul_f32 v[80:81], v[160:161], s[94:95]
    v_pk_mul_f32 v[84:85], v[162:163], s[94:95]
    v_pk_mul_f32 v[88:89], v[164:165], s[94:95]
    v_pk_mul_f32 v[92:93], v[166:167], s[94:95]
    v_exp_f32 v80, v80
    v_exp_f32 v81, v81
    v_exp_f32 v84, v84
    v_exp_f32 v85, v85
    v_exp_f32 v88, v88
    v_exp_f32 v89, v89
    v_exp_f32 v92, v92
    v_exp_f32 v93, v93
    v_pk_add_f32 v[82:83], v[80:81], s[96:97]
    v_pk_add_f32 v[86:87], v[84:85], s[96:97]
    v_pk_add_f32 v[90:91], v[88:89], s[96:97]
    v_pk_add_f32 v[94:95], v[92:93], s[96:97]
    v_pk_fma_f32 v[82:83], v[80:81], v[82:83], s[96:97]
    v_pk_fma_f32 v[86:87], v[84:85], v[86:87], s[96:97]
    v_pk_fma_f32 v[90:91], v[88:89], v[90:91], s[96:97]
    v_pk_fma_f32 v[94:95], v[92:93], v[94:95], s[96:97]
    v_rcp_f32 v82, v82
    v_rcp_f32 v83, v83
    v_rcp_f32 v86, v86
    v_rcp_f32 v87, v87
    v_rcp_f32 v90, v90
    v_rcp_f32 v91, v91
    v_rcp_f32 v94, v94
    v_rcp_f32 v95, v95
    v_pk_mul_f32 v[82:83], v[82:83], v[160:161]
    v_pk_mul_f32 v[86:87], v[86:87], v[162:163]
    v_pk_mul_f32 v[90:91], v[90:91], v[164:165]
    v_pk_mul_f32 v[94:95], v[94:95], v[166:167]
    v_pk_fma_f32 v[82:83], v[82:83], s[98:99], v[160:161]
    v_pk_fma_f32 v[86:87], v[86:87], s[98:99], v[162:163]
    v_pk_fma_f32 v[90:91], v[90:91], s[98:99], v[164:165]
    v_pk_fma_f32 v[94:95], v[94:95], s[98:99], v[166:167]
    v_cvt_pk_bf16_f32 v80, v82, v83
    v_cvt_pk_bf16_f32 v81, v86, v87
    v_cvt_pk_bf16_f32 v88, v90, v91
    v_cvt_pk_bf16_f32 v89, v94, v95
    ds_write_b64 v6, v[80:81] offset:1024
    ds_write_b64 v6, v[88:89] offset:19456
    v_pk_mul_f32 v[96:97], v[168:169], s[94:95]
    v_pk_mul_f32 v[100:101], v[170:171], s[94:95]
    v_pk_mul_f32 v[104:105], v[172:173], s[94:95]
    v_pk_mul_f32 v[108:109], v[174:175], s[94:95]
    v_exp_f32 v96, v96
    v_exp_f32 v97, v97
    v_exp_f32 v100, v100
    v_exp_f32 v101, v101
    v_exp_f32 v104, v104
    v_exp_f32 v105, v105
    v_exp_f32 v108, v108
    v_exp_f32 v109, v109
    v_pk_add_f32 v[98:99], v[96:97], s[96:97]
    v_pk_add_f32 v[102:103], v[100:101], s[96:97]
    v_pk_add_f32 v[106:107], v[104:105], s[96:97]
    v_pk_add_f32 v[110:111], v[108:109], s[96:97]
    v_pk_fma_f32 v[98:99], v[96:97], v[98:99], s[96:97]
    v_pk_fma_f32 v[102:103], v[100:101], v[102:103], s[96:97]
    v_pk_fma_f32 v[106:107], v[104:105], v[106:107], s[96:97]
    v_pk_fma_f32 v[110:111], v[108:109], v[110:111], s[96:97]
    v_rcp_f32 v98, v98
    v_rcp_f32 v99, v99
    v_rcp_f32 v102, v102
    v_rcp_f32 v103, v103
    v_rcp_f32 v106, v106
    v_rcp_f32 v107, v107
    v_rcp_f32 v110, v110
    v_rcp_f32 v111, v111
    v_pk_mul_f32 v[98:99], v[98:99], v[168:169]
    v_pk_mul_f32 v[102:103], v[102:103], v[170:171]
    v_pk_mul_f32 v[106:107], v[106:107], v[172:173]
    v_pk_mul_f32 v[110:111], v[110:111], v[174:175]
    v_pk_fma_f32 v[98:99], v[98:99], s[98:99], v[168:169]
    v_pk_fma_f32 v[102:103], v[102:103], s[98:99], v[170:171]
    v_pk_fma_f32 v[106:107], v[106:107], s[98:99], v[172:173]
    v_pk_fma_f32 v[110:111], v[110:111], s[98:99], v[174:175]
    v_cvt_pk_bf16_f32 v96, v98, v99
    v_cvt_pk_bf16_f32 v97, v102, v103
    v_cvt_pk_bf16_f32 v104, v106, v107
    v_cvt_pk_bf16_f32 v105, v110, v111
    ds_write_b64 v6, v[96:97] offset:37888
    ds_write_b64 v6, v[104:105] offset:56320
    v_pk_mul_f32 v[80:81], v[144:145], s[94:95]
    v_pk_mul_f32 v[84:85], v[146:147], s[94:95]
    v_pk_mul_f32 v[88:89], v[148:149], s[94:95]
    v_pk_mul_f32 v[92:93], v[150:151], s[94:95]
    v_exp_f32 v80, v80
    v_exp_f32 v81, v81
    v_exp_f32 v84, v84
    v_exp_f32 v85, v85
    v_exp_f32 v88, v88
    v_exp_f32 v89, v89
    v_exp_f32 v92, v92
    v_exp_f32 v93, v93
    v_pk_add_f32 v[82:83], v[80:81], s[96:97]
    v_pk_add_f32 v[86:87], v[84:85], s[96:97]
    v_pk_add_f32 v[90:91], v[88:89], s[96:97]
    v_pk_add_f32 v[94:95], v[92:93], s[96:97]
    v_pk_fma_f32 v[82:83], v[80:81], v[82:83], s[96:97]
    v_pk_fma_f32 v[86:87], v[84:85], v[86:87], s[96:97]
    v_pk_fma_f32 v[90:91], v[88:89], v[90:91], s[96:97]
    v_pk_fma_f32 v[94:95], v[92:93], v[94:95], s[96:97]
    v_rcp_f32 v82, v82
    v_rcp_f32 v83, v83
    v_rcp_f32 v86, v86
    v_rcp_f32 v87, v87
    v_rcp_f32 v90, v90
    v_rcp_f32 v91, v91
    v_rcp_f32 v94, v94
    v_rcp_f32 v95, v95
    v_pk_mul_f32 v[82:83], v[82:83], v[144:145]
    v_pk_mul_f32 v[86:87], v[86:87], v[146:147]
    v_pk_mul_f32 v[90:91], v[90:91], v[148:149]
    v_pk_mul_f32 v[94:95], v[94:95], v[150:151]
    v_pk_fma_f32 v[82:83], v[82:83], s[98:99], v[144:145]
    v_pk_fma_f32 v[86:87], v[86:87], s[98:99], v[146:147]
    v_pk_fma_f32 v[90:91], v[90:91], s[98:99], v[148:149]
    v_pk_fma_f32 v[94:95], v[94:95], s[98:99], v[150:151]
    v_cvt_pk_bf16_f32 v80, v82, v83
    v_cvt_pk_bf16_f32 v81, v86, v87
    v_cvt_pk_bf16_f32 v88, v90, v91
    v_cvt_pk_bf16_f32 v89, v94, v95
    ds_write_b64 v5, v[80:81] offset:1024
    ds_write_b64 v5, v[88:89] offset:19456
    v_pk_mul_f32 v[96:97], v[152:153], s[94:95]
    v_pk_mul_f32 v[100:101], v[154:155], s[94:95]
    v_pk_mul_f32 v[104:105], v[156:157], s[94:95]
    v_pk_mul_f32 v[108:109], v[158:159], s[94:95]
    v_exp_f32 v96, v96
    v_exp_f32 v97, v97
    v_exp_f32 v100, v100
    v_exp_f32 v101, v101
    v_exp_f32 v104, v104
    v_exp_f32 v105, v105
    v_exp_f32 v108, v108
    v_exp_f32 v109, v109
    v_pk_add_f32 v[98:99], v[96:97], s[96:97]
    v_pk_add_f32 v[102:103], v[100:101], s[96:97]
    v_pk_add_f32 v[106:107], v[104:105], s[96:97]
    v_pk_add_f32 v[110:111], v[108:109], s[96:97]
    v_pk_fma_f32 v[98:99], v[96:97], v[98:99], s[96:97]
    v_pk_fma_f32 v[102:103], v[100:101], v[102:103], s[96:97]
    v_pk_fma_f32 v[106:107], v[104:105], v[106:107], s[96:97]
    v_pk_fma_f32 v[110:111], v[108:109], v[110:111], s[96:97]
    v_rcp_f32 v98, v98
    v_rcp_f32 v99, v99
    v_rcp_f32 v102, v102
    v_rcp_f32 v103, v103
    v_rcp_f32 v106, v106
    v_rcp_f32 v107, v107
    v_rcp_f32 v110, v110
    v_rcp_f32 v111, v111
    v_pk_mul_f32 v[98:99], v[98:99], v[152:153]
    v_pk_mul_f32 v[102:103], v[102:103], v[154:155]
    v_pk_mul_f32 v[106:107], v[106:107], v[156:157]
    v_pk_mul_f32 v[110:111], v[110:111], v[158:159]
    v_pk_fma_f32 v[98:99], v[98:99], s[98:99], v[152:153]
    v_pk_fma_f32 v[102:103], v[102:103], s[98:99], v[154:155]
    v_pk_fma_f32 v[106:107], v[106:107], s[98:99], v[156:157]
    v_pk_fma_f32 v[110:111], v[110:111], s[98:99], v[158:159]
    v_cvt_pk_bf16_f32 v96, v98, v99
    v_cvt_pk_bf16_f32 v97, v102, v103
    v_cvt_pk_bf16_f32 v104, v106, v107
    v_cvt_pk_bf16_f32 v105, v110, v111
    ds_write_b64 v5, v[96:97] offset:37888
    ds_write_b64 v5, v[104:105] offset:56320
    v_pk_mul_f32 v[80:81], v[128:129], s[94:95]
    v_pk_mul_f32 v[84:85], v[130:131], s[94:95]
    v_pk_mul_f32 v[88:89], v[132:133], s[94:95]
    v_pk_mul_f32 v[92:93], v[134:135], s[94:95]
    v_exp_f32 v80, v80
    v_exp_f32 v81, v81
    v_exp_f32 v84, v84
    v_exp_f32 v85, v85
    v_exp_f32 v88, v88
    v_exp_f32 v89, v89
    v_exp_f32 v92, v92
    v_exp_f32 v93, v93
    v_pk_add_f32 v[82:83], v[80:81], s[96:97]
    v_pk_add_f32 v[86:87], v[84:85], s[96:97]
    v_pk_add_f32 v[90:91], v[88:89], s[96:97]
    v_pk_add_f32 v[94:95], v[92:93], s[96:97]
    v_pk_fma_f32 v[82:83], v[80:81], v[82:83], s[96:97]
    v_pk_fma_f32 v[86:87], v[84:85], v[86:87], s[96:97]
    v_pk_fma_f32 v[90:91], v[88:89], v[90:91], s[96:97]
    v_pk_fma_f32 v[94:95], v[92:93], v[94:95], s[96:97]
    v_rcp_f32 v82, v82
    v_rcp_f32 v83, v83
    v_rcp_f32 v86, v86
    v_rcp_f32 v87, v87
    v_rcp_f32 v90, v90
    v_rcp_f32 v91, v91
    v_rcp_f32 v94, v94
    v_rcp_f32 v95, v95
    v_pk_mul_f32 v[82:83], v[82:83], v[128:129]
    v_pk_mul_f32 v[86:87], v[86:87], v[130:131]
    v_pk_mul_f32 v[90:91], v[90:91], v[132:133]
    v_pk_mul_f32 v[94:95], v[94:95], v[134:135]
    v_pk_fma_f32 v[82:83], v[82:83], s[98:99], v[128:129]
    v_pk_fma_f32 v[86:87], v[86:87], s[98:99], v[130:131]
    v_pk_fma_f32 v[90:91], v[90:91], s[98:99], v[132:133]
    v_pk_fma_f32 v[94:95], v[94:95], s[98:99], v[134:135]
    v_cvt_pk_bf16_f32 v80, v82, v83
    v_cvt_pk_bf16_f32 v81, v86, v87
    v_cvt_pk_bf16_f32 v88, v90, v91
    v_cvt_pk_bf16_f32 v89, v94, v95
    ds_write_b64 v6, v[80:81] offset:0
    ds_write_b64 v6, v[88:89] offset:18432
    v_pk_mul_f32 v[96:97], v[136:137], s[94:95]
    v_pk_mul_f32 v[100:101], v[138:139], s[94:95]
    v_pk_mul_f32 v[104:105], v[140:141], s[94:95]
    v_pk_mul_f32 v[108:109], v[142:143], s[94:95]
    v_exp_f32 v96, v96
    v_exp_f32 v97, v97
    v_exp_f32 v100, v100
    v_exp_f32 v101, v101
    v_exp_f32 v104, v104
    v_exp_f32 v105, v105
    v_exp_f32 v108, v108
    v_exp_f32 v109, v109
    v_pk_add_f32 v[98:99], v[96:97], s[96:97]
    v_pk_add_f32 v[102:103], v[100:101], s[96:97]
    v_pk_add_f32 v[106:107], v[104:105], s[96:97]
    v_pk_add_f32 v[110:111], v[108:109], s[96:97]
    v_pk_fma_f32 v[98:99], v[96:97], v[98:99], s[96:97]
    v_pk_fma_f32 v[102:103], v[100:101], v[102:103], s[96:97]
    v_pk_fma_f32 v[106:107], v[104:105], v[106:107], s[96:97]
    v_pk_fma_f32 v[110:111], v[108:109], v[110:111], s[96:97]
    v_rcp_f32 v98, v98
    v_rcp_f32 v99, v99
    v_rcp_f32 v102, v102
    v_rcp_f32 v103, v103
    v_rcp_f32 v106, v106
    v_rcp_f32 v107, v107
    v_rcp_f32 v110, v110
    v_rcp_f32 v111, v111
    v_pk_mul_f32 v[98:99], v[98:99], v[136:137]
    v_pk_mul_f32 v[102:103], v[102:103], v[138:139]
    v_pk_mul_f32 v[106:107], v[106:107], v[140:141]
    v_pk_mul_f32 v[110:111], v[110:111], v[142:143]
    v_pk_fma_f32 v[98:99], v[98:99], s[98:99], v[136:137]
    v_pk_fma_f32 v[102:103], v[102:103], s[98:99], v[138:139]
    v_pk_fma_f32 v[106:107], v[106:107], s[98:99], v[140:141]
    v_pk_fma_f32 v[110:111], v[110:111], s[98:99], v[142:143]
    v_cvt_pk_bf16_f32 v96, v98, v99
    v_cvt_pk_bf16_f32 v97, v102, v103
    v_cvt_pk_bf16_f32 v104, v106, v107
    v_cvt_pk_bf16_f32 v105, v110, v111
    ds_write_b64 v6, v[96:97] offset:36864
    ds_write_b64 v6, v[104:105] offset:55296
    v_pk_mul_f32 v[80:81], v[112:113], s[94:95]
    v_pk_mul_f32 v[84:85], v[114:115], s[94:95]
    v_pk_mul_f32 v[88:89], v[116:117], s[94:95]
    v_pk_mul_f32 v[92:93], v[118:119], s[94:95]
    v_exp_f32 v80, v80
    v_exp_f32 v81, v81
    v_exp_f32 v84, v84
    v_exp_f32 v85, v85
    v_exp_f32 v88, v88
    v_exp_f32 v89, v89
    v_exp_f32 v92, v92
    v_exp_f32 v93, v93
    v_pk_add_f32 v[82:83], v[80:81], s[96:97]
    v_pk_add_f32 v[86:87], v[84:85], s[96:97]
    v_pk_add_f32 v[90:91], v[88:89], s[96:97]
    v_pk_add_f32 v[94:95], v[92:93], s[96:97]
    v_pk_fma_f32 v[82:83], v[80:81], v[82:83], s[96:97]
    v_pk_fma_f32 v[86:87], v[84:85], v[86:87], s[96:97]
    v_pk_fma_f32 v[90:91], v[88:89], v[90:91], s[96:97]
    v_pk_fma_f32 v[94:95], v[92:93], v[94:95], s[96:97]
    v_rcp_f32 v82, v82
    v_rcp_f32 v83, v83
    v_rcp_f32 v86, v86
    v_rcp_f32 v87, v87
    v_rcp_f32 v90, v90
    v_rcp_f32 v91, v91
    v_rcp_f32 v94, v94
    v_rcp_f32 v95, v95
    v_pk_mul_f32 v[82:83], v[82:83], v[112:113]
    v_pk_mul_f32 v[86:87], v[86:87], v[114:115]
    v_pk_mul_f32 v[90:91], v[90:91], v[116:117]
    v_pk_mul_f32 v[94:95], v[94:95], v[118:119]
    v_pk_fma_f32 v[82:83], v[82:83], s[98:99], v[112:113]
    v_pk_fma_f32 v[86:87], v[86:87], s[98:99], v[114:115]
    v_pk_fma_f32 v[90:91], v[90:91], s[98:99], v[116:117]
    v_pk_fma_f32 v[94:95], v[94:95], s[98:99], v[118:119]
    v_cvt_pk_bf16_f32 v80, v82, v83
    v_cvt_pk_bf16_f32 v81, v86, v87
    v_cvt_pk_bf16_f32 v88, v90, v91
    v_cvt_pk_bf16_f32 v89, v94, v95
    ds_write_b64 v5, v[80:81] offset:0
    ds_write_b64 v5, v[88:89] offset:18432
    v_pk_mul_f32 v[96:97], v[120:121], s[94:95]
    v_pk_mul_f32 v[100:101], v[122:123], s[94:95]
    v_pk_mul_f32 v[104:105], v[124:125], s[94:95]
    v_pk_mul_f32 v[108:109], v[126:127], s[94:95]
    v_exp_f32 v96, v96
    v_exp_f32 v97, v97
    v_exp_f32 v100, v100
    v_exp_f32 v101, v101
    v_exp_f32 v104, v104
    v_exp_f32 v105, v105
    v_exp_f32 v108, v108
    v_exp_f32 v109, v109
    v_pk_add_f32 v[98:99], v[96:97], s[96:97]
    v_pk_add_f32 v[102:103], v[100:101], s[96:97]
    v_pk_add_f32 v[106:107], v[104:105], s[96:97]
    v_pk_add_f32 v[110:111], v[108:109], s[96:97]
    v_pk_fma_f32 v[98:99], v[96:97], v[98:99], s[96:97]
    v_pk_fma_f32 v[102:103], v[100:101], v[102:103], s[96:97]
    v_pk_fma_f32 v[106:107], v[104:105], v[106:107], s[96:97]
    v_pk_fma_f32 v[110:111], v[108:109], v[110:111], s[96:97]
    v_rcp_f32 v98, v98
    v_rcp_f32 v99, v99
    v_rcp_f32 v102, v102
    v_rcp_f32 v103, v103
    v_rcp_f32 v106, v106
    v_rcp_f32 v107, v107
    v_rcp_f32 v110, v110
    v_rcp_f32 v111, v111
    v_pk_mul_f32 v[98:99], v[98:99], v[120:121]
    v_pk_mul_f32 v[102:103], v[102:103], v[122:123]
    v_pk_mul_f32 v[106:107], v[106:107], v[124:125]
    v_pk_mul_f32 v[110:111], v[110:111], v[126:127]
    v_pk_fma_f32 v[98:99], v[98:99], s[98:99], v[120:121]
    v_pk_fma_f32 v[102:103], v[102:103], s[98:99], v[122:123]
    v_pk_fma_f32 v[106:107], v[106:107], s[98:99], v[124:125]
    v_pk_fma_f32 v[110:111], v[110:111], s[98:99], v[126:127]
    v_cvt_pk_bf16_f32 v96, v98, v99
    v_cvt_pk_bf16_f32 v97, v102, v103
    v_cvt_pk_bf16_f32 v104, v106, v107
    v_cvt_pk_bf16_f32 v105, v110, v111
    ds_write_b64 v5, v[96:97] offset:36864
    ds_write_b64 v5, v[104:105] offset:55296
    s_waitcnt lgkmcnt(0)
    s_barrier
    ds_read_b128 v[80:83], v2 offset:0
    ds_read_b128 v[84:87], v2 offset:18432
    ds_read_b128 v[88:91], v3 offset:0
    ds_read_b128 v[92:95], v3 offset:18432
    s_waitcnt lgkmcnt(0)
    ds_read_b128 v[96:99], v2 offset:1024
    ds_read_b128 v[100:103], v2 offset:19456
    ds_read_b128 v[104:107], v3 offset:1024
    ds_read_b128 v[108:111], v3 offset:19456
    s_waitcnt vmcnt(29)
    v_mfma_f32_16x16x32_bf16 v[112:115], v[8:11], v[80:83], 0
    v_mfma_f32_16x16x32_bf16 v[116:119], v[8:11], v[84:87], 0
    v_mfma_f32_16x16x32_bf16 v[120:123], v[8:11], v[88:91], 0
    v_mfma_f32_16x16x32_bf16 v[124:127], v[8:11], v[92:95], 0
    s_add_u32 s93, s91, 10240
    buffer_load_dwordx4 v[8:11], v2, s[24:27], s93 offen
    s_waitcnt vmcnt(29)
    v_mfma_f32_16x16x32_bf16 v[128:131], v[12:15], v[80:83], 0
    v_mfma_f32_16x16x32_bf16 v[132:135], v[12:15], v[84:87], 0
    v_mfma_f32_16x16x32_bf16 v[136:139], v[12:15], v[88:91], 0
    v_mfma_f32_16x16x32_bf16 v[140:143], v[12:15], v[92:95], 0
    s_add_u32 s93, s91, 157696
    buffer_load_dwordx4 v[12:15], v2, s[24:27], s93 offen
    s_waitcnt vmcnt(29)
    v_mfma_f32_16x16x32_bf16 v[144:147], v[16:19], v[80:83], 0
    v_mfma_f32_16x16x32_bf16 v[148:151], v[16:19], v[84:87], 0
    v_mfma_f32_16x16x32_bf16 v[152:155], v[16:19], v[88:91], 0
    v_mfma_f32_16x16x32_bf16 v[156:159], v[16:19], v[92:95], 0
    s_add_u32 s93, s91, 305152
    buffer_load_dwordx4 v[16:19], v2, s[24:27], s93 offen
    s_waitcnt lgkmcnt(0)
    ds_read_b128 v[80:83], v2 offset:2048
    ds_read_b128 v[84:87], v2 offset:20480
    ds_read_b128 v[88:91], v3 offset:2048
    ds_read_b128 v[92:95], v3 offset:20480
    s_waitcnt vmcnt(29)
    v_mfma_f32_16x16x32_bf16 v[112:115], v[20:23], v[96:99], v[112:115]
    v_mfma_f32_16x16x32_bf16 v[116:119], v[20:23], v[100:103], v[116:119]
    v_mfma_f32_16x16x32_bf16 v[120:123], v[20:23], v[104:107], v[120:123]
    v_mfma_f32_16x16x32_bf16 v[124:127], v[20:23], v[108:111], v[124:127]
    s_add_u32 s93, s91, 11264
    buffer_load_dwordx4 v[20:23], v2, s[24:27], s93 offen
    s_waitcnt vmcnt(29)
    v_mfma_f32_16x16x32_bf16 v[128:131], v[24:27], v[96:99], v[128:131]
    v_mfma_f32_16x16x32_bf16 v[132:135], v[24:27], v[100:103], v[132:135]
    v_mfma_f32_16x16x32_bf16 v[136:139], v[24:27], v[104:107], v[136:139]
    v_mfma_f32_16x16x32_bf16 v[140:143], v[24:27], v[108:111], v[140:143]
    s_add_u32 s93, s91, 158720
    buffer_load_dwordx4 v[24:27], v2, s[24:27], s93 offen
    s_waitcnt vmcnt(29)
    v_mfma_f32_16x16x32_bf16 v[144:147], v[28:31], v[96:99], v[144:147]
    v_mfma_f32_16x16x32_bf16 v[148:151], v[28:31], v[100:103], v[148:151]
    v_mfma_f32_16x16x32_bf16 v[152:155], v[28:31], v[104:107], v[152:155]
    v_mfma_f32_16x16x32_bf16 v[156:159], v[28:31], v[108:111], v[156:159]
    s_add_u32 s93, s91, 306176
    buffer_load_dwordx4 v[28:31], v2, s[24:27], s93 offen
    s_waitcnt lgkmcnt(0)
    ds_read_b128 v[96:99], v2 offset:3072
    ds_read_b128 v[100:103], v2 offset:21504
    ds_read_b128 v[104:107], v3 offset:3072
    ds_read_b128 v[108:111], v3 offset:21504
    s_waitcnt vmcnt(29)
    v_mfma_f32_16x16x32_bf16 v[112:115], v[32:35], v[80:83], v[112:115]
    v_mfma_f32_16x16x32_bf16 v[116:119], v[32:35], v[84:87], v[116:119]
    v_mfma_f32_16x16x32_bf16 v[120:123], v[32:35], v[88:91], v[120:123]
    v_mfma_f32_16x16x32_bf16 v[124:127], v[32:35], v[92:95], v[124:127]
    s_add_u32 s93, s91, 12288
    buffer_load_dwordx4 v[32:35], v2, s[24:27], s93 offen
    s_waitcnt vmcnt(29)
    v_mfma_f32_16x16x32_bf16 v[128:131], v[36:39], v[80:83], v[128:131]
    v_mfma_f32_16x16x32_bf16 v[132:135], v[36:39], v[84:87], v[132:135]
    v_mfma_f32_16x16x32_bf16 v[136:139], v[36:39], v[88:91], v[136:139]
    v_mfma_f32_16x16x32_bf16 v[140:143], v[36:39], v[92:95], v[140:143]
    s_add_u32 s93, s91, 159744
    buffer_load_dwordx4 v[36:39], v2, s[24:27], s93 offen
    s_waitcnt vmcnt(29)
    v_mfma_f32_16x16x32_bf16 v[144:147], v[40:43], v[80:83], v[144:147]
    v_mfma_f32_16x16x32_bf16 v[148:151], v[40:43], v[84:87], v[148:151]
    v_mfma_f32_16x16x32_bf16 v[152:155], v[40:43], v[88:91], v[152:155]
    v_mfma_f32_16x16x32_bf16 v[156:159], v[40:43], v[92:95], v[156:159]
    s_add_u32 s93, s91, 307200
    buffer_load_dwordx4 v[40:43], v2, s[24:27], s93 offen
    s_waitcnt lgkmcnt(0)
    ds_read_b128 v[80:83], v2 offset:4096
    ds_read_b128 v[84:87], v2 offset:22528
    ds_read_b128 v[88:91], v3 offset:4096
    ds_read_b128 v[92:95], v3 offset:22528
    s_waitcnt vmcnt(29)
    v_mfma_f32_16x16x32_bf16 v[112:115], v[44:47], v[96:99], v[112:115]
    v_mfma_f32_16x16x32_bf16 v[116:119], v[44:47], v[100:103], v[116:119]
    v_mfma_f32_16x16x32_bf16 v[120:123], v[44:47], v[104:107], v[120:123]
    v_mfma_f32_16x16x32_bf16 v[124:127], v[44:47], v[108:111], v[124:127]
    s_add_u32 s93, s91, 13312
    buffer_load_dwordx4 v[44:47], v2, s[24:27], s93 offen
    s_waitcnt vmcnt(29)
    v_mfma_f32_16x16x32_bf16 v[128:131], v[48:51], v[96:99], v[128:131]
    v_mfma_f32_16x16x32_bf16 v[132:135], v[48:51], v[100:103], v[132:135]
    v_mfma_f32_16x16x32_bf16 v[136:139], v[48:51], v[104:107], v[136:139]
    v_mfma_f32_16x16x32_bf16 v[140:143], v[48:51], v[108:111], v[140:143]
    s_add_u32 s93, s91, 160768
    buffer_load_dwordx4 v[48:51], v2, s[24:27], s93 offen
    s_waitcnt vmcnt(29)
    v_mfma_f32_16x16x32_bf16 v[144:147], v[52:55], v[96:99], v[144:147]
    v_mfma_f32_16x16x32_bf16 v[148:151], v[52:55], v[100:103], v[148:151]
    v_mfma_f32_16x16x32_bf16 v[152:155], v[52:55], v[104:107], v[152:155]
    v_mfma_f32_16x16x32_bf16 v[156:159], v[52:55], v[108:111], v[156:159]
    s_add_u32 s93, s91, 308224
    buffer_load_dwordx4 v[52:55], v2, s[24:27], s93 offen
    s_waitcnt lgkmcnt(0)
    ds_read_b128 v[96:99], v2 offset:5120
    ds_read_b128 v[100:103], v2 offset:23552
    ds_read_b128 v[104:107], v3 offset:5120
    ds_read_b128 v[108:111], v3 offset:23552
    s_waitcnt vmcnt(29)
    v_mfma_f32_16x16x32_bf16 v[112:115], v[56:59], v[80:83], v[112:115]
    v_mfma_f32_16x16x32_bf16 v[116:119], v[56:59], v[84:87], v[116:119]
    v_mfma_f32_16x16x32_bf16 v[120:123], v[56:59], v[88:91], v[120:123]
    v_mfma_f32_16x16x32_bf16 v[124:127], v[56:59], v[92:95], v[124:127]
    s_add_u32 s93, s91, 14336
    buffer_load_dwordx4 v[56:59], v2, s[24:27], s93 offen
    s_waitcnt vmcnt(29)
    v_mfma_f32_16x16x32_bf16 v[128:131], v[60:63], v[80:83], v[128:131]
    v_mfma_f32_16x16x32_bf16 v[132:135], v[60:63], v[84:87], v[132:135]
    v_mfma_f32_16x16x32_bf16 v[136:139], v[60:63], v[88:91], v[136:139]
    v_mfma_f32_16x16x32_bf16 v[140:143], v[60:63], v[92:95], v[140:143]
    s_add_u32 s93, s91, 161792
    buffer_load_dwordx4 v[60:63], v2, s[24:27], s93 offen
    s_waitcnt vmcnt(29)
    v_mfma_f32_16x16x32_bf16 v[144:147], v[64:67], v[80:83], v[144:147]
    v_mfma_f32_16x16x32_bf16 v[148:151], v[64:67], v[84:87], v[148:151]
    v_mfma_f32_16x16x32_bf16 v[152:155], v[64:67], v[88:91], v[152:155]
    v_mfma_f32_16x16x32_bf16 v[156:159], v[64:67], v[92:95], v[156:159]
    s_add_u32 s93, s91, 309248
    buffer_load_dwordx4 v[64:67], v2, s[24:27], s93 offen
    s_waitcnt lgkmcnt(0)
    ds_read_b128 v[80:83], v2 offset:6144
    ds_read_b128 v[84:87], v2 offset:24576
    ds_read_b128 v[88:91], v3 offset:6144
    ds_read_b128 v[92:95], v3 offset:24576
    s_waitcnt vmcnt(29)
    v_mfma_f32_16x16x32_bf16 v[112:115], v[68:71], v[96:99], v[112:115]
    v_mfma_f32_16x16x32_bf16 v[116:119], v[68:71], v[100:103], v[116:119]
    v_mfma_f32_16x16x32_bf16 v[120:123], v[68:71], v[104:107], v[120:123]
    v_mfma_f32_16x16x32_bf16 v[124:127], v[68:71], v[108:111], v[124:127]
    s_add_u32 s93, s91, 15360
    buffer_load_dwordx4 v[68:71], v2, s[24:27], s93 offen
    s_waitcnt vmcnt(29)
    v_mfma_f32_16x16x32_bf16 v[128:131], v[72:75], v[96:99], v[128:131]
    v_mfma_f32_16x16x32_bf16 v[132:135], v[72:75], v[100:103], v[132:135]
    v_mfma_f32_16x16x32_bf16 v[136:139], v[72:75], v[104:107], v[136:139]
    v_mfma_f32_16x16x32_bf16 v[140:143], v[72:75], v[108:111], v[140:143]
    s_add_u32 s93, s91, 162816
    buffer_load_dwordx4 v[72:75], v2, s[24:27], s93 offen
    s_waitcnt vmcnt(29)
    v_mfma_f32_16x16x32_bf16 v[144:147], v[76:79], v[96:99], v[144:147]
    v_mfma_f32_16x16x32_bf16 v[148:151], v[76:79], v[100:103], v[148:151]
    v_mfma_f32_16x16x32_bf16 v[152:155], v[76:79], v[104:107], v[152:155]
    v_mfma_f32_16x16x32_bf16 v[156:159], v[76:79], v[108:111], v[156:159]
    s_add_u32 s93, s91, 310272
    buffer_load_dwordx4 v[76:79], v2, s[24:27], s93 offen
    s_waitcnt lgkmcnt(0)
    ds_read_b128 v[96:99], v2 offset:7168
    ds_read_b128 v[100:103], v2 offset:25600
    ds_read_b128 v[104:107], v3 offset:7168
    ds_read_b128 v[108:111], v3 offset:25600
    s_waitcnt vmcnt(29)
    v_mfma_f32_16x16x32_bf16 v[112:115], v[208:211], v[80:83], v[112:115]
    v_mfma_f32_16x16x32_bf16 v[116:119], v[208:211], v[84:87], v[116:119]
    v_mfma_f32_16x16x32_bf16 v[120:123], v[208:211], v[88:91], v[120:123]
    v_mfma_f32_16x16x32_bf16 v[124:127], v[208:211], v[92:95], v[124:127]
    s_add_u32 s93, s91, 16384
    buffer_load_dwordx4 v[208:211], v2, s[24:27], s93 offen
    s_waitcnt vmcnt(29)
    v_mfma_f32_16x16x32_bf16 v[128:131], v[212:215], v[80:83], v[128:131]
    v_mfma_f32_16x16x32_bf16 v[132:135], v[212:215], v[84:87], v[132:135]
    v_mfma_f32_16x16x32_bf16 v[136:139], v[212:215], v[88:91], v[136:139]
    v_mfma_f32_16x16x32_bf16 v[140:143], v[212:215], v[92:95], v[140:143]
    s_add_u32 s93, s91, 163840
    buffer_load_dwordx4 v[212:215], v2, s[24:27], s93 offen
    s_waitcnt vmcnt(29)
    v_mfma_f32_16x16x32_bf16 v[144:147], v[216:219], v[80:83], v[144:147]
    v_mfma_f32_16x16x32_bf16 v[148:151], v[216:219], v[84:87], v[148:151]
    v_mfma_f32_16x16x32_bf16 v[152:155], v[216:219], v[88:91], v[152:155]
    v_mfma_f32_16x16x32_bf16 v[156:159], v[216:219], v[92:95], v[156:159]
    s_add_u32 s93, s91, 311296
    buffer_load_dwordx4 v[216:219], v2, s[24:27], s93 offen
    s_waitcnt lgkmcnt(0)
    ds_read_b128 v[80:83], v2 offset:8192
    ds_read_b128 v[84:87], v2 offset:26624
    ds_read_b128 v[88:91], v3 offset:8192
    ds_read_b128 v[92:95], v3 offset:26624
    s_waitcnt vmcnt(29)
    v_mfma_f32_16x16x32_bf16 v[112:115], v[220:223], v[96:99], v[112:115]
    v_mfma_f32_16x16x32_bf16 v[116:119], v[220:223], v[100:103], v[116:119]
    v_mfma_f32_16x16x32_bf16 v[120:123], v[220:223], v[104:107], v[120:123]
    v_mfma_f32_16x16x32_bf16 v[124:127], v[220:223], v[108:111], v[124:127]
    s_add_u32 s93, s91, 17408
    buffer_load_dwordx4 v[220:223], v2, s[24:27], s93 offen
    s_waitcnt vmcnt(29)
    v_mfma_f32_16x16x32_bf16 v[128:131], v[224:227], v[96:99], v[128:131]
    v_mfma_f32_16x16x32_bf16 v[132:135], v[224:227], v[100:103], v[132:135]
    v_mfma_f32_16x16x32_bf16 v[136:139], v[224:227], v[104:107], v[136:139]
    v_mfma_f32_16x16x32_bf16 v[140:143], v[224:227], v[108:111], v[140:143]
    s_add_u32 s93, s91, 164864
    buffer_load_dwordx4 v[224:227], v2, s[24:27], s93 offen
    s_waitcnt vmcnt(29)
    v_mfma_f32_16x16x32_bf16 v[144:147], v[228:231], v[96:99], v[144:147]
    v_mfma_f32_16x16x32_bf16 v[148:151], v[228:231], v[100:103], v[148:151]
    v_mfma_f32_16x16x32_bf16 v[152:155], v[228:231], v[104:107], v[152:155]
    v_mfma_f32_16x16x32_bf16 v[156:159], v[228:231], v[108:111], v[156:159]
    s_add_u32 s93, s91, 312320
    buffer_load_dwordx4 v[228:231], v2, s[24:27], s93 offen
    s_waitcnt lgkmcnt(0)
    ds_read_b128 v[96:99], v2 offset:9216
    ds_read_b128 v[100:103], v2 offset:27648
    ds_read_b128 v[104:107], v3 offset:9216
    ds_read_b128 v[108:111], v3 offset:27648
    s_waitcnt vmcnt(29)
    v_mfma_f32_16x16x32_bf16 v[112:115], v[232:235], v[80:83], v[112:115]
    v_mfma_f32_16x16x32_bf16 v[116:119], v[232:235], v[84:87], v[116:119]
    v_mfma_f32_16x16x32_bf16 v[120:123], v[232:235], v[88:91], v[120:123]
    v_mfma_f32_16x16x32_bf16 v[124:127], v[232:235], v[92:95], v[124:127]
    s_add_u32 s93, s91, 442368
    buffer_load_dwordx4 v[232:235], v2, s[24:27], s93 offen
    s_waitcnt vmcnt(29)
    v_mfma_f32_16x16x32_bf16 v[128:131], v[236:239], v[80:83], v[128:131]
    v_mfma_f32_16x16x32_bf16 v[132:135], v[236:239], v[84:87], v[132:135]
    v_mfma_f32_16x16x32_bf16 v[136:139], v[236:239], v[88:91], v[136:139]
    v_mfma_f32_16x16x32_bf16 v[140:143], v[236:239], v[92:95], v[140:143]
    s_add_u32 s93, s91, 589824
    buffer_load_dwordx4 v[236:239], v2, s[24:27], s93 offen
    s_waitcnt vmcnt(29)
    v_mfma_f32_16x16x32_bf16 v[144:147], v[240:243], v[80:83], v[144:147]
    v_mfma_f32_16x16x32_bf16 v[148:151], v[240:243], v[84:87], v[148:151]
    v_mfma_f32_16x16x32_bf16 v[152:155], v[240:243], v[88:91], v[152:155]
    v_mfma_f32_16x16x32_bf16 v[156:159], v[240:243], v[92:95], v[156:159]
    s_add_u32 s93, s91, 737280
    buffer_load_dwordx4 v[240:243], v2, s[24:27], s93 offen
    s_waitcnt lgkmcnt(0)
    ds_read_b128 v[80:83], v2 offset:10240
    ds_read_b128 v[84:87], v2 offset:28672
    ds_read_b128 v[88:91], v3 offset:10240
    ds_read_b128 v[92:95], v3 offset:28672
    s_waitcnt vmcnt(29)
    v_mfma_f32_16x16x32_bf16 v[112:115], v[244:247], v[96:99], v[112:115]
    v_mfma_f32_16x16x32_bf16 v[116:119], v[244:247], v[100:103], v[116:119]
    v_mfma_f32_16x16x32_bf16 v[120:123], v[244:247], v[104:107], v[120:123]
    v_mfma_f32_16x16x32_bf16 v[124:127], v[244:247], v[108:111], v[124:127]
    s_add_u32 s93, s91, 443392
    buffer_load_dwordx4 v[244:247], v2, s[24:27], s93 offen
    s_waitcnt vmcnt(29)
    v_mfma_f32_16x16x32_bf16 v[128:131], v[248:251], v[96:99], v[128:131]
    v_mfma_f32_16x16x32_bf16 v[132:135], v[248:251], v[100:103], v[132:135]
    v_mfma_f32_16x16x32_bf16 v[136:139], v[248:251], v[104:107], v[136:139]
    v_mfma_f32_16x16x32_bf16 v[140:143], v[248:251], v[108:111], v[140:143]
    s_add_u32 s93, s91, 590848
    buffer_load_dwordx4 v[248:251], v2, s[24:27], s93 offen
    s_waitcnt vmcnt(29)
    v_mfma_f32_16x16x32_bf16 v[144:147], v[252:255], v[96:99], v[144:147]
    v_mfma_f32_16x16x32_bf16 v[148:151], v[252:255], v[100:103], v[148:151]
    v_mfma_f32_16x16x32_bf16 v[152:155], v[252:255], v[104:107], v[152:155]
    v_mfma_f32_16x16x32_bf16 v[156:159], v[252:255], v[108:111], v[156:159]
    s_add_u32 s93, s91, 738304
    buffer_load_dwordx4 v[252:255], v2, s[24:27], s93 offen
    s_waitcnt lgkmcnt(0)
    ds_read_b128 v[96:99], v2 offset:11264
    ds_read_b128 v[100:103], v2 offset:29696
    ds_read_b128 v[104:107], v3 offset:11264
    ds_read_b128 v[108:111], v3 offset:29696
    s_waitcnt vmcnt(29)
    v_mfma_f32_16x16x32_bf16 v[112:115], v[8:11], v[80:83], v[112:115]
    v_mfma_f32_16x16x32_bf16 v[116:119], v[8:11], v[84:87], v[116:119]
    v_mfma_f32_16x16x32_bf16 v[120:123], v[8:11], v[88:91], v[120:123]
    v_mfma_f32_16x16x32_bf16 v[124:127], v[8:11], v[92:95], v[124:127]
    s_add_u32 s93, s91, 444416
    buffer_load_dwordx4 v[8:11], v2, s[24:27], s93 offen
    s_waitcnt vmcnt(29)
    v_mfma_f32_16x16x32_bf16 v[128:131], v[12:15], v[80:83], v[128:131]
    v_mfma_f32_16x16x32_bf16 v[132:135], v[12:15], v[84:87], v[132:135]
    v_mfma_f32_16x16x32_bf16 v[136:139], v[12:15], v[88:91], v[136:139]
    v_mfma_f32_16x16x32_bf16 v[140:143], v[12:15], v[92:95], v[140:143]
    s_add_u32 s93, s91, 591872
    buffer_load_dwordx4 v[12:15], v2, s[24:27], s93 offen
    s_waitcnt vmcnt(29)
    v_mfma_f32_16x16x32_bf16 v[144:147], v[16:19], v[80:83], v[144:147]
    v_mfma_f32_16x16x32_bf16 v[148:151], v[16:19], v[84:87], v[148:151]
    v_mfma_f32_16x16x32_bf16 v[152:155], v[16:19], v[88:91], v[152:155]
    v_mfma_f32_16x16x32_bf16 v[156:159], v[16:19], v[92:95], v[156:159]
    s_add_u32 s93, s91, 739328
    buffer_load_dwordx4 v[16:19], v2, s[24:27], s93 offen
    s_waitcnt lgkmcnt(0)
    ds_read_b128 v[80:83], v2 offset:12288
    ds_read_b128 v[84:87], v2 offset:30720
    ds_read_b128 v[88:91], v3 offset:12288
    ds_read_b128 v[92:95], v3 offset:30720
    s_waitcnt vmcnt(29)
    v_mfma_f32_16x16x32_bf16 v[112:115], v[20:23], v[96:99], v[112:115]
    v_mfma_f32_16x16x32_bf16 v[116:119], v[20:23], v[100:103], v[116:119]
    v_mfma_f32_16x16x32_bf16 v[120:123], v[20:23], v[104:107], v[120:123]
    v_mfma_f32_16x16x32_bf16 v[124:127], v[20:23], v[108:111], v[124:127]
    s_add_u32 s93, s91, 445440
    buffer_load_dwordx4 v[20:23], v2, s[24:27], s93 offen
    s_waitcnt vmcnt(29)
    v_mfma_f32_16x16x32_bf16 v[128:131], v[24:27], v[96:99], v[128:131]
    v_mfma_f32_16x16x32_bf16 v[132:135], v[24:27], v[100:103], v[132:135]
    v_mfma_f32_16x16x32_bf16 v[136:139], v[24:27], v[104:107], v[136:139]
    v_mfma_f32_16x16x32_bf16 v[140:143], v[24:27], v[108:111], v[140:143]
    s_add_u32 s93, s91, 592896
    buffer_load_dwordx4 v[24:27], v2, s[24:27], s93 offen
    s_waitcnt vmcnt(29)
    v_mfma_f32_16x16x32_bf16 v[144:147], v[28:31], v[96:99], v[144:147]
    v_mfma_f32_16x16x32_bf16 v[148:151], v[28:31], v[100:103], v[148:151]
    v_mfma_f32_16x16x32_bf16 v[152:155], v[28:31], v[104:107], v[152:155]
    v_mfma_f32_16x16x32_bf16 v[156:159], v[28:31], v[108:111], v[156:159]
    s_add_u32 s93, s91, 740352
    buffer_load_dwordx4 v[28:31], v2, s[24:27], s93 offen
    s_waitcnt lgkmcnt(0)
    ds_read_b128 v[96:99], v2 offset:13312
    ds_read_b128 v[100:103], v2 offset:31744
    ds_read_b128 v[104:107], v3 offset:13312
    ds_read_b128 v[108:111], v3 offset:31744
    s_waitcnt vmcnt(29)
    v_mfma_f32_16x16x32_bf16 v[112:115], v[32:35], v[80:83], v[112:115]
    v_mfma_f32_16x16x32_bf16 v[116:119], v[32:35], v[84:87], v[116:119]
    v_mfma_f32_16x16x32_bf16 v[120:123], v[32:35], v[88:91], v[120:123]
    v_mfma_f32_16x16x32_bf16 v[124:127], v[32:35], v[92:95], v[124:127]
    s_add_u32 s93, s91, 446464
    buffer_load_dwordx4 v[32:35], v2, s[24:27], s93 offen
    s_waitcnt vmcnt(29)
    v_mfma_f32_16x16x32_bf16 v[128:131], v[36:39], v[80:83], v[128:131]
    v_mfma_f32_16x16x32_bf16 v[132:135], v[36:39], v[84:87], v[132:135]
    v_mfma_f32_16x16x32_bf16 v[136:139], v[36:39], v[88:91], v[136:139]
    v_mfma_f32_16x16x32_bf16 v[140:143], v[36:39], v[92:95], v[140:143]
    s_add_u32 s93, s91, 593920
    buffer_load_dwordx4 v[36:39], v2, s[24:27], s93 offen
    s_waitcnt vmcnt(29)
    v_mfma_f32_16x16x32_bf16 v[144:147], v[40:43], v[80:83], v[144:147]
    v_mfma_f32_16x16x32_bf16 v[148:151], v[40:43], v[84:87], v[148:151]
    v_mfma_f32_16x16x32_bf16 v[152:155], v[40:43], v[88:91], v[152:155]
    v_mfma_f32_16x16x32_bf16 v[156:159], v[40:43], v[92:95], v[156:159]
    s_add_u32 s93, s91, 741376
    buffer_load_dwordx4 v[40:43], v2, s[24:27], s93 offen
    s_waitcnt lgkmcnt(0)
    ds_read_b128 v[80:83], v2 offset:14336
    ds_read_b128 v[84:87], v2 offset:32768
    ds_read_b128 v[88:91], v3 offset:14336
    ds_read_b128 v[92:95], v3 offset:32768
    s_waitcnt vmcnt(29)
    v_mfma_f32_16x16x32_bf16 v[112:115], v[44:47], v[96:99], v[112:115]
    v_mfma_f32_16x16x32_bf16 v[116:119], v[44:47], v[100:103], v[116:119]
    v_mfma_f32_16x16x32_bf16 v[120:123], v[44:47], v[104:107], v[120:123]
    v_mfma_f32_16x16x32_bf16 v[124:127], v[44:47], v[108:111], v[124:127]
    s_add_u32 s93, s91, 447488
    buffer_load_dwordx4 v[44:47], v2, s[24:27], s93 offen
    s_waitcnt vmcnt(29)
    v_mfma_f32_16x16x32_bf16 v[128:131], v[48:51], v[96:99], v[128:131]
    v_mfma_f32_16x16x32_bf16 v[132:135], v[48:51], v[100:103], v[132:135]
    v_mfma_f32_16x16x32_bf16 v[136:139], v[48:51], v[104:107], v[136:139]
    v_mfma_f32_16x16x32_bf16 v[140:143], v[48:51], v[108:111], v[140:143]
    s_add_u32 s93, s91, 594944
    buffer_load_dwordx4 v[48:51], v2, s[24:27], s93 offen
    s_waitcnt vmcnt(29)
    v_mfma_f32_16x16x32_bf16 v[144:147], v[52:55], v[96:99], v[144:147]
    v_mfma_f32_16x16x32_bf16 v[148:151], v[52:55], v[100:103], v[148:151]
    v_mfma_f32_16x16x32_bf16 v[152:155], v[52:55], v[104:107], v[152:155]
    v_mfma_f32_16x16x32_bf16 v[156:159], v[52:55], v[108:111], v[156:159]
    s_add_u32 s93, s91, 742400
    buffer_load_dwordx4 v[52:55], v2, s[24:27], s93 offen
    s_waitcnt lgkmcnt(0)
    ds_read_b128 v[96:99], v2 offset:15360
    ds_read_b128 v[100:103], v2 offset:33792
    ds_read_b128 v[104:107], v3 offset:15360
    ds_read_b128 v[108:111], v3 offset:33792
    s_waitcnt vmcnt(29)
    v_mfma_f32_16x16x32_bf16 v[112:115], v[56:59], v[80:83], v[112:115]
    v_mfma_f32_16x16x32_bf16 v[116:119], v[56:59], v[84:87], v[116:119]
    v_mfma_f32_16x16x32_bf16 v[120:123], v[56:59], v[88:91], v[120:123]
    v_mfma_f32_16x16x32_bf16 v[124:127], v[56:59], v[92:95], v[124:127]
    s_add_u32 s93, s91, 448512
    buffer_load_dwordx4 v[56:59], v2, s[24:27], s93 offen
    s_waitcnt vmcnt(29)
    v_mfma_f32_16x16x32_bf16 v[128:131], v[60:63], v[80:83], v[128:131]
    v_mfma_f32_16x16x32_bf16 v[132:135], v[60:63], v[84:87], v[132:135]
    v_mfma_f32_16x16x32_bf16 v[136:139], v[60:63], v[88:91], v[136:139]
    v_mfma_f32_16x16x32_bf16 v[140:143], v[60:63], v[92:95], v[140:143]
    s_add_u32 s93, s91, 595968
    buffer_load_dwordx4 v[60:63], v2, s[24:27], s93 offen
    s_waitcnt vmcnt(29)
    v_mfma_f32_16x16x32_bf16 v[144:147], v[64:67], v[80:83], v[144:147]
    v_mfma_f32_16x16x32_bf16 v[148:151], v[64:67], v[84:87], v[148:151]
    v_mfma_f32_16x16x32_bf16 v[152:155], v[64:67], v[88:91], v[152:155]
    v_mfma_f32_16x16x32_bf16 v[156:159], v[64:67], v[92:95], v[156:159]
    s_add_u32 s93, s91, 743424
    buffer_load_dwordx4 v[64:67], v2, s[24:27], s93 offen
    s_waitcnt lgkmcnt(0)
    ds_read_b128 v[80:83], v2 offset:16384
    ds_read_b128 v[84:87], v2 offset:34816
    ds_read_b128 v[88:91], v3 offset:16384
    ds_read_b128 v[92:95], v3 offset:34816
    s_waitcnt vmcnt(29)
    v_mfma_f32_16x16x32_bf16 v[112:115], v[68:71], v[96:99], v[112:115]
    v_mfma_f32_16x16x32_bf16 v[116:119], v[68:71], v[100:103], v[116:119]
    v_mfma_f32_16x16x32_bf16 v[120:123], v[68:71], v[104:107], v[120:123]
    v_mfma_f32_16x16x32_bf16 v[124:127], v[68:71], v[108:111], v[124:127]
    s_add_u32 s93, s91, 449536
    buffer_load_dwordx4 v[68:71], v2, s[24:27], s93 offen
    s_waitcnt vmcnt(29)
    v_mfma_f32_16x16x32_bf16 v[128:131], v[72:75], v[96:99], v[128:131]
    v_mfma_f32_16x16x32_bf16 v[132:135], v[72:75], v[100:103], v[132:135]
    v_mfma_f32_16x16x32_bf16 v[136:139], v[72:75], v[104:107], v[136:139]
    v_mfma_f32_16x16x32_bf16 v[140:143], v[72:75], v[108:111], v[140:143]
    s_add_u32 s93, s91, 596992
    buffer_load_dwordx4 v[72:75], v2, s[24:27], s93 offen
    s_waitcnt vmcnt(29)
    v_mfma_f32_16x16x32_bf16 v[144:147], v[76:79], v[96:99], v[144:147]
    v_mfma_f32_16x16x32_bf16 v[148:151], v[76:79], v[100:103], v[148:151]
    v_mfma_f32_16x16x32_bf16 v[152:155], v[76:79], v[104:107], v[152:155]
    v_mfma_f32_16x16x32_bf16 v[156:159], v[76:79], v[108:111], v[156:159]
    s_add_u32 s93, s91, 744448
    buffer_load_dwordx4 v[76:79], v2, s[24:27], s93 offen
    s_waitcnt lgkmcnt(0)
    ds_read_b128 v[96:99], v2 offset:17408
    ds_read_b128 v[100:103], v2 offset:35840
    ds_read_b128 v[104:107], v3 offset:17408
    ds_read_b128 v[108:111], v3 offset:35840
    s_waitcnt vmcnt(29)
    v_mfma_f32_16x16x32_bf16 v[112:115], v[208:211], v[80:83], v[112:115]
    v_mfma_f32_16x16x32_bf16 v[116:119], v[208:211], v[84:87], v[116:119]
    v_mfma_f32_16x16x32_bf16 v[120:123], v[208:211], v[88:91], v[120:123]
    v_mfma_f32_16x16x32_bf16 v[124:127], v[208:211], v[92:95], v[124:127]
    s_add_u32 s93, s91, 450560
    buffer_load_dwordx4 v[208:211], v2, s[24:27], s93 offen
    s_waitcnt vmcnt(29)
    v_mfma_f32_16x16x32_bf16 v[128:131], v[212:215], v[80:83], v[128:131]
    v_mfma_f32_16x16x32_bf16 v[132:135], v[212:215], v[84:87], v[132:135]
    v_mfma_f32_16x16x32_bf16 v[136:139], v[212:215], v[88:91], v[136:139]
    v_mfma_f32_16x16x32_bf16 v[140:143], v[212:215], v[92:95], v[140:143]
    s_add_u32 s93, s91, 598016
    buffer_load_dwordx4 v[212:215], v2, s[24:27], s93 offen
    s_waitcnt vmcnt(29)
    v_mfma_f32_16x16x32_bf16 v[144:147], v[216:219], v[80:83], v[144:147]
    v_mfma_f32_16x16x32_bf16 v[148:151], v[216:219], v[84:87], v[148:151]
    v_mfma_f32_16x16x32_bf16 v[152:155], v[216:219], v[88:91], v[152:155]
    v_mfma_f32_16x16x32_bf16 v[156:159], v[216:219], v[92:95], v[156:159]
    s_add_u32 s93, s91, 745472
    buffer_load_dwordx4 v[216:219], v2, s[24:27], s93 offen
    s_waitcnt lgkmcnt(0)
    ds_read_b128 v[80:83], v2 offset:0
    ds_read_b128 v[84:87], v2 offset:18432
    ds_read_b128 v[88:91], v3 offset:0
    ds_read_b128 v[92:95], v3 offset:18432
    s_waitcnt vmcnt(29)
    v_mfma_f32_16x16x32_bf16 v[112:115], v[220:223], v[96:99], v[112:115]
    v_mfma_f32_16x16x32_bf16 v[116:119], v[220:223], v[100:103], v[116:119]
    v_mfma_f32_16x16x32_bf16 v[120:123], v[220:223], v[104:107], v[120:123]
    v_mfma_f32_16x16x32_bf16 v[124:127], v[220:223], v[108:111], v[124:127]
    s_add_u32 s93, s91, 451584
    buffer_load_dwordx4 v[220:223], v2, s[24:27], s93 offen
    s_waitcnt vmcnt(29)
    v_mfma_f32_16x16x32_bf16 v[128:131], v[224:227], v[96:99], v[128:131]
    v_mfma_f32_16x16x32_bf16 v[132:135], v[224:227], v[100:103], v[132:135]
    v_mfma_f32_16x16x32_bf16 v[136:139], v[224:227], v[104:107], v[136:139]
    v_mfma_f32_16x16x32_bf16 v[140:143], v[224:227], v[108:111], v[140:143]
    s_add_u32 s93, s91, 599040
    buffer_load_dwordx4 v[224:227], v2, s[24:27], s93 offen
    s_waitcnt vmcnt(29)
    v_mfma_f32_16x16x32_bf16 v[144:147], v[228:231], v[96:99], v[144:147]
    v_mfma_f32_16x16x32_bf16 v[148:151], v[228:231], v[100:103], v[148:151]
    v_mfma_f32_16x16x32_bf16 v[152:155], v[228:231], v[104:107], v[152:155]
    v_mfma_f32_16x16x32_bf16 v[156:159], v[228:231], v[108:111], v[156:159]
    s_add_u32 s93, s91, 746496
    buffer_load_dwordx4 v[228:231], v2, s[24:27], s93 offen
    s_waitcnt lgkmcnt(0)
    ds_read_b128 v[96:99], v2 offset:1024
    ds_read_b128 v[100:103], v2 offset:19456
    ds_read_b128 v[104:107], v3 offset:1024
    ds_read_b128 v[108:111], v3 offset:19456
    s_waitcnt vmcnt(29)
    v_mfma_f32_16x16x32_bf16 v[160:163], v[232:235], v[80:83], 0
    v_mfma_f32_16x16x32_bf16 v[164:167], v[232:235], v[84:87], 0
    v_mfma_f32_16x16x32_bf16 v[168:171], v[232:235], v[88:91], 0
    v_mfma_f32_16x16x32_bf16 v[172:175], v[232:235], v[92:95], 0
    s_add_u32 s93, s91, 452608
    buffer_load_dwordx4 v[232:235], v2, s[24:27], s93 offen
    s_waitcnt vmcnt(29)
    v_mfma_f32_16x16x32_bf16 v[176:179], v[236:239], v[80:83], 0
    v_mfma_f32_16x16x32_bf16 v[180:183], v[236:239], v[84:87], 0
    v_mfma_f32_16x16x32_bf16 v[184:187], v[236:239], v[88:91], 0
    v_mfma_f32_16x16x32_bf16 v[188:191], v[236:239], v[92:95], 0
    s_add_u32 s93, s91, 600064
    buffer_load_dwordx4 v[236:239], v2, s[24:27], s93 offen
    s_waitcnt vmcnt(29)
    v_mfma_f32_16x16x32_bf16 v[192:195], v[240:243], v[80:83], 0
    v_mfma_f32_16x16x32_bf16 v[196:199], v[240:243], v[84:87], 0
    v_mfma_f32_16x16x32_bf16 v[200:203], v[240:243], v[88:91], 0
    v_mfma_f32_16x16x32_bf16 v[204:207], v[240:243], v[92:95], 0
    s_add_u32 s93, s91, 747520
    buffer_load_dwordx4 v[240:243], v2, s[24:27], s93 offen
    s_waitcnt lgkmcnt(0)
    ds_read_b128 v[80:83], v2 offset:2048
    ds_read_b128 v[84:87], v2 offset:20480
    ds_read_b128 v[88:91], v3 offset:2048
    ds_read_b128 v[92:95], v3 offset:20480
    s_waitcnt vmcnt(29)
    v_mfma_f32_16x16x32_bf16 v[160:163], v[244:247], v[96:99], v[160:163]
    v_mfma_f32_16x16x32_bf16 v[164:167], v[244:247], v[100:103], v[164:167]
    v_mfma_f32_16x16x32_bf16 v[168:171], v[244:247], v[104:107], v[168:171]
    v_mfma_f32_16x16x32_bf16 v[172:175], v[244:247], v[108:111], v[172:175]
    v_cvt_pk_bf16_f32 v112, v112, v113
    v_cvt_pk_bf16_f32 v113, v114, v115
    v_cvt_pk_bf16_f32 v114, v116, v117
    v_cvt_pk_bf16_f32 v115, v118, v119
    s_add_u32 s93, s92, 0
    buffer_store_dwordx4 v[112:115], v2, s[12:15], s93 offen sc0 sc1
    s_add_u32 s93, s91, 453632
    buffer_load_dwordx4 v[244:247], v2, s[24:27], s93 offen
    s_waitcnt vmcnt(30)
    v_mfma_f32_16x16x32_bf16 v[176:179], v[248:251], v[96:99], v[176:179]
    v_mfma_f32_16x16x32_bf16 v[180:183], v[248:251], v[100:103], v[180:183]
    v_mfma_f32_16x16x32_bf16 v[184:187], v[248:251], v[104:107], v[184:187]
    v_mfma_f32_16x16x32_bf16 v[188:191], v[248:251], v[108:111], v[188:191]
    v_cvt_pk_bf16_f32 v120, v120, v121
    v_cvt_pk_bf16_f32 v121, v122, v123
    v_cvt_pk_bf16_f32 v122, v124, v125
    v_cvt_pk_bf16_f32 v123, v126, v127
    s_add_u32 s93, s92, 36864
    buffer_store_dwordx4 v[120:123], v2, s[12:15], s93 offen sc0 sc1
    s_add_u32 s93, s91, 601088
    buffer_load_dwordx4 v[248:251], v2, s[24:27], s93 offen
    s_waitcnt vmcnt(31)
    v_mfma_f32_16x16x32_bf16 v[192:195], v[252:255], v[96:99], v[192:195]
    v_mfma_f32_16x16x32_bf16 v[196:199], v[252:255], v[100:103], v[196:199]
    v_mfma_f32_16x16x32_bf16 v[200:203], v[252:255], v[104:107], v[200:203]
    v_mfma_f32_16x16x32_bf16 v[204:207], v[252:255], v[108:111], v[204:207]
    v_cvt_pk_bf16_f32 v128, v128, v129
    v_cvt_pk_bf16_f32 v129, v130, v131
    v_cvt_pk_bf16_f32 v130, v132, v133
    v_cvt_pk_bf16_f32 v131, v134, v135
    s_add_u32 s93, s92, 1024
    buffer_store_dwordx4 v[128:131], v2, s[12:15], s93 offen sc0 sc1
    s_add_u32 s93, s91, 748544
    buffer_load_dwordx4 v[252:255], v2, s[24:27], s93 offen
    s_waitcnt lgkmcnt(0)
    ds_read_b128 v[96:99], v2 offset:3072
    ds_read_b128 v[100:103], v2 offset:21504
    ds_read_b128 v[104:107], v3 offset:3072
    ds_read_b128 v[108:111], v3 offset:21504
    s_waitcnt vmcnt(32)
    v_mfma_f32_16x16x32_bf16 v[160:163], v[8:11], v[80:83], v[160:163]
    v_mfma_f32_16x16x32_bf16 v[164:167], v[8:11], v[84:87], v[164:167]
    v_mfma_f32_16x16x32_bf16 v[168:171], v[8:11], v[88:91], v[168:171]
    v_mfma_f32_16x16x32_bf16 v[172:175], v[8:11], v[92:95], v[172:175]
    v_cvt_pk_bf16_f32 v136, v136, v137
    v_cvt_pk_bf16_f32 v137, v138, v139
    v_cvt_pk_bf16_f32 v138, v140, v141
    v_cvt_pk_bf16_f32 v139, v142, v143
    s_add_u32 s93, s92, 37888
    buffer_store_dwordx4 v[136:139], v2, s[12:15], s93 offen sc0 sc1
    s_add_u32 s93, s91, 454656
    buffer_load_dwordx4 v[8:11], v2, s[24:27], s93 offen
    s_waitcnt vmcnt(33)
    v_mfma_f32_16x16x32_bf16 v[176:179], v[12:15], v[80:83], v[176:179]
    v_mfma_f32_16x16x32_bf16 v[180:183], v[12:15], v[84:87], v[180:183]
    v_mfma_f32_16x16x32_bf16 v[184:187], v[12:15], v[88:91], v[184:187]
    v_mfma_f32_16x16x32_bf16 v[188:191], v[12:15], v[92:95], v[188:191]
    v_cvt_pk_bf16_f32 v144, v144, v145
    v_cvt_pk_bf16_f32 v145, v146, v147
    v_cvt_pk_bf16_f32 v146, v148, v149
    v_cvt_pk_bf16_f32 v147, v150, v151
    s_add_u32 s93, s92, 2048
    buffer_store_dwordx4 v[144:147], v2, s[12:15], s93 offen sc0 sc1
    s_add_u32 s93, s91, 602112
    buffer_load_dwordx4 v[12:15], v2, s[24:27], s93 offen
    s_waitcnt vmcnt(34)
    v_mfma_f32_16x16x32_bf16 v[192:195], v[16:19], v[80:83], v[192:195]
    v_mfma_f32_16x16x32_bf16 v[196:199], v[16:19], v[84:87], v[196:199]
    v_mfma_f32_16x16x32_bf16 v[200:203], v[16:19], v[88:91], v[200:203]
    v_mfma_f32_16x16x32_bf16 v[204:207], v[16:19], v[92:95], v[204:207]
    v_cvt_pk_bf16_f32 v152, v152, v153
    v_cvt_pk_bf16_f32 v153, v154, v155
    v_cvt_pk_bf16_f32 v154, v156, v157
    v_cvt_pk_bf16_f32 v155, v158, v159
    s_add_u32 s93, s92, 38912
    buffer_store_dwordx4 v[152:155], v2, s[12:15], s93 offen sc0 sc1
    s_add_u32 s93, s91, 749568
    buffer_load_dwordx4 v[16:19], v2, s[24:27], s93 offen
    s_waitcnt lgkmcnt(0)
    ds_read_b128 v[80:83], v2 offset:4096
    ds_read_b128 v[84:87], v2 offset:22528
    ds_read_b128 v[88:91], v3 offset:4096
    ds_read_b128 v[92:95], v3 offset:22528
    s_waitcnt vmcnt(35)
    v_mfma_f32_16x16x32_bf16 v[160:163], v[20:23], v[96:99], v[160:163]
    v_mfma_f32_16x16x32_bf16 v[164:167], v[20:23], v[100:103], v[164:167]
    v_mfma_f32_16x16x32_bf16 v[168:171], v[20:23], v[104:107], v[168:171]
    v_mfma_f32_16x16x32_bf16 v[172:175], v[20:23], v[108:111], v[172:175]
    s_add_u32 s93, s91, 455680
    buffer_load_dwordx4 v[20:23], v2, s[24:27], s93 offen
    s_waitcnt vmcnt(35)
    v_mfma_f32_16x16x32_bf16 v[176:179], v[24:27], v[96:99], v[176:179]
    v_mfma_f32_16x16x32_bf16 v[180:183], v[24:27], v[100:103], v[180:183]
    v_mfma_f32_16x16x32_bf16 v[184:187], v[24:27], v[104:107], v[184:187]
    v_mfma_f32_16x16x32_bf16 v[188:191], v[24:27], v[108:111], v[188:191]
    s_add_u32 s93, s91, 603136
    buffer_load_dwordx4 v[24:27], v2, s[24:27], s93 offen
    s_waitcnt vmcnt(35)
    v_mfma_f32_16x16x32_bf16 v[192:195], v[28:31], v[96:99], v[192:195]
    v_mfma_f32_16x16x32_bf16 v[196:199], v[28:31], v[100:103], v[196:199]
    v_mfma_f32_16x16x32_bf16 v[200:203], v[28:31], v[104:107], v[200:203]
    v_mfma_f32_16x16x32_bf16 v[204:207], v[28:31], v[108:111], v[204:207]
    s_add_u32 s93, s91, 750592
    buffer_load_dwordx4 v[28:31], v2, s[24:27], s93 offen
    s_waitcnt lgkmcnt(0)
    ds_read_b128 v[96:99], v2 offset:5120
    ds_read_b128 v[100:103], v2 offset:23552
    ds_read_b128 v[104:107], v3 offset:5120
    ds_read_b128 v[108:111], v3 offset:23552
    s_waitcnt vmcnt(35)
    v_mfma_f32_16x16x32_bf16 v[160:163], v[32:35], v[80:83], v[160:163]
    v_mfma_f32_16x16x32_bf16 v[164:167], v[32:35], v[84:87], v[164:167]
    v_mfma_f32_16x16x32_bf16 v[168:171], v[32:35], v[88:91], v[168:171]
    v_mfma_f32_16x16x32_bf16 v[172:175], v[32:35], v[92:95], v[172:175]
    s_add_u32 s93, s91, 456704
    buffer_load_dwordx4 v[32:35], v2, s[24:27], s93 offen
    s_waitcnt vmcnt(35)
    v_mfma_f32_16x16x32_bf16 v[176:179], v[36:39], v[80:83], v[176:179]
    v_mfma_f32_16x16x32_bf16 v[180:183], v[36:39], v[84:87], v[180:183]
    v_mfma_f32_16x16x32_bf16 v[184:187], v[36:39], v[88:91], v[184:187]
    v_mfma_f32_16x16x32_bf16 v[188:191], v[36:39], v[92:95], v[188:191]
    s_add_u32 s93, s91, 604160
    buffer_load_dwordx4 v[36:39], v2, s[24:27], s93 offen
    s_waitcnt vmcnt(35)
    v_mfma_f32_16x16x32_bf16 v[192:195], v[40:43], v[80:83], v[192:195]
    v_mfma_f32_16x16x32_bf16 v[196:199], v[40:43], v[84:87], v[196:199]
    v_mfma_f32_16x16x32_bf16 v[200:203], v[40:43], v[88:91], v[200:203]
    v_mfma_f32_16x16x32_bf16 v[204:207], v[40:43], v[92:95], v[204:207]
    s_add_u32 s93, s91, 751616
    buffer_load_dwordx4 v[40:43], v2, s[24:27], s93 offen
    s_waitcnt lgkmcnt(0)
    ds_read_b128 v[80:83], v2 offset:6144
    ds_read_b128 v[84:87], v2 offset:24576
    ds_read_b128 v[88:91], v3 offset:6144
    ds_read_b128 v[92:95], v3 offset:24576
    s_waitcnt vmcnt(35)
    v_mfma_f32_16x16x32_bf16 v[160:163], v[44:47], v[96:99], v[160:163]
    v_mfma_f32_16x16x32_bf16 v[164:167], v[44:47], v[100:103], v[164:167]
    v_mfma_f32_16x16x32_bf16 v[168:171], v[44:47], v[104:107], v[168:171]
    v_mfma_f32_16x16x32_bf16 v[172:175], v[44:47], v[108:111], v[172:175]
    s_add_u32 s93, s91, 457728
    buffer_load_dwordx4 v[44:47], v2, s[24:27], s93 offen
    s_waitcnt vmcnt(35)
    v_mfma_f32_16x16x32_bf16 v[176:179], v[48:51], v[96:99], v[176:179]
    v_mfma_f32_16x16x32_bf16 v[180:183], v[48:51], v[100:103], v[180:183]
    v_mfma_f32_16x16x32_bf16 v[184:187], v[48:51], v[104:107], v[184:187]
    v_mfma_f32_16x16x32_bf16 v[188:191], v[48:51], v[108:111], v[188:191]
    s_add_u32 s93, s91, 605184
    buffer_load_dwordx4 v[48:51], v2, s[24:27], s93 offen
    s_waitcnt vmcnt(35)
    v_mfma_f32_16x16x32_bf16 v[192:195], v[52:55], v[96:99], v[192:195]
    v_mfma_f32_16x16x32_bf16 v[196:199], v[52:55], v[100:103], v[196:199]
    v_mfma_f32_16x16x32_bf16 v[200:203], v[52:55], v[104:107], v[200:203]
    v_mfma_f32_16x16x32_bf16 v[204:207], v[52:55], v[108:111], v[204:207]
    s_add_u32 s93, s91, 752640
    buffer_load_dwordx4 v[52:55], v2, s[24:27], s93 offen
    s_waitcnt lgkmcnt(0)
    ds_read_b128 v[96:99], v2 offset:7168
    ds_read_b128 v[100:103], v2 offset:25600
    ds_read_b128 v[104:107], v3 offset:7168
    ds_read_b128 v[108:111], v3 offset:25600
    s_waitcnt vmcnt(35)
    v_mfma_f32_16x16x32_bf16 v[160:163], v[56:59], v[80:83], v[160:163]
    v_mfma_f32_16x16x32_bf16 v[164:167], v[56:59], v[84:87], v[164:167]
    v_mfma_f32_16x16x32_bf16 v[168:171], v[56:59], v[88:91], v[168:171]
    v_mfma_f32_16x16x32_bf16 v[172:175], v[56:59], v[92:95], v[172:175]
    s_add_u32 s93, s91, 458752
    buffer_load_dwordx4 v[56:59], v2, s[24:27], s93 offen
    s_waitcnt vmcnt(35)
    v_mfma_f32_16x16x32_bf16 v[176:179], v[60:63], v[80:83], v[176:179]
    v_mfma_f32_16x16x32_bf16 v[180:183], v[60:63], v[84:87], v[180:183]
    v_mfma_f32_16x16x32_bf16 v[184:187], v[60:63], v[88:91], v[184:187]
    v_mfma_f32_16x16x32_bf16 v[188:191], v[60:63], v[92:95], v[188:191]
    s_add_u32 s93, s91, 606208
    buffer_load_dwordx4 v[60:63], v2, s[24:27], s93 offen
    s_waitcnt vmcnt(35)
    v_mfma_f32_16x16x32_bf16 v[192:195], v[64:67], v[80:83], v[192:195]
    v_mfma_f32_16x16x32_bf16 v[196:199], v[64:67], v[84:87], v[196:199]
    v_mfma_f32_16x16x32_bf16 v[200:203], v[64:67], v[88:91], v[200:203]
    v_mfma_f32_16x16x32_bf16 v[204:207], v[64:67], v[92:95], v[204:207]
    s_add_u32 s93, s91, 753664
    buffer_load_dwordx4 v[64:67], v2, s[24:27], s93 offen
    s_waitcnt lgkmcnt(0)
    ds_read_b128 v[80:83], v2 offset:8192
    ds_read_b128 v[84:87], v2 offset:26624
    ds_read_b128 v[88:91], v3 offset:8192
    ds_read_b128 v[92:95], v3 offset:26624
    s_waitcnt vmcnt(35)
    v_mfma_f32_16x16x32_bf16 v[160:163], v[68:71], v[96:99], v[160:163]
    v_mfma_f32_16x16x32_bf16 v[164:167], v[68:71], v[100:103], v[164:167]
    v_mfma_f32_16x16x32_bf16 v[168:171], v[68:71], v[104:107], v[168:171]
    v_mfma_f32_16x16x32_bf16 v[172:175], v[68:71], v[108:111], v[172:175]
    s_add_u32 s93, s91, 459776
    buffer_load_dwordx4 v[68:71], v2, s[24:27], s93 offen
    s_waitcnt vmcnt(35)
    v_mfma_f32_16x16x32_bf16 v[176:179], v[72:75], v[96:99], v[176:179]
    v_mfma_f32_16x16x32_bf16 v[180:183], v[72:75], v[100:103], v[180:183]
    v_mfma_f32_16x16x32_bf16 v[184:187], v[72:75], v[104:107], v[184:187]
    v_mfma_f32_16x16x32_bf16 v[188:191], v[72:75], v[108:111], v[188:191]
    s_add_u32 s93, s91, 607232
    buffer_load_dwordx4 v[72:75], v2, s[24:27], s93 offen
    s_waitcnt vmcnt(35)
    v_mfma_f32_16x16x32_bf16 v[192:195], v[76:79], v[96:99], v[192:195]
    v_mfma_f32_16x16x32_bf16 v[196:199], v[76:79], v[100:103], v[196:199]
    v_mfma_f32_16x16x32_bf16 v[200:203], v[76:79], v[104:107], v[200:203]
    v_mfma_f32_16x16x32_bf16 v[204:207], v[76:79], v[108:111], v[204:207]
    s_add_u32 s93, s91, 754688
    buffer_load_dwordx4 v[76:79], v2, s[24:27], s93 offen
    s_waitcnt lgkmcnt(0)
    ds_read_b128 v[96:99], v2 offset:9216
    ds_read_b128 v[100:103], v2 offset:27648
    ds_read_b128 v[104:107], v3 offset:9216
    ds_read_b128 v[108:111], v3 offset:27648
    s_waitcnt vmcnt(35)
    v_mfma_f32_16x16x32_bf16 v[160:163], v[208:211], v[80:83], v[160:163]
    v_mfma_f32_16x16x32_bf16 v[164:167], v[208:211], v[84:87], v[164:167]
    v_mfma_f32_16x16x32_bf16 v[168:171], v[208:211], v[88:91], v[168:171]
    v_mfma_f32_16x16x32_bf16 v[172:175], v[208:211], v[92:95], v[172:175]
    s_add_u32 s93, s91, 884736
    buffer_load_dwordx4 v[208:211], v2, s[24:27], s93 offen
    s_waitcnt vmcnt(35)
    v_mfma_f32_16x16x32_bf16 v[176:179], v[212:215], v[80:83], v[176:179]
    v_mfma_f32_16x16x32_bf16 v[180:183], v[212:215], v[84:87], v[180:183]
    v_mfma_f32_16x16x32_bf16 v[184:187], v[212:215], v[88:91], v[184:187]
    v_mfma_f32_16x16x32_bf16 v[188:191], v[212:215], v[92:95], v[188:191]
    s_add_u32 s93, s91, 1032192
    buffer_load_dwordx4 v[212:215], v2, s[24:27], s93 offen
    s_waitcnt vmcnt(35)
    v_mfma_f32_16x16x32_bf16 v[192:195], v[216:219], v[80:83], v[192:195]
    v_mfma_f32_16x16x32_bf16 v[196:199], v[216:219], v[84:87], v[196:199]
    v_mfma_f32_16x16x32_bf16 v[200:203], v[216:219], v[88:91], v[200:203]
    v_mfma_f32_16x16x32_bf16 v[204:207], v[216:219], v[92:95], v[204:207]
    s_add_u32 s93, s91, 1179648
    buffer_load_dwordx4 v[216:219], v2, s[24:27], s93 offen
    s_waitcnt lgkmcnt(0)
    ds_read_b128 v[80:83], v2 offset:10240
    ds_read_b128 v[84:87], v2 offset:28672
    ds_read_b128 v[88:91], v3 offset:10240
    ds_read_b128 v[92:95], v3 offset:28672
    s_waitcnt vmcnt(35)
    v_mfma_f32_16x16x32_bf16 v[160:163], v[220:223], v[96:99], v[160:163]
    v_mfma_f32_16x16x32_bf16 v[164:167], v[220:223], v[100:103], v[164:167]
    v_mfma_f32_16x16x32_bf16 v[168:171], v[220:223], v[104:107], v[168:171]
    v_mfma_f32_16x16x32_bf16 v[172:175], v[220:223], v[108:111], v[172:175]
    s_add_u32 s93, s91, 885760
    buffer_load_dwordx4 v[220:223], v2, s[24:27], s93 offen
    s_waitcnt vmcnt(35)
    v_mfma_f32_16x16x32_bf16 v[176:179], v[224:227], v[96:99], v[176:179]
    v_mfma_f32_16x16x32_bf16 v[180:183], v[224:227], v[100:103], v[180:183]
    v_mfma_f32_16x16x32_bf16 v[184:187], v[224:227], v[104:107], v[184:187]
    v_mfma_f32_16x16x32_bf16 v[188:191], v[224:227], v[108:111], v[188:191]
    s_add_u32 s93, s91, 1033216
    buffer_load_dwordx4 v[224:227], v2, s[24:27], s93 offen
    s_waitcnt vmcnt(35)
    v_mfma_f32_16x16x32_bf16 v[192:195], v[228:231], v[96:99], v[192:195]
    v_mfma_f32_16x16x32_bf16 v[196:199], v[228:231], v[100:103], v[196:199]
    v_mfma_f32_16x16x32_bf16 v[200:203], v[228:231], v[104:107], v[200:203]
    v_mfma_f32_16x16x32_bf16 v[204:207], v[228:231], v[108:111], v[204:207]
    s_add_u32 s93, s91, 1180672
    buffer_load_dwordx4 v[228:231], v2, s[24:27], s93 offen
    s_waitcnt lgkmcnt(0)
    ds_read_b128 v[96:99], v2 offset:11264
    ds_read_b128 v[100:103], v2 offset:29696
    ds_read_b128 v[104:107], v3 offset:11264
    ds_read_b128 v[108:111], v3 offset:29696
    s_waitcnt vmcnt(35)
    v_mfma_f32_16x16x32_bf16 v[160:163], v[232:235], v[80:83], v[160:163]
    v_mfma_f32_16x16x32_bf16 v[164:167], v[232:235], v[84:87], v[164:167]
    v_mfma_f32_16x16x32_bf16 v[168:171], v[232:235], v[88:91], v[168:171]
    v_mfma_f32_16x16x32_bf16 v[172:175], v[232:235], v[92:95], v[172:175]
    s_add_u32 s93, s91, 886784
    buffer_load_dwordx4 v[232:235], v2, s[24:27], s93 offen
    s_waitcnt vmcnt(35)
    v_mfma_f32_16x16x32_bf16 v[176:179], v[236:239], v[80:83], v[176:179]
    v_mfma_f32_16x16x32_bf16 v[180:183], v[236:239], v[84:87], v[180:183]
    v_mfma_f32_16x16x32_bf16 v[184:187], v[236:239], v[88:91], v[184:187]
    v_mfma_f32_16x16x32_bf16 v[188:191], v[236:239], v[92:95], v[188:191]
    s_add_u32 s93, s91, 1034240
    buffer_load_dwordx4 v[236:239], v2, s[24:27], s93 offen
    s_waitcnt vmcnt(35)
    v_mfma_f32_16x16x32_bf16 v[192:195], v[240:243], v[80:83], v[192:195]
    v_mfma_f32_16x16x32_bf16 v[196:199], v[240:243], v[84:87], v[196:199]
    v_mfma_f32_16x16x32_bf16 v[200:203], v[240:243], v[88:91], v[200:203]
    v_mfma_f32_16x16x32_bf16 v[204:207], v[240:243], v[92:95], v[204:207]
    s_add_u32 s93, s91, 1181696
    buffer_load_dwordx4 v[240:243], v2, s[24:27], s93 offen
    s_waitcnt lgkmcnt(0)
    ds_read_b128 v[80:83], v2 offset:12288
    ds_read_b128 v[84:87], v2 offset:30720
    ds_read_b128 v[88:91], v3 offset:12288
    ds_read_b128 v[92:95], v3 offset:30720
    s_waitcnt vmcnt(34)
    v_mfma_f32_16x16x32_bf16 v[160:163], v[244:247], v[96:99], v[160:163]
    v_mfma_f32_16x16x32_bf16 v[164:167], v[244:247], v[100:103], v[164:167]
    v_mfma_f32_16x16x32_bf16 v[168:171], v[244:247], v[104:107], v[168:171]
    v_mfma_f32_16x16x32_bf16 v[172:175], v[244:247], v[108:111], v[172:175]
    s_add_u32 s93, s91, 887808
    buffer_load_dwordx4 v[244:247], v2, s[24:27], s93 offen
    s_waitcnt vmcnt(33)
    v_mfma_f32_16x16x32_bf16 v[176:179], v[248:251], v[96:99], v[176:179]
    v_mfma_f32_16x16x32_bf16 v[180:183], v[248:251], v[100:103], v[180:183]
    v_mfma_f32_16x16x32_bf16 v[184:187], v[248:251], v[104:107], v[184:187]
    v_mfma_f32_16x16x32_bf16 v[188:191], v[248:251], v[108:111], v[188:191]
    s_add_u32 s93, s91, 1035264
    buffer_load_dwordx4 v[248:251], v2, s[24:27], s93 offen
    s_waitcnt vmcnt(32)
    v_mfma_f32_16x16x32_bf16 v[192:195], v[252:255], v[96:99], v[192:195]
    v_mfma_f32_16x16x32_bf16 v[196:199], v[252:255], v[100:103], v[196:199]
    v_mfma_f32_16x16x32_bf16 v[200:203], v[252:255], v[104:107], v[200:203]
    v_mfma_f32_16x16x32_bf16 v[204:207], v[252:255], v[108:111], v[204:207]
    s_add_u32 s93, s91, 1182720
    buffer_load_dwordx4 v[252:255], v2, s[24:27], s93 offen
    s_waitcnt lgkmcnt(0)
    ds_read_b128 v[96:99], v2 offset:13312
    ds_read_b128 v[100:103], v2 offset:31744
    ds_read_b128 v[104:107], v3 offset:13312
    ds_read_b128 v[108:111], v3 offset:31744
    s_waitcnt vmcnt(31)
    v_mfma_f32_16x16x32_bf16 v[160:163], v[8:11], v[80:83], v[160:163]
    v_mfma_f32_16x16x32_bf16 v[164:167], v[8:11], v[84:87], v[164:167]
    v_mfma_f32_16x16x32_bf16 v[168:171], v[8:11], v[88:91], v[168:171]
    v_mfma_f32_16x16x32_bf16 v[172:175], v[8:11], v[92:95], v[172:175]
    s_add_u32 s93, s91, 888832
    buffer_load_dwordx4 v[8:11], v2, s[24:27], s93 offen
    s_waitcnt vmcnt(30)
    v_mfma_f32_16x16x32_bf16 v[176:179], v[12:15], v[80:83], v[176:179]
    v_mfma_f32_16x16x32_bf16 v[180:183], v[12:15], v[84:87], v[180:183]
    v_mfma_f32_16x16x32_bf16 v[184:187], v[12:15], v[88:91], v[184:187]
    v_mfma_f32_16x16x32_bf16 v[188:191], v[12:15], v[92:95], v[188:191]
    s_add_u32 s93, s91, 1036288
    buffer_load_dwordx4 v[12:15], v2, s[24:27], s93 offen
    s_waitcnt vmcnt(29)
    s_mov_b64 exec, 1
    buffer_store_dword v4, v7, s[28:31], s60 offen offset:0 sc0 sc1
    s_mov_b64 exec, -1
    v_mfma_f32_16x16x32_bf16 v[192:195], v[16:19], v[80:83], v[192:195]
    v_mfma_f32_16x16x32_bf16 v[196:199], v[16:19], v[84:87], v[196:199]
    v_mfma_f32_16x16x32_bf16 v[200:203], v[16:19], v[88:91], v[200:203]
    v_mfma_f32_16x16x32_bf16 v[204:207], v[16:19], v[92:95], v[204:207]
    s_add_u32 s93, s91, 1183744
    buffer_load_dwordx4 v[16:19], v2, s[24:27], s93 offen
    s_waitcnt lgkmcnt(0)
    ds_read_b128 v[80:83], v2 offset:14336
    ds_read_b128 v[84:87], v2 offset:32768
    ds_read_b128 v[88:91], v3 offset:14336
    ds_read_b128 v[92:95], v3 offset:32768
    s_waitcnt vmcnt(30)
    v_mfma_f32_16x16x32_bf16 v[160:163], v[20:23], v[96:99], v[160:163]
    v_mfma_f32_16x16x32_bf16 v[164:167], v[20:23], v[100:103], v[164:167]
    v_mfma_f32_16x16x32_bf16 v[168:171], v[20:23], v[104:107], v[168:171]
    v_mfma_f32_16x16x32_bf16 v[172:175], v[20:23], v[108:111], v[172:175]
    s_add_u32 s93, s91, 889856
    buffer_load_dwordx4 v[20:23], v2, s[24:27], s93 offen
    s_waitcnt vmcnt(30)
    v_mfma_f32_16x16x32_bf16 v[176:179], v[24:27], v[96:99], v[176:179]
    v_mfma_f32_16x16x32_bf16 v[180:183], v[24:27], v[100:103], v[180:183]
    v_mfma_f32_16x16x32_bf16 v[184:187], v[24:27], v[104:107], v[184:187]
    v_mfma_f32_16x16x32_bf16 v[188:191], v[24:27], v[108:111], v[188:191]
    s_add_u32 s93, s91, 1037312
    buffer_load_dwordx4 v[24:27], v2, s[24:27], s93 offen
    s_waitcnt vmcnt(30)
    v_mfma_f32_16x16x32_bf16 v[192:195], v[28:31], v[96:99], v[192:195]
    v_mfma_f32_16x16x32_bf16 v[196:199], v[28:31], v[100:103], v[196:199]
    v_mfma_f32_16x16x32_bf16 v[200:203], v[28:31], v[104:107], v[200:203]
    v_mfma_f32_16x16x32_bf16 v[204:207], v[28:31], v[108:111], v[204:207]
    s_add_u32 s93, s91, 1184768
    buffer_load_dwordx4 v[28:31], v2, s[24:27], s93 offen
    s_waitcnt lgkmcnt(0)
    ds_read_b128 v[96:99], v2 offset:15360
    ds_read_b128 v[100:103], v2 offset:33792
    ds_read_b128 v[104:107], v3 offset:15360
    ds_read_b128 v[108:111], v3 offset:33792
    s_waitcnt vmcnt(30)
    v_mfma_f32_16x16x32_bf16 v[160:163], v[32:35], v[80:83], v[160:163]
    v_mfma_f32_16x16x32_bf16 v[164:167], v[32:35], v[84:87], v[164:167]
    v_mfma_f32_16x16x32_bf16 v[168:171], v[32:35], v[88:91], v[168:171]
    v_mfma_f32_16x16x32_bf16 v[172:175], v[32:35], v[92:95], v[172:175]
    s_add_u32 s93, s91, 890880
    buffer_load_dwordx4 v[32:35], v2, s[24:27], s93 offen
    s_waitcnt vmcnt(30)
    v_mfma_f32_16x16x32_bf16 v[176:179], v[36:39], v[80:83], v[176:179]
    v_mfma_f32_16x16x32_bf16 v[180:183], v[36:39], v[84:87], v[180:183]
    v_mfma_f32_16x16x32_bf16 v[184:187], v[36:39], v[88:91], v[184:187]
    v_mfma_f32_16x16x32_bf16 v[188:191], v[36:39], v[92:95], v[188:191]
    s_add_u32 s93, s91, 1038336
    buffer_load_dwordx4 v[36:39], v2, s[24:27], s93 offen
    s_waitcnt vmcnt(30)
    v_mfma_f32_16x16x32_bf16 v[192:195], v[40:43], v[80:83], v[192:195]
    v_mfma_f32_16x16x32_bf16 v[196:199], v[40:43], v[84:87], v[196:199]
    v_mfma_f32_16x16x32_bf16 v[200:203], v[40:43], v[88:91], v[200:203]
    v_mfma_f32_16x16x32_bf16 v[204:207], v[40:43], v[92:95], v[204:207]
    s_add_u32 s93, s91, 1185792
    buffer_load_dwordx4 v[40:43], v2, s[24:27], s93 offen
    s_waitcnt lgkmcnt(0)
    ds_read_b128 v[80:83], v2 offset:16384
    ds_read_b128 v[84:87], v2 offset:34816
    ds_read_b128 v[88:91], v3 offset:16384
    ds_read_b128 v[92:95], v3 offset:34816
    s_waitcnt vmcnt(30)
    v_mfma_f32_16x16x32_bf16 v[160:163], v[44:47], v[96:99], v[160:163]
    v_mfma_f32_16x16x32_bf16 v[164:167], v[44:47], v[100:103], v[164:167]
    v_mfma_f32_16x16x32_bf16 v[168:171], v[44:47], v[104:107], v[168:171]
    v_mfma_f32_16x16x32_bf16 v[172:175], v[44:47], v[108:111], v[172:175]
    s_add_u32 s93, s91, 891904
    buffer_load_dwordx4 v[44:47], v2, s[24:27], s93 offen
    s_waitcnt vmcnt(30)
    v_mfma_f32_16x16x32_bf16 v[176:179], v[48:51], v[96:99], v[176:179]
    v_mfma_f32_16x16x32_bf16 v[180:183], v[48:51], v[100:103], v[180:183]
    v_mfma_f32_16x16x32_bf16 v[184:187], v[48:51], v[104:107], v[184:187]
    v_mfma_f32_16x16x32_bf16 v[188:191], v[48:51], v[108:111], v[188:191]
    s_add_u32 s93, s91, 1039360
    buffer_load_dwordx4 v[48:51], v2, s[24:27], s93 offen
    s_waitcnt vmcnt(30)
    v_mfma_f32_16x16x32_bf16 v[192:195], v[52:55], v[96:99], v[192:195]
    v_mfma_f32_16x16x32_bf16 v[196:199], v[52:55], v[100:103], v[196:199]
    v_mfma_f32_16x16x32_bf16 v[200:203], v[52:55], v[104:107], v[200:203]
    v_mfma_f32_16x16x32_bf16 v[204:207], v[52:55], v[108:111], v[204:207]
    s_add_u32 s93, s91, 1186816
    buffer_load_dwordx4 v[52:55], v2, s[24:27], s93 offen
    s_waitcnt lgkmcnt(0)
    ds_read_b128 v[96:99], v2 offset:17408
    ds_read_b128 v[100:103], v2 offset:35840
    ds_read_b128 v[104:107], v3 offset:17408
    ds_read_b128 v[108:111], v3 offset:35840
    s_waitcnt vmcnt(30)
    v_mfma_f32_16x16x32_bf16 v[160:163], v[56:59], v[80:83], v[160:163]
    v_mfma_f32_16x16x32_bf16 v[164:167], v[56:59], v[84:87], v[164:167]
    v_mfma_f32_16x16x32_bf16 v[168:171], v[56:59], v[88:91], v[168:171]
    v_mfma_f32_16x16x32_bf16 v[172:175], v[56:59], v[92:95], v[172:175]
    s_add_u32 s93, s91, 892928
    buffer_load_dwordx4 v[56:59], v2, s[24:27], s93 offen
    s_waitcnt vmcnt(30)
    v_mfma_f32_16x16x32_bf16 v[176:179], v[60:63], v[80:83], v[176:179]
    v_mfma_f32_16x16x32_bf16 v[180:183], v[60:63], v[84:87], v[180:183]
    v_mfma_f32_16x16x32_bf16 v[184:187], v[60:63], v[88:91], v[184:187]
    v_mfma_f32_16x16x32_bf16 v[188:191], v[60:63], v[92:95], v[188:191]
    s_add_u32 s93, s91, 1040384
    buffer_load_dwordx4 v[60:63], v2, s[24:27], s93 offen
    s_waitcnt vmcnt(30)
    v_mfma_f32_16x16x32_bf16 v[192:195], v[64:67], v[80:83], v[192:195]
    v_mfma_f32_16x16x32_bf16 v[196:199], v[64:67], v[84:87], v[196:199]
    v_mfma_f32_16x16x32_bf16 v[200:203], v[64:67], v[88:91], v[200:203]
    v_mfma_f32_16x16x32_bf16 v[204:207], v[64:67], v[92:95], v[204:207]
    s_add_u32 s93, s91, 1187840
    buffer_load_dwordx4 v[64:67], v2, s[24:27], s93 offen
    s_waitcnt lgkmcnt(0)
    ds_read_b128 v[80:83], v2 offset:0
    ds_read_b128 v[84:87], v2 offset:18432
    ds_read_b128 v[88:91], v3 offset:0
    ds_read_b128 v[92:95], v3 offset:18432
    s_waitcnt vmcnt(30)
    v_mfma_f32_16x16x32_bf16 v[160:163], v[68:71], v[96:99], v[160:163]
    v_mfma_f32_16x16x32_bf16 v[164:167], v[68:71], v[100:103], v[164:167]
    v_mfma_f32_16x16x32_bf16 v[168:171], v[68:71], v[104:107], v[168:171]
    v_mfma_f32_16x16x32_bf16 v[172:175], v[68:71], v[108:111], v[172:175]
    s_add_u32 s93, s91, 893952
    buffer_load_dwordx4 v[68:71], v2, s[24:27], s93 offen
    s_waitcnt vmcnt(30)
    v_mfma_f32_16x16x32_bf16 v[176:179], v[72:75], v[96:99], v[176:179]
    v_mfma_f32_16x16x32_bf16 v[180:183], v[72:75], v[100:103], v[180:183]
    v_mfma_f32_16x16x32_bf16 v[184:187], v[72:75], v[104:107], v[184:187]
    v_mfma_f32_16x16x32_bf16 v[188:191], v[72:75], v[108:111], v[188:191]
    s_add_u32 s93, s91, 1041408
    buffer_load_dwordx4 v[72:75], v2, s[24:27], s93 offen
    s_waitcnt vmcnt(30)
    v_mfma_f32_16x16x32_bf16 v[192:195], v[76:79], v[96:99], v[192:195]
    v_mfma_f32_16x16x32_bf16 v[196:199], v[76:79], v[100:103], v[196:199]
    v_mfma_f32_16x16x32_bf16 v[200:203], v[76:79], v[104:107], v[200:203]
    v_mfma_f32_16x16x32_bf16 v[204:207], v[76:79], v[108:111], v[204:207]
    s_add_u32 s93, s91, 1188864
    buffer_load_dwordx4 v[76:79], v2, s[24:27], s93 offen
    s_waitcnt lgkmcnt(0)
    ds_read_b128 v[96:99], v2 offset:1024
    ds_read_b128 v[100:103], v2 offset:19456
    ds_read_b128 v[104:107], v3 offset:1024
    ds_read_b128 v[108:111], v3 offset:19456
    s_waitcnt vmcnt(30)
    v_mfma_f32_16x16x32_bf16 v[112:115], v[208:211], v[80:83], 0
    v_mfma_f32_16x16x32_bf16 v[116:119], v[208:211], v[84:87], 0
    v_mfma_f32_16x16x32_bf16 v[120:123], v[208:211], v[88:91], 0
    v_mfma_f32_16x16x32_bf16 v[124:127], v[208:211], v[92:95], 0
    s_add_u32 s93, s91, 894976
    buffer_load_dwordx4 v[208:211], v2, s[24:27], s93 offen
    s_waitcnt vmcnt(30)
    v_mfma_f32_16x16x32_bf16 v[128:131], v[212:215], v[80:83], 0
    v_mfma_f32_16x16x32_bf16 v[132:135], v[212:215], v[84:87], 0
    v_mfma_f32_16x16x32_bf16 v[136:139], v[212:215], v[88:91], 0
    v_mfma_f32_16x16x32_bf16 v[140:143], v[212:215], v[92:95], 0
    s_add_u32 s93, s91, 1042432
    buffer_load_dwordx4 v[212:215], v2, s[24:27], s93 offen
    s_waitcnt vmcnt(30)
    v_mfma_f32_16x16x32_bf16 v[144:147], v[216:219], v[80:83], 0
    v_mfma_f32_16x16x32_bf16 v[148:151], v[216:219], v[84:87], 0
    v_mfma_f32_16x16x32_bf16 v[152:155], v[216:219], v[88:91], 0
    v_mfma_f32_16x16x32_bf16 v[156:159], v[216:219], v[92:95], 0
    s_add_u32 s93, s91, 1189888
    buffer_load_dwordx4 v[216:219], v2, s[24:27], s93 offen
    s_waitcnt lgkmcnt(0)
    ds_read_b128 v[80:83], v2 offset:2048
    ds_read_b128 v[84:87], v2 offset:20480
    ds_read_b128 v[88:91], v3 offset:2048
    ds_read_b128 v[92:95], v3 offset:20480
    s_waitcnt vmcnt(30)
    v_mfma_f32_16x16x32_bf16 v[112:115], v[220:223], v[96:99], v[112:115]
    v_mfma_f32_16x16x32_bf16 v[116:119], v[220:223], v[100:103], v[116:119]
    v_mfma_f32_16x16x32_bf16 v[120:123], v[220:223], v[104:107], v[120:123]
    v_mfma_f32_16x16x32_bf16 v[124:127], v[220:223], v[108:111], v[124:127]
    v_cvt_pk_bf16_f32 v160, v160, v161
    v_cvt_pk_bf16_f32 v161, v162, v163
    v_cvt_pk_bf16_f32 v162, v164, v165
    v_cvt_pk_bf16_f32 v163, v166, v167
    s_add_u32 s93, s92, 3072
    buffer_store_dwordx4 v[160:163], v2, s[12:15], s93 offen sc0 sc1
    s_add_u32 s93, s91, 896000
    buffer_load_dwordx4 v[220:223], v2, s[24:27], s93 offen
    s_waitcnt vmcnt(31)
    v_mfma_f32_16x16x32_bf16 v[128:131], v[224:227], v[96:99], v[128:131]
    v_mfma_f32_16x16x32_bf16 v[132:135], v[224:227], v[100:103], v[132:135]
    v_mfma_f32_16x16x32_bf16 v[136:139], v[224:227], v[104:107], v[136:139]
    v_mfma_f32_16x16x32_bf16 v[140:143], v[224:227], v[108:111], v[140:143]
    v_cvt_pk_bf16_f32 v168, v168, v169
    v_cvt_pk_bf16_f32 v169, v170, v171
    v_cvt_pk_bf16_f32 v170, v172, v173
    v_cvt_pk_bf16_f32 v171, v174, v175
    s_add_u32 s93, s92, 39936
    buffer_store_dwordx4 v[168:171], v2, s[12:15], s93 offen sc0 sc1
    s_add_u32 s93, s91, 1043456
    buffer_load_dwordx4 v[224:227], v2, s[24:27], s93 offen
    s_waitcnt vmcnt(32)
    v_mfma_f32_16x16x32_bf16 v[144:147], v[228:231], v[96:99], v[144:147]
    v_mfma_f32_16x16x32_bf16 v[148:151], v[228:231], v[100:103], v[148:151]
    v_mfma_f32_16x16x32_bf16 v[152:155], v[228:231], v[104:107], v[152:155]
    v_mfma_f32_16x16x32_bf16 v[156:159], v[228:231], v[108:111], v[156:159]
    v_cvt_pk_bf16_f32 v176, v176, v177
    v_cvt_pk_bf16_f32 v177, v178, v179
    v_cvt_pk_bf16_f32 v178, v180, v181
    v_cvt_pk_bf16_f32 v179, v182, v183
    s_add_u32 s93, s92, 4096
    buffer_store_dwordx4 v[176:179], v2, s[12:15], s93 offen sc0 sc1
    s_add_u32 s93, s91, 1190912
    buffer_load_dwordx4 v[228:231], v2, s[24:27], s93 offen
    s_waitcnt lgkmcnt(0)
    ds_read_b128 v[96:99], v2 offset:3072
    ds_read_b128 v[100:103], v2 offset:21504
    ds_read_b128 v[104:107], v3 offset:3072
    ds_read_b128 v[108:111], v3 offset:21504
    s_waitcnt vmcnt(33)
    v_mfma_f32_16x16x32_bf16 v[112:115], v[232:235], v[80:83], v[112:115]
    v_mfma_f32_16x16x32_bf16 v[116:119], v[232:235], v[84:87], v[116:119]
    v_mfma_f32_16x16x32_bf16 v[120:123], v[232:235], v[88:91], v[120:123]
    v_mfma_f32_16x16x32_bf16 v[124:127], v[232:235], v[92:95], v[124:127]
    v_cvt_pk_bf16_f32 v184, v184, v185
    v_cvt_pk_bf16_f32 v185, v186, v187
    v_cvt_pk_bf16_f32 v186, v188, v189
    v_cvt_pk_bf16_f32 v187, v190, v191
    s_add_u32 s93, s92, 40960
    buffer_store_dwordx4 v[184:187], v2, s[12:15], s93 offen sc0 sc1
    s_add_u32 s93, s91, 897024
    buffer_load_dwordx4 v[232:235], v2, s[24:27], s93 offen
    s_waitcnt vmcnt(34)
    v_mfma_f32_16x16x32_bf16 v[128:131], v[236:239], v[80:83], v[128:131]
    v_mfma_f32_16x16x32_bf16 v[132:135], v[236:239], v[84:87], v[132:135]
    v_mfma_f32_16x16x32_bf16 v[136:139], v[236:239], v[88:91], v[136:139]
    v_mfma_f32_16x16x32_bf16 v[140:143], v[236:239], v[92:95], v[140:143]
    v_cvt_pk_bf16_f32 v192, v192, v193
    v_cvt_pk_bf16_f32 v193, v194, v195
    v_cvt_pk_bf16_f32 v194, v196, v197
    v_cvt_pk_bf16_f32 v195, v198, v199
    s_add_u32 s93, s92, 5120
    buffer_store_dwordx4 v[192:195], v2, s[12:15], s93 offen sc0 sc1
    s_add_u32 s93, s91, 1044480
    buffer_load_dwordx4 v[236:239], v2, s[24:27], s93 offen
    s_waitcnt vmcnt(35)
    v_mfma_f32_16x16x32_bf16 v[144:147], v[240:243], v[80:83], v[144:147]
    v_mfma_f32_16x16x32_bf16 v[148:151], v[240:243], v[84:87], v[148:151]
    v_mfma_f32_16x16x32_bf16 v[152:155], v[240:243], v[88:91], v[152:155]
    v_mfma_f32_16x16x32_bf16 v[156:159], v[240:243], v[92:95], v[156:159]
    v_cvt_pk_bf16_f32 v200, v200, v201
    v_cvt_pk_bf16_f32 v201, v202, v203
    v_cvt_pk_bf16_f32 v202, v204, v205
    v_cvt_pk_bf16_f32 v203, v206, v207
    s_add_u32 s93, s92, 41984
    buffer_store_dwordx4 v[200:203], v2, s[12:15], s93 offen sc0 sc1
    s_add_u32 s93, s91, 1191936
    buffer_load_dwordx4 v[240:243], v2, s[24:27], s93 offen
    s_waitcnt lgkmcnt(0)
    ds_read_b128 v[80:83], v2 offset:4096
    ds_read_b128 v[84:87], v2 offset:22528
    ds_read_b128 v[88:91], v3 offset:4096
    ds_read_b128 v[92:95], v3 offset:22528
    s_waitcnt vmcnt(36)
    v_mfma_f32_16x16x32_bf16 v[112:115], v[244:247], v[96:99], v[112:115]
    v_mfma_f32_16x16x32_bf16 v[116:119], v[244:247], v[100:103], v[116:119]
    v_mfma_f32_16x16x32_bf16 v[120:123], v[244:247], v[104:107], v[120:123]
    v_mfma_f32_16x16x32_bf16 v[124:127], v[244:247], v[108:111], v[124:127]
    s_add_u32 s93, s91, 898048
    buffer_load_dwordx4 v[244:247], v2, s[24:27], s93 offen
    s_waitcnt vmcnt(36)
    v_mfma_f32_16x16x32_bf16 v[128:131], v[248:251], v[96:99], v[128:131]
    v_mfma_f32_16x16x32_bf16 v[132:135], v[248:251], v[100:103], v[132:135]
    v_mfma_f32_16x16x32_bf16 v[136:139], v[248:251], v[104:107], v[136:139]
    v_mfma_f32_16x16x32_bf16 v[140:143], v[248:251], v[108:111], v[140:143]
    s_add_u32 s93, s91, 1045504
    buffer_load_dwordx4 v[248:251], v2, s[24:27], s93 offen
    s_waitcnt vmcnt(36)
    v_mfma_f32_16x16x32_bf16 v[144:147], v[252:255], v[96:99], v[144:147]
    v_mfma_f32_16x16x32_bf16 v[148:151], v[252:255], v[100:103], v[148:151]
    v_mfma_f32_16x16x32_bf16 v[152:155], v[252:255], v[104:107], v[152:155]
    v_mfma_f32_16x16x32_bf16 v[156:159], v[252:255], v[108:111], v[156:159]
    s_add_u32 s93, s91, 1192960
    buffer_load_dwordx4 v[252:255], v2, s[24:27], s93 offen
    s_waitcnt lgkmcnt(0)
    ds_read_b128 v[96:99], v2 offset:5120
    ds_read_b128 v[100:103], v2 offset:23552
    ds_read_b128 v[104:107], v3 offset:5120
    ds_read_b128 v[108:111], v3 offset:23552
    s_waitcnt vmcnt(36)
    v_mfma_f32_16x16x32_bf16 v[112:115], v[8:11], v[80:83], v[112:115]
    v_mfma_f32_16x16x32_bf16 v[116:119], v[8:11], v[84:87], v[116:119]
    v_mfma_f32_16x16x32_bf16 v[120:123], v[8:11], v[88:91], v[120:123]
    v_mfma_f32_16x16x32_bf16 v[124:127], v[8:11], v[92:95], v[124:127]
    s_add_u32 s93, s91, 899072
    buffer_load_dwordx4 v[8:11], v2, s[24:27], s93 offen
    s_waitcnt vmcnt(36)
    v_mfma_f32_16x16x32_bf16 v[128:131], v[12:15], v[80:83], v[128:131]
    v_mfma_f32_16x16x32_bf16 v[132:135], v[12:15], v[84:87], v[132:135]
    v_mfma_f32_16x16x32_bf16 v[136:139], v[12:15], v[88:91], v[136:139]
    v_mfma_f32_16x16x32_bf16 v[140:143], v[12:15], v[92:95], v[140:143]
    s_add_u32 s93, s91, 1046528
    buffer_load_dwordx4 v[12:15], v2, s[24:27], s93 offen
    s_waitcnt vmcnt(35)
    v_mfma_f32_16x16x32_bf16 v[144:147], v[16:19], v[80:83], v[144:147]
    v_mfma_f32_16x16x32_bf16 v[148:151], v[16:19], v[84:87], v[148:151]
    v_mfma_f32_16x16x32_bf16 v[152:155], v[16:19], v[88:91], v[152:155]
    v_mfma_f32_16x16x32_bf16 v[156:159], v[16:19], v[92:95], v[156:159]
    s_add_u32 s93, s91, 1193984
    buffer_load_dwordx4 v[16:19], v2, s[24:27], s93 offen
    s_waitcnt lgkmcnt(0)
    ds_read_b128 v[80:83], v2 offset:6144
    ds_read_b128 v[84:87], v2 offset:24576
    ds_read_b128 v[88:91], v3 offset:6144
    ds_read_b128 v[92:95], v3 offset:24576
    s_waitcnt vmcnt(35)
    v_mfma_f32_16x16x32_bf16 v[112:115], v[20:23], v[96:99], v[112:115]
    v_mfma_f32_16x16x32_bf16 v[116:119], v[20:23], v[100:103], v[116:119]
    v_mfma_f32_16x16x32_bf16 v[120:123], v[20:23], v[104:107], v[120:123]
    v_mfma_f32_16x16x32_bf16 v[124:127], v[20:23], v[108:111], v[124:127]
    s_add_u32 s93, s91, 900096
    buffer_load_dwordx4 v[20:23], v2, s[24:27], s93 offen
    s_waitcnt vmcnt(35)
    v_mfma_f32_16x16x32_bf16 v[128:131], v[24:27], v[96:99], v[128:131]
    v_mfma_f32_16x16x32_bf16 v[132:135], v[24:27], v[100:103], v[132:135]
    v_mfma_f32_16x16x32_bf16 v[136:139], v[24:27], v[104:107], v[136:139]
    v_mfma_f32_16x16x32_bf16 v[140:143], v[24:27], v[108:111], v[140:143]
    s_add_u32 s93, s91, 1047552
    buffer_load_dwordx4 v[24:27], v2, s[24:27], s93 offen
    s_waitcnt vmcnt(35)
    v_mfma_f32_16x16x32_bf16 v[144:147], v[28:31], v[96:99], v[144:147]
    v_mfma_f32_16x16x32_bf16 v[148:151], v[28:31], v[100:103], v[148:151]
    v_mfma_f32_16x16x32_bf16 v[152:155], v[28:31], v[104:107], v[152:155]
    v_mfma_f32_16x16x32_bf16 v[156:159], v[28:31], v[108:111], v[156:159]
    s_add_u32 s93, s91, 1195008
    buffer_load_dwordx4 v[28:31], v2, s[24:27], s93 offen
    s_waitcnt lgkmcnt(0)
    ds_read_b128 v[96:99], v2 offset:7168
    ds_read_b128 v[100:103], v2 offset:25600
    ds_read_b128 v[104:107], v3 offset:7168
    ds_read_b128 v[108:111], v3 offset:25600
    s_waitcnt vmcnt(35)
    v_mfma_f32_16x16x32_bf16 v[112:115], v[32:35], v[80:83], v[112:115]
    v_mfma_f32_16x16x32_bf16 v[116:119], v[32:35], v[84:87], v[116:119]
    v_mfma_f32_16x16x32_bf16 v[120:123], v[32:35], v[88:91], v[120:123]
    v_mfma_f32_16x16x32_bf16 v[124:127], v[32:35], v[92:95], v[124:127]
    s_add_u32 s93, s91, 901120
    buffer_load_dwordx4 v[32:35], v2, s[24:27], s93 offen
    s_waitcnt vmcnt(35)
    v_mfma_f32_16x16x32_bf16 v[128:131], v[36:39], v[80:83], v[128:131]
    v_mfma_f32_16x16x32_bf16 v[132:135], v[36:39], v[84:87], v[132:135]
    v_mfma_f32_16x16x32_bf16 v[136:139], v[36:39], v[88:91], v[136:139]
    v_mfma_f32_16x16x32_bf16 v[140:143], v[36:39], v[92:95], v[140:143]
    s_add_u32 s93, s91, 1048576
    buffer_load_dwordx4 v[36:39], v2, s[24:27], s93 offen
    s_waitcnt vmcnt(35)
    v_mfma_f32_16x16x32_bf16 v[144:147], v[40:43], v[80:83], v[144:147]
    v_mfma_f32_16x16x32_bf16 v[148:151], v[40:43], v[84:87], v[148:151]
    v_mfma_f32_16x16x32_bf16 v[152:155], v[40:43], v[88:91], v[152:155]
    v_mfma_f32_16x16x32_bf16 v[156:159], v[40:43], v[92:95], v[156:159]
    s_add_u32 s93, s91, 1196032
    buffer_load_dwordx4 v[40:43], v2, s[24:27], s93 offen
    s_waitcnt lgkmcnt(0)
    ds_read_b128 v[80:83], v2 offset:8192
    ds_read_b128 v[84:87], v2 offset:26624
    ds_read_b128 v[88:91], v3 offset:8192
    ds_read_b128 v[92:95], v3 offset:26624
    s_waitcnt vmcnt(35)
    v_mfma_f32_16x16x32_bf16 v[112:115], v[44:47], v[96:99], v[112:115]
    v_mfma_f32_16x16x32_bf16 v[116:119], v[44:47], v[100:103], v[116:119]
    v_mfma_f32_16x16x32_bf16 v[120:123], v[44:47], v[104:107], v[120:123]
    v_mfma_f32_16x16x32_bf16 v[124:127], v[44:47], v[108:111], v[124:127]
    s_add_u32 s93, s91, 902144
    buffer_load_dwordx4 v[44:47], v2, s[24:27], s93 offen
    s_waitcnt vmcnt(35)
    v_mfma_f32_16x16x32_bf16 v[128:131], v[48:51], v[96:99], v[128:131]
    v_mfma_f32_16x16x32_bf16 v[132:135], v[48:51], v[100:103], v[132:135]
    v_mfma_f32_16x16x32_bf16 v[136:139], v[48:51], v[104:107], v[136:139]
    v_mfma_f32_16x16x32_bf16 v[140:143], v[48:51], v[108:111], v[140:143]
    s_add_u32 s93, s91, 1049600
    buffer_load_dwordx4 v[48:51], v2, s[24:27], s93 offen
    s_waitcnt vmcnt(35)
    v_mfma_f32_16x16x32_bf16 v[144:147], v[52:55], v[96:99], v[144:147]
    v_mfma_f32_16x16x32_bf16 v[148:151], v[52:55], v[100:103], v[148:151]
    v_mfma_f32_16x16x32_bf16 v[152:155], v[52:55], v[104:107], v[152:155]
    v_mfma_f32_16x16x32_bf16 v[156:159], v[52:55], v[108:111], v[156:159]
    s_add_u32 s93, s91, 1197056
    buffer_load_dwordx4 v[52:55], v2, s[24:27], s93 offen
    s_waitcnt lgkmcnt(0)
    ds_read_b128 v[96:99], v2 offset:9216
    ds_read_b128 v[100:103], v2 offset:27648
    ds_read_b128 v[104:107], v3 offset:9216
    ds_read_b128 v[108:111], v3 offset:27648
    s_waitcnt vmcnt(35)
    v_mfma_f32_16x16x32_bf16 v[112:115], v[56:59], v[80:83], v[112:115]
    v_mfma_f32_16x16x32_bf16 v[116:119], v[56:59], v[84:87], v[116:119]
    v_mfma_f32_16x16x32_bf16 v[120:123], v[56:59], v[88:91], v[120:123]
    v_mfma_f32_16x16x32_bf16 v[124:127], v[56:59], v[92:95], v[124:127]
    s_waitcnt vmcnt(34)
    v_mfma_f32_16x16x32_bf16 v[128:131], v[60:63], v[80:83], v[128:131]
    v_mfma_f32_16x16x32_bf16 v[132:135], v[60:63], v[84:87], v[132:135]
    v_mfma_f32_16x16x32_bf16 v[136:139], v[60:63], v[88:91], v[136:139]
    v_mfma_f32_16x16x32_bf16 v[140:143], v[60:63], v[92:95], v[140:143]
    s_waitcnt vmcnt(33)
    v_mfma_f32_16x16x32_bf16 v[144:147], v[64:67], v[80:83], v[144:147]
    v_mfma_f32_16x16x32_bf16 v[148:151], v[64:67], v[84:87], v[148:151]
    v_mfma_f32_16x16x32_bf16 v[152:155], v[64:67], v[88:91], v[152:155]
    v_mfma_f32_16x16x32_bf16 v[156:159], v[64:67], v[92:95], v[156:159]
    s_waitcnt lgkmcnt(0)
    ds_read_b128 v[80:83], v2 offset:10240
    ds_read_b128 v[84:87], v2 offset:28672
    ds_read_b128 v[88:91], v3 offset:10240
    ds_read_b128 v[92:95], v3 offset:28672
    s_waitcnt vmcnt(32)
    v_mfma_f32_16x16x32_bf16 v[112:115], v[68:71], v[96:99], v[112:115]
    v_mfma_f32_16x16x32_bf16 v[116:119], v[68:71], v[100:103], v[116:119]
    v_mfma_f32_16x16x32_bf16 v[120:123], v[68:71], v[104:107], v[120:123]
    v_mfma_f32_16x16x32_bf16 v[124:127], v[68:71], v[108:111], v[124:127]
    s_waitcnt vmcnt(31)
    v_mfma_f32_16x16x32_bf16 v[128:131], v[72:75], v[96:99], v[128:131]
    v_mfma_f32_16x16x32_bf16 v[132:135], v[72:75], v[100:103], v[132:135]
    v_mfma_f32_16x16x32_bf16 v[136:139], v[72:75], v[104:107], v[136:139]
    v_mfma_f32_16x16x32_bf16 v[140:143], v[72:75], v[108:111], v[140:143]
    s_waitcnt vmcnt(30)
    v_mfma_f32_16x16x32_bf16 v[144:147], v[76:79], v[96:99], v[144:147]
    v_mfma_f32_16x16x32_bf16 v[148:151], v[76:79], v[100:103], v[148:151]
    v_mfma_f32_16x16x32_bf16 v[152:155], v[76:79], v[104:107], v[152:155]
    v_mfma_f32_16x16x32_bf16 v[156:159], v[76:79], v[108:111], v[156:159]
    s_waitcnt lgkmcnt(0)
    ds_read_b128 v[96:99], v2 offset:11264
    ds_read_b128 v[100:103], v2 offset:29696
    ds_read_b128 v[104:107], v3 offset:11264
    ds_read_b128 v[108:111], v3 offset:29696
    s_waitcnt vmcnt(29)
    v_mfma_f32_16x16x32_bf16 v[112:115], v[208:211], v[80:83], v[112:115]
    v_mfma_f32_16x16x32_bf16 v[116:119], v[208:211], v[84:87], v[116:119]
    v_mfma_f32_16x16x32_bf16 v[120:123], v[208:211], v[88:91], v[120:123]
    v_mfma_f32_16x16x32_bf16 v[124:127], v[208:211], v[92:95], v[124:127]
    s_waitcnt vmcnt(28)
    v_mfma_f32_16x16x32_bf16 v[128:131], v[212:215], v[80:83], v[128:131]
    v_mfma_f32_16x16x32_bf16 v[132:135], v[212:215], v[84:87], v[132:135]
    v_mfma_f32_16x16x32_bf16 v[136:139], v[212:215], v[88:91], v[136:139]
    v_mfma_f32_16x16x32_bf16 v[140:143], v[212:215], v[92:95], v[140:143]
    s_waitcnt vmcnt(27)
    v_mfma_f32_16x16x32_bf16 v[144:147], v[216:219], v[80:83], v[144:147]
    v_mfma_f32_16x16x32_bf16 v[148:151], v[216:219], v[84:87], v[148:151]
    v_mfma_f32_16x16x32_bf16 v[152:155], v[216:219], v[88:91], v[152:155]
    v_mfma_f32_16x16x32_bf16 v[156:159], v[216:219], v[92:95], v[156:159]
    s_waitcnt lgkmcnt(0)
    ds_read_b128 v[80:83], v2 offset:12288
    ds_read_b128 v[84:87], v2 offset:30720
    ds_read_b128 v[88:91], v3 offset:12288
    ds_read_b128 v[92:95], v3 offset:30720
    s_waitcnt vmcnt(25)
    v_mfma_f32_16x16x32_bf16 v[112:115], v[220:223], v[96:99], v[112:115]
    v_mfma_f32_16x16x32_bf16 v[116:119], v[220:223], v[100:103], v[116:119]
    v_mfma_f32_16x16x32_bf16 v[120:123], v[220:223], v[104:107], v[120:123]
    v_mfma_f32_16x16x32_bf16 v[124:127], v[220:223], v[108:111], v[124:127]
    s_waitcnt vmcnt(23)
    v_mfma_f32_16x16x32_bf16 v[128:131], v[224:227], v[96:99], v[128:131]
    v_mfma_f32_16x16x32_bf16 v[132:135], v[224:227], v[100:103], v[132:135]
    v_mfma_f32_16x16x32_bf16 v[136:139], v[224:227], v[104:107], v[136:139]
    v_mfma_f32_16x16x32_bf16 v[140:143], v[224:227], v[108:111], v[140:143]
    s_waitcnt vmcnt(21)
    v_mfma_f32_16x16x32_bf16 v[144:147], v[228:231], v[96:99], v[144:147]
    v_mfma_f32_16x16x32_bf16 v[148:151], v[228:231], v[100:103], v[148:151]
    v_mfma_f32_16x16x32_bf16 v[152:155], v[228:231], v[104:107], v[152:155]
    v_mfma_f32_16x16x32_bf16 v[156:159], v[228:231], v[108:111], v[156:159]
    s_waitcnt lgkmcnt(0)
    ds_read_b128 v[96:99], v2 offset:13312
    ds_read_b128 v[100:103], v2 offset:31744
    ds_read_b128 v[104:107], v3 offset:13312
    ds_read_b128 v[108:111], v3 offset:31744
    s_waitcnt vmcnt(19)
    v_mfma_f32_16x16x32_bf16 v[112:115], v[232:235], v[80:83], v[112:115]
    v_mfma_f32_16x16x32_bf16 v[116:119], v[232:235], v[84:87], v[116:119]
    v_mfma_f32_16x16x32_bf16 v[120:123], v[232:235], v[88:91], v[120:123]
    v_mfma_f32_16x16x32_bf16 v[124:127], v[232:235], v[92:95], v[124:127]
    s_waitcnt vmcnt(17)
    v_mfma_f32_16x16x32_bf16 v[128:131], v[236:239], v[80:83], v[128:131]
    v_mfma_f32_16x16x32_bf16 v[132:135], v[236:239], v[84:87], v[132:135]
    v_mfma_f32_16x16x32_bf16 v[136:139], v[236:239], v[88:91], v[136:139]
    v_mfma_f32_16x16x32_bf16 v[140:143], v[236:239], v[92:95], v[140:143]
    s_waitcnt vmcnt(15)
    s_mov_b64 exec, 1
    buffer_store_dword v4, v7, s[28:31], s60 offen offset:64 sc0 sc1
    s_mov_b64 exec, -1
    v_mfma_f32_16x16x32_bf16 v[144:147], v[240:243], v[80:83], v[144:147]
    v_mfma_f32_16x16x32_bf16 v[148:151], v[240:243], v[84:87], v[148:151]
    v_mfma_f32_16x16x32_bf16 v[152:155], v[240:243], v[88:91], v[152:155]
    v_mfma_f32_16x16x32_bf16 v[156:159], v[240:243], v[92:95], v[156:159]
    s_waitcnt lgkmcnt(0)
    ds_read_b128 v[80:83], v2 offset:14336
    ds_read_b128 v[84:87], v2 offset:32768
    ds_read_b128 v[88:91], v3 offset:14336
    ds_read_b128 v[92:95], v3 offset:32768
    s_waitcnt vmcnt(15)
    v_mfma_f32_16x16x32_bf16 v[112:115], v[244:247], v[96:99], v[112:115]
    v_mfma_f32_16x16x32_bf16 v[116:119], v[244:247], v[100:103], v[116:119]
    v_mfma_f32_16x16x32_bf16 v[120:123], v[244:247], v[104:107], v[120:123]
    v_mfma_f32_16x16x32_bf16 v[124:127], v[244:247], v[108:111], v[124:127]
    s_waitcnt vmcnt(14)
    v_mfma_f32_16x16x32_bf16 v[128:131], v[248:251], v[96:99], v[128:131]
    v_mfma_f32_16x16x32_bf16 v[132:135], v[248:251], v[100:103], v[132:135]
    v_mfma_f32_16x16x32_bf16 v[136:139], v[248:251], v[104:107], v[136:139]
    v_mfma_f32_16x16x32_bf16 v[140:143], v[248:251], v[108:111], v[140:143]
    s_waitcnt vmcnt(13)
    v_mfma_f32_16x16x32_bf16 v[144:147], v[252:255], v[96:99], v[144:147]
    v_mfma_f32_16x16x32_bf16 v[148:151], v[252:255], v[100:103], v[148:151]
    v_mfma_f32_16x16x32_bf16 v[152:155], v[252:255], v[104:107], v[152:155]
    v_mfma_f32_16x16x32_bf16 v[156:159], v[252:255], v[108:111], v[156:159]
    s_waitcnt lgkmcnt(0)
    ds_read_b128 v[96:99], v2 offset:15360
    ds_read_b128 v[100:103], v2 offset:33792
    ds_read_b128 v[104:107], v3 offset:15360
    ds_read_b128 v[108:111], v3 offset:33792
    s_waitcnt vmcnt(12)
    v_mfma_f32_16x16x32_bf16 v[112:115], v[8:11], v[80:83], v[112:115]
    v_mfma_f32_16x16x32_bf16 v[116:119], v[8:11], v[84:87], v[116:119]
    v_mfma_f32_16x16x32_bf16 v[120:123], v[8:11], v[88:91], v[120:123]
    v_mfma_f32_16x16x32_bf16 v[124:127], v[8:11], v[92:95], v[124:127]
    s_waitcnt vmcnt(11)
    v_mfma_f32_16x16x32_bf16 v[128:131], v[12:15], v[80:83], v[128:131]
    v_mfma_f32_16x16x32_bf16 v[132:135], v[12:15], v[84:87], v[132:135]
    v_mfma_f32_16x16x32_bf16 v[136:139], v[12:15], v[88:91], v[136:139]
    v_mfma_f32_16x16x32_bf16 v[140:143], v[12:15], v[92:95], v[140:143]
    s_waitcnt vmcnt(10)
    v_mfma_f32_16x16x32_bf16 v[144:147], v[16:19], v[80:83], v[144:147]
    v_mfma_f32_16x16x32_bf16 v[148:151], v[16:19], v[84:87], v[148:151]
    v_mfma_f32_16x16x32_bf16 v[152:155], v[16:19], v[88:91], v[152:155]
    v_mfma_f32_16x16x32_bf16 v[156:159], v[16:19], v[92:95], v[156:159]
    s_waitcnt lgkmcnt(0)
    ds_read_b128 v[80:83], v2 offset:16384
    ds_read_b128 v[84:87], v2 offset:34816
    ds_read_b128 v[88:91], v3 offset:16384
    ds_read_b128 v[92:95], v3 offset:34816
    s_waitcnt vmcnt(9)
    v_mfma_f32_16x16x32_bf16 v[112:115], v[20:23], v[96:99], v[112:115]
    v_mfma_f32_16x16x32_bf16 v[116:119], v[20:23], v[100:103], v[116:119]
    v_mfma_f32_16x16x32_bf16 v[120:123], v[20:23], v[104:107], v[120:123]
    v_mfma_f32_16x16x32_bf16 v[124:127], v[20:23], v[108:111], v[124:127]
    s_waitcnt vmcnt(8)
    v_mfma_f32_16x16x32_bf16 v[128:131], v[24:27], v[96:99], v[128:131]
    v_mfma_f32_16x16x32_bf16 v[132:135], v[24:27], v[100:103], v[132:135]
    v_mfma_f32_16x16x32_bf16 v[136:139], v[24:27], v[104:107], v[136:139]
    v_mfma_f32_16x16x32_bf16 v[140:143], v[24:27], v[108:111], v[140:143]
    s_waitcnt vmcnt(7)
    v_mfma_f32_16x16x32_bf16 v[144:147], v[28:31], v[96:99], v[144:147]
    v_mfma_f32_16x16x32_bf16 v[148:151], v[28:31], v[100:103], v[148:151]
    v_mfma_f32_16x16x32_bf16 v[152:155], v[28:31], v[104:107], v[152:155]
    v_mfma_f32_16x16x32_bf16 v[156:159], v[28:31], v[108:111], v[156:159]
    s_waitcnt lgkmcnt(0)
    ds_read_b128 v[96:99], v2 offset:17408
    ds_read_b128 v[100:103], v2 offset:35840
    ds_read_b128 v[104:107], v3 offset:17408
    ds_read_b128 v[108:111], v3 offset:35840
    s_waitcnt vmcnt(6)
    v_mfma_f32_16x16x32_bf16 v[112:115], v[32:35], v[80:83], v[112:115]
    v_mfma_f32_16x16x32_bf16 v[116:119], v[32:35], v[84:87], v[116:119]
    v_mfma_f32_16x16x32_bf16 v[120:123], v[32:35], v[88:91], v[120:123]
    v_mfma_f32_16x16x32_bf16 v[124:127], v[32:35], v[92:95], v[124:127]
    s_waitcnt vmcnt(5)
    v_mfma_f32_16x16x32_bf16 v[128:131], v[36:39], v[80:83], v[128:131]
    v_mfma_f32_16x16x32_bf16 v[132:135], v[36:39], v[84:87], v[132:135]
    v_mfma_f32_16x16x32_bf16 v[136:139], v[36:39], v[88:91], v[136:139]
    v_mfma_f32_16x16x32_bf16 v[140:143], v[36:39], v[92:95], v[140:143]
    s_waitcnt vmcnt(4)
    v_mfma_f32_16x16x32_bf16 v[144:147], v[40:43], v[80:83], v[144:147]
    v_mfma_f32_16x16x32_bf16 v[148:151], v[40:43], v[84:87], v[148:151]
    v_mfma_f32_16x16x32_bf16 v[152:155], v[40:43], v[88:91], v[152:155]
    v_mfma_f32_16x16x32_bf16 v[156:159], v[40:43], v[92:95], v[156:159]
    s_waitcnt lgkmcnt(0)
    s_waitcnt vmcnt(3)
    v_mfma_f32_16x16x32_bf16 v[112:115], v[44:47], v[96:99], v[112:115]
    v_mfma_f32_16x16x32_bf16 v[116:119], v[44:47], v[100:103], v[116:119]
    v_mfma_f32_16x16x32_bf16 v[120:123], v[44:47], v[104:107], v[120:123]
    v_mfma_f32_16x16x32_bf16 v[124:127], v[44:47], v[108:111], v[124:127]
    s_waitcnt vmcnt(2)
    v_mfma_f32_16x16x32_bf16 v[128:131], v[48:51], v[96:99], v[128:131]
    v_mfma_f32_16x16x32_bf16 v[132:135], v[48:51], v[100:103], v[132:135]
    v_mfma_f32_16x16x32_bf16 v[136:139], v[48:51], v[104:107], v[136:139]
    v_mfma_f32_16x16x32_bf16 v[140:143], v[48:51], v[108:111], v[140:143]
    s_waitcnt vmcnt(1)
    v_mfma_f32_16x16x32_bf16 v[144:147], v[52:55], v[96:99], v[144:147]
    v_mfma_f32_16x16x32_bf16 v[148:151], v[52:55], v[100:103], v[148:151]
    v_mfma_f32_16x16x32_bf16 v[152:155], v[52:55], v[104:107], v[152:155]
    v_mfma_f32_16x16x32_bf16 v[156:159], v[52:55], v[108:111], v[156:159]
    s_nop 15
    v_cvt_pk_bf16_f32 v112, v112, v113
    v_cvt_pk_bf16_f32 v113, v114, v115
    v_cvt_pk_bf16_f32 v114, v116, v117
    v_cvt_pk_bf16_f32 v115, v118, v119
    s_add_u32 s93, s92, 6144
    buffer_store_dwordx4 v[112:115], v2, s[12:15], s93 offen sc0 sc1
    v_cvt_pk_bf16_f32 v120, v120, v121
    v_cvt_pk_bf16_f32 v121, v122, v123
    v_cvt_pk_bf16_f32 v122, v124, v125
    v_cvt_pk_bf16_f32 v123, v126, v127
    s_add_u32 s93, s92, 43008
    buffer_store_dwordx4 v[120:123], v2, s[12:15], s93 offen sc0 sc1
    v_cvt_pk_bf16_f32 v128, v128, v129
    v_cvt_pk_bf16_f32 v129, v130, v131
    v_cvt_pk_bf16_f32 v130, v132, v133
    v_cvt_pk_bf16_f32 v131, v134, v135
    s_add_u32 s93, s92, 7168
    buffer_store_dwordx4 v[128:131], v2, s[12:15], s93 offen sc0 sc1
    v_cvt_pk_bf16_f32 v136, v136, v137
    v_cvt_pk_bf16_f32 v137, v138, v139
    v_cvt_pk_bf16_f32 v138, v140, v141
    v_cvt_pk_bf16_f32 v139, v142, v143
    s_add_u32 s93, s92, 44032
    buffer_store_dwordx4 v[136:139], v2, s[12:15], s93 offen sc0 sc1
    v_cvt_pk_bf16_f32 v144, v144, v145
    v_cvt_pk_bf16_f32 v145, v146, v147
    v_cvt_pk_bf16_f32 v146, v148, v149
    v_cvt_pk_bf16_f32 v147, v150, v151
    s_add_u32 s93, s92, 8192
    buffer_store_dwordx4 v[144:147], v2, s[12:15], s93 offen sc0 sc1
    v_cvt_pk_bf16_f32 v152, v152, v153
    v_cvt_pk_bf16_f32 v153, v154, v155
    v_cvt_pk_bf16_f32 v154, v156, v157
    v_cvt_pk_bf16_f32 v155, v158, v159
    s_add_u32 s93, s92, 45056
    buffer_store_dwordx4 v[152:155], v2, s[12:15], s93 offen sc0 sc1
    s_waitcnt vmcnt(0)
    s_mov_b64 exec, 1
    buffer_store_dword v4, v7, s[28:31], s60 offen offset:128 sc0 sc1
    s_mov_b64 exec, -1
    s_endpgm
CONV_ENTRY:
    s_sub_u32 s2, s2, 256
    s_cmp_ge_u32 s2, 256
    s_cbranch_scc1 C_END
    s_mov_b32 s79, s2
    s_mov_b32 s80, s16
    s_mov_b32 s81, s17
    s_add_u32 s8, s46, 2359296
    s_addc_u32 s9, s47, 0
    s_and_b32 s9, s9, 0xffff
    s_mov_b32 s10, 2359296
    s_mov_b32 s11, 0x00020000
    s_add_u32 s12, s46, 38928384
    s_addc_u32 s13, s47, 0
    s_and_b32 s13, s13, 0xffff
    s_mov_b32 s14, 50626560
    s_mov_b32 s15, 0x00020000
    s_add_u32 s4, s46, 41287680
    s_addc_u32 s5, s47, 0
    s_and_b32 s5, s5, 0xffff
    s_mov_b32 s6, 9732096
    s_mov_b32 s7, 0x00020000
    v_lshrrev_b32 v1, 6, v0
    s_nop 0
    v_readfirstlane_b32 s20, v1
    v_and_b32 v104, 63, v0
    v_lshlrev_b32 v104, 4, v104
    v_lshlrev_b32 v105, 4, v0
    v_lshrrev_b32 v4, 2, v0
    v_mul_u32_u24 v4, 80, v4
    v_and_b32 v5, 3, v0
    v_lshl_add_u32 v106, v5, 4, v4
    v_mov_b32 v108, 0
    v_mov_b32 v109, 0
    v_mov_b32 v110, 0
    v_mov_b32 v111, 0
    s_lshl_b32 s65, s2, 12
    buffer_load_dwordx4 v[100:103], v105, s[8:11], s65 offen
    s_mul_i32 s3, s2, 8448
    s_add_u32 s17, s20, 0
    s_lshl_b32 s17, s17, 10
    s_min_u32 s17, s17, 7424
    s_add_u32 s19, s3, s17
    s_add_u32 m0, s17, 7680
    s_nop 0
    buffer_load_dwordx4 v104, s[4:7], s19 offen lds
    s_add_u32 s17, s20, 4
    s_lshl_b32 s17, s17, 10
    s_min_u32 s17, s17, 7424
    s_add_u32 s19, s3, s17
    s_add_u32 m0, s17, 7680
    s_nop 0
    buffer_load_dwordx4 v104, s[4:7], s19 offen lds
    s_add_u32 s17, s20, 8
    s_lshl_b32 s17, s17, 10
    s_min_u32 s17, s17, 7424
    s_add_u32 s19, s3, s17
    s_add_u32 m0, s17, 7680
    s_nop 0
    buffer_load_dwordx4 v104, s[4:7], s19 offen lds
    s_waitcnt vmcnt(0)
    v_cmp_gt_u32 vcc, 160, v0
    s_and_saveexec_b64 s[48:49], vcc
    ds_write_b128 v105, v[108:111] offset:0
    s_or_b64 exec, exec, s[48:49]
    ds_write_b128 v106, v[100:103] offset:2560
    s_lshl_b32 s64, s2, 12
    v_and_b32 v2, 31, v0
    v_bfe_u32 v3, v0, 5, 1
    v_and_b32 v4, 1, v2
    v_mul_u32_u24 v5, 4224, v4
    v_sub_u32 v6, 2048, v2
    v_sub_u32 v6, v6, v4
    v_lshl_add_u32 v6, v3, 3, v6
    v_lshl_add_u32 v5, v6, 1, v5
    s_lshl_b32 s21, s20, 6
    s_sub_u32 s21, 7680, s21
    v_add_u32 v5, s21, v5
    v_mul_u32_u24 v9, 80, v2
    v_lshl_add_u32 v9, v3, 4, v9
    s_mul_i32 s21, s20, 80
    v_subrev_u32 v9, s21, v9
    s_add_u32 s22, s2, 256
    s_waitcnt lgkmcnt(0)
    s_barrier
    ds_read2_b32 v[28:29], v5 offset0:0 offset1:1
    ds_read2_b32 v[30:31], v5 offset0:2 offset1:3
    ds_read_b128 v[32:35], v9 offset:5120
    ds_read_b128 v[36:39], v9 offset:2560
    ds_read2_b32 v[40:41], v5 offset0:8 offset1:9
    ds_read2_b32 v[42:43], v5 offset0:10 offset1:11
    ds_read_b128 v[44:47], v9 offset:5152
    ds_read_b128 v[48:51], v9 offset:2592
    v_subrev_u32 v5, 256, v5
    v_subrev_u32 v9, 320, v9
    ds_read2_b32 v[52:53], v5 offset0:0 offset1:1
    ds_read2_b32 v[54:55], v5 offset0:2 offset1:3
    ds_read_b128 v[56:59], v9 offset:5120
    ds_read_b128 v[60:63], v9 offset:2560
    ds_read2_b32 v[64:65], v5 offset0:8 offset1:9
    ds_read2_b32 v[66:67], v5 offset0:10 offset1:11
    ds_read_b128 v[68:71], v9 offset:5152
    ds_read_b128 v[72:75], v9 offset:2592
    v_subrev_u32 v5, 256, v5
    v_subrev_u32 v9, 320, v9
    s_lshl_b32 s65, s22, 12
    buffer_load_dwordx4 v[100:103], v105, s[8:11], s65 offen
    s_mul_i32 s3, s22, 8448
    s_add_u32 s17, s20, 0
    s_lshl_b32 s17, s17, 10
    s_min_u32 s17, s17, 7424
    s_add_u32 s19, s3, s17
    s_add_u32 m0, s17, 40448
    s_nop 0
    buffer_load_dwordx4 v104, s[4:7], s19 offen lds
    s_add_u32 s17, s20, 4
    s_lshl_b32 s17, s17, 10
    s_min_u32 s17, s17, 7424
    s_add_u32 s19, s3, s17
    s_add_u32 m0, s17, 40448
    s_nop 0
    buffer_load_dwordx4 v104, s[4:7], s19 offen lds
    s_add_u32 s17, s20, 8
    s_lshl_b32 s17, s17, 10
    s_min_u32 s17, s17, 7424
    s_add_u32 s19, s3, s17
    s_add_u32 m0, s17, 40448
    s_nop 0
    buffer_load_dwordx4 v104, s[4:7], s19 offen lds
    s_waitcnt lgkmcnt(8)
    ds_read2_b32 v[76:77], v5 offset0:0 offset1:1
    ds_read2_b32 v[78:79], v5 offset0:2 offset1:3
    ds_read_b128 v[80:83], v9 offset:5120
    ds_read_b128 v[84:87], v9 offset:2560
    ds_read2_b32 v[88:89], v5 offset0:8 offset1:9
    ds_read2_b32 v[90:91], v5 offset0:10 offset1:11
    ds_read_b128 v[92:95], v9 offset:5152
    ds_read_b128 v[96:99], v9 offset:2592
    v_subrev_u32 v5, 256, v5
    v_subrev_u32 v9, 320, v9
    v_mfma_f32_32x32x16_bf16 v[112:127], v[28:31], v[32:35], 0
    v_mfma_f32_32x32x16_bf16 v[128:143], v[28:31], v[36:39], 0
    v_mfma_f32_32x32x16_bf16 v[112:127], v[40:43], v[44:47], v[112:127]
    v_mfma_f32_32x32x16_bf16 v[128:143], v[40:43], v[48:51], v[128:143]
    s_waitcnt lgkmcnt(8)
    ds_read2_b32 v[28:29], v5 offset0:0 offset1:1
    ds_read2_b32 v[30:31], v5 offset0:2 offset1:3
    ds_read_b128 v[32:35], v9 offset:5120
    ds_read_b128 v[36:39], v9 offset:2560
    ds_read2_b32 v[40:41], v5 offset0:8 offset1:9
    ds_read2_b32 v[42:43], v5 offset0:10 offset1:11
    ds_read_b128 v[44:47], v9 offset:5152
    ds_read_b128 v[48:51], v9 offset:2592
    v_subrev_u32 v5, 256, v5
    v_subrev_u32 v9, 320, v9
    v_mfma_f32_32x32x16_bf16 v[112:127], v[52:55], v[56:59], v[112:127]
    v_mfma_f32_32x32x16_bf16 v[128:143], v[52:55], v[60:63], v[128:143]
    v_mfma_f32_32x32x16_bf16 v[112:127], v[64:67], v[68:71], v[112:127]
    v_mfma_f32_32x32x16_bf16 v[128:143], v[64:67], v[72:75], v[128:143]
    s_waitcnt lgkmcnt(8)
    ds_read2_b32 v[52:53], v5 offset0:0 offset1:1
    ds_read2_b32 v[54:55], v5 offset0:2 offset1:3
    ds_read_b128 v[56:59], v9 offset:5120
    ds_read_b128 v[60:63], v9 offset:2560
    ds_read2_b32 v[64:65], v5 offset0:8 offset1:9
    ds_read2_b32 v[66:67], v5 offset0:10 offset1:11
    ds_read_b128 v[68:71], v9 offset:5152
    ds_read_b128 v[72:75], v9 offset:2592
    v_subrev_u32 v5, 256, v5
    v_subrev_u32 v9, 320, v9
    v_mfma_f32_32x32x16_bf16 v[112:127], v[76:79], v[80:83], v[112:127]
    v_mfma_f32_32x32x16_bf16 v[128:143], v[76:79], v[84:87], v[128:143]
    v_mfma_f32_32x32x16_bf16 v[112:127], v[88:91], v[92:95], v[112:127]
    v_mfma_f32_32x32x16_bf16 v[128:143], v[88:91], v[96:99], v[128:143]
    s_waitcnt lgkmcnt(8)
    ds_read2_b32 v[76:77], v5 offset0:0 offset1:1
    ds_read2_b32 v[78:79], v5 offset0:2 offset1:3
    ds_read_b128 v[80:83], v9 offset:5120
    ds_read_b128 v[84:87], v9 offset:2560
    ds_read2_b32 v[88:89], v5 offset0:8 offset1:9
    ds_read2_b32 v[90:91], v5 offset0:10 offset1:11
    ds_read_b128 v[92:95], v9 offset:5152
    ds_read_b128 v[96:99], v9 offset:2592
    v_subrev_u32 v5, 256, v5
    v_subrev_u32 v9, 320, v9
    v_mfma_f32_32x32x16_bf16 v[112:127], v[28:31], v[32:35], v[112:127]
    v_mfma_f32_32x32x16_bf16 v[128:143], v[28:31], v[36:39], v[128:143]
    v_mfma_f32_32x32x16_bf16 v[112:127], v[40:43], v[44:47], v[112:127]
    v_mfma_f32_32x32x16_bf16 v[128:143], v[40:43], v[48:51], v[128:143]
    s_waitcnt lgkmcnt(8)
    ds_read2_b32 v[28:29], v5 offset0:0 offset1:1
    ds_read2_b32 v[30:31], v5 offset0:2 offset1:3
    ds_read_b128 v[32:35], v9 offset:5120
    ds_read_b128 v[36:39], v9 offset:2560
    ds_read2_b32 v[40:41], v5 offset0:8 offset1:9
    ds_read2_b32 v[42:43], v5 offset0:10 offset1:11
    ds_read_b128 v[44:47], v9 offset:5152
    ds_read_b128 v[48:51], v9 offset:2592
    v_subrev_u32 v5, 256, v5
    v_subrev_u32 v9, 320, v9
    v_mfma_f32_32x32x16_bf16 v[112:127], v[52:55], v[56:59], v[112:127]
    v_mfma_f32_32x32x16_bf16 v[128:143], v[52:55], v[60:63], v[128:143]
    v_mfma_f32_32x32x16_bf16 v[112:127], v[64:67], v[68:71], v[112:127]
    v_mfma_f32_32x32x16_bf16 v[128:143], v[64:67], v[72:75], v[128:143]
    s_waitcnt lgkmcnt(8)
    ds_read2_b32 v[52:53], v5 offset0:0 offset1:1
    ds_read2_b32 v[54:55], v5 offset0:2 offset1:3
    ds_read_b128 v[56:59], v9 offset:5120
    ds_read_b128 v[60:63], v9 offset:2560
    ds_read2_b32 v[64:65], v5 offset0:8 offset1:9
    ds_read2_b32 v[66:67], v5 offset0:10 offset1:11
    ds_read_b128 v[68:71], v9 offset:5152
    ds_read_b128 v[72:75], v9 offset:2592
    v_subrev_u32 v5, 256, v5
    v_subrev_u32 v9, 320, v9
    v_mfma_f32_32x32x16_bf16 v[112:127], v[76:79], v[80:83], v[112:127]
    v_mfma_f32_32x32x16_bf16 v[128:143], v[76:79], v[84:87], v[128:143]
    v_mfma_f32_32x32x16_bf16 v[112:127], v[88:91], v[92:95], v[112:127]
    v_mfma_f32_32x32x16_bf16 v[128:143], v[88:91], v[96:99], v[128:143]
    s_waitcnt lgkmcnt(8)
    ds_read2_b32 v[76:77], v5 offset0:0 offset1:1
    ds_read2_b32 v[78:79], v5 offset0:2 offset1:3
    ds_read_b128 v[80:83], v9 offset:5120
    ds_read2_b32 v[88:89], v5 offset0:8 offset1:9
    ds_read2_b32 v[90:91], v5 offset0:10 offset1:11
    ds_read_b128 v[92:95], v9 offset:5152
    v_subrev_u32 v5, 256, v5
    v_subrev_u32 v9, 320, v9
    v_mfma_f32_32x32x16_bf16 v[112:127], v[28:31], v[32:35], v[112:127]
    v_mfma_f32_32x32x16_bf16 v[128:143], v[28:31], v[36:39], v[128:143]
    v_mfma_f32_32x32x16_bf16 v[112:127], v[40:43], v[44:47], v[112:127]
    v_mfma_f32_32x32x16_bf16 v[128:143], v[40:43], v[48:51], v[128:143]
    s_waitcnt lgkmcnt(6)
    ds_read2_b32 v[28:29], v5 offset0:0 offset1:1
    ds_read2_b32 v[30:31], v5 offset0:2 offset1:3
    ds_read_b128 v[32:35], v9 offset:5120
    ds_read2_b32 v[40:41], v5 offset0:8 offset1:9
    ds_read2_b32 v[42:43], v5 offset0:10 offset1:11
    ds_read_b128 v[44:47], v9 offset:5152
    v_subrev_u32 v5, 256, v5
    v_subrev_u32 v9, 320, v9
    v_mfma_f32_32x32x16_bf16 v[112:127], v[52:55], v[56:59], v[112:127]
    v_mfma_f32_32x32x16_bf16 v[128:143], v[52:55], v[60:63], v[128:143]
    v_mfma_f32_32x32x16_bf16 v[112:127], v[64:67], v[68:71], v[112:127]
    v_mfma_f32_32x32x16_bf16 v[128:143], v[64:67], v[72:75], v[128:143]
    s_waitcnt lgkmcnt(6)
    ds_read2_b32 v[52:53], v5 offset0:0 offset1:1
    ds_read2_b32 v[54:55], v5 offset0:2 offset1:3
    ds_read_b128 v[56:59], v9 offset:5120
    ds_read2_b32 v[64:65], v5 offset0:8 offset1:9
    ds_read2_b32 v[66:67], v5 offset0:10 offset1:11
    ds_read_b128 v[68:71], v9 offset:5152
    v_subrev_u32 v5, 256, v5
    v_subrev_u32 v9, 320, v9
    v_mfma_f32_32x32x16_bf16 v[112:127], v[76:79], v[80:83], v[112:127]
    v_mfma_f32_32x32x16_bf16 v[112:127], v[88:91], v[92:95], v[112:127]
    s_waitcnt lgkmcnt(6)
    ds_read2_b32 v[76:77], v5 offset0:0 offset1:1
    ds_read2_b32 v[78:79], v5 offset0:2 offset1:3
    ds_read_b128 v[80:83], v9 offset:5120
    ds_read2_b32 v[88:89], v5 offset0:8 offset1:9
    ds_read2_b32 v[90:91], v5 offset0:10 offset1:11
    ds_read_b128 v[92:95], v9 offset:5152
    v_subrev_u32 v5, 256, v5
    v_subrev_u32 v9, 320, v9
    v_mfma_f32_32x32x16_bf16 v[112:127], v[28:31], v[32:35], v[112:127]
    v_mfma_f32_32x32x16_bf16 v[112:127], v[40:43], v[44:47], v[112:127]
    s_waitcnt lgkmcnt(6)
    ds_read2_b32 v[28:29], v5 offset0:0 offset1:1
    ds_read2_b32 v[30:31], v5 offset0:2 offset1:3
    ds_read_b128 v[32:35], v9 offset:5120
    ds_read2_b32 v[40:41], v5 offset0:8 offset1:9
    ds_read2_b32 v[42:43], v5 offset0:10 offset1:11
    ds_read_b128 v[44:47], v9 offset:5152
    v_subrev_u32 v5, 256, v5
    v_subrev_u32 v9, 320, v9
    v_mfma_f32_32x32x16_bf16 v[112:127], v[52:55], v[56:59], v[112:127]
    v_mfma_f32_32x32x16_bf16 v[112:127], v[64:67], v[68:71], v[112:127]
    s_waitcnt lgkmcnt(6)
    ds_read2_b32 v[52:53], v5 offset0:0 offset1:1
    ds_read2_b32 v[54:55], v5 offset0:2 offset1:3
    ds_read_b128 v[56:59], v9 offset:5120
    ds_read2_b32 v[64:65], v5 offset0:8 offset1:9
    ds_read2_b32 v[66:67], v5 offset0:10 offset1:11
    ds_read_b128 v[68:71], v9 offset:5152
    v_subrev_u32 v5, 256, v5
    v_subrev_u32 v9, 320, v9
    v_mfma_f32_32x32x16_bf16 v[112:127], v[76:79], v[80:83], v[112:127]
    v_mfma_f32_32x32x16_bf16 v[112:127], v[88:91], v[92:95], v[112:127]
    s_waitcnt lgkmcnt(6)
    ds_read2_b32 v[76:77], v5 offset0:0 offset1:1
    ds_read2_b32 v[78:79], v5 offset0:2 offset1:3
    ds_read_b128 v[80:83], v9 offset:5120
    ds_read2_b32 v[88:89], v5 offset0:8 offset1:9
    ds_read2_b32 v[90:91], v5 offset0:10 offset1:11
    ds_read_b128 v[92:95], v9 offset:5152
    v_subrev_u32 v5, 256, v5
    v_subrev_u32 v9, 320, v9
    v_mfma_f32_32x32x16_bf16 v[112:127], v[28:31], v[32:35], v[112:127]
    v_mfma_f32_32x32x16_bf16 v[112:127], v[40:43], v[44:47], v[112:127]
    s_waitcnt lgkmcnt(6)
    ds_read2_b32 v[28:29], v5 offset0:0 offset1:1
    ds_read2_b32 v[30:31], v5 offset0:2 offset1:3
    ds_read_b128 v[32:35], v9 offset:5120
    ds_read2_b32 v[40:41], v5 offset0:8 offset1:9
    ds_read2_b32 v[42:43], v5 offset0:10 offset1:11
    ds_read_b128 v[44:47], v9 offset:5152
    v_subrev_u32 v5, 256, v5
    v_subrev_u32 v9, 320, v9
    v_mfma_f32_32x32x16_bf16 v[112:127], v[52:55], v[56:59], v[112:127]
    v_mfma_f32_32x32x16_bf16 v[112:127], v[64:67], v[68:71], v[112:127]
    s_waitcnt lgkmcnt(6)
    v_mfma_f32_32x32x16_bf16 v[112:127], v[76:79], v[80:83], v[112:127]
    v_mfma_f32_32x32x16_bf16 v[112:127], v[88:91], v[92:95], v[112:127]
    s_waitcnt lgkmcnt(0)
    v_mfma_f32_32x32x16_bf16 v[112:127], v[28:31], v[32:35], v[112:127]
    v_mfma_f32_32x32x16_bf16 v[112:127], v[40:43], v[44:47], v[112:127]
    s_nop 15
    s_nop 15
    s_barrier
    v_lshrrev_b32 v1, 6, v0
    v_lshlrev_b32 v9, 7, v2
    v_lshl_add_u32 v9, v3, 4, v9
    v_lshl_add_u32 v9, v1, 13, v9
    ds_write_b128 v9, v[128:131] offset:0
    ds_write_b128 v9, v[132:135] offset:32
    ds_write_b128 v9, v[136:139] offset:64
    ds_write_b128 v9, v[140:143] offset:96
    ds_write_b128 v9, v[112:115] offset:4096
    ds_write_b128 v9, v[116:119] offset:4128
    ds_write_b128 v9, v[120:123] offset:4160
    ds_write_b128 v9, v[124:127] offset:4192
    s_waitcnt lgkmcnt(0)
    s_barrier
    v_lshlrev_b32 v8, 5, v0
    ds_read_b128 v[64:67], v8 offset:0
    ds_read_b128 v[68:71], v8 offset:16
    ds_read_b128 v[72:75], v8 offset:8192
    ds_read_b128 v[76:79], v8 offset:8208
    ds_read_b128 v[80:83], v8 offset:16384
    ds_read_b128 v[84:87], v8 offset:16400
    ds_read_b128 v[88:91], v8 offset:24576
    ds_read_b128 v[92:95], v8 offset:24592
    s_waitcnt vmcnt(0)
    v_cmp_gt_u32 vcc, 160, v0
    s_and_saveexec_b64 s[48:49], vcc
    ds_write_b128 v105, v[108:111] offset:32768
    s_or_b64 exec, exec, s[48:49]
    ds_write_b128 v106, v[100:103] offset:35328
    s_waitcnt lgkmcnt(0)
    v_add_f32 v40, v64, v72
    v_add_f32 v64, v80, v88
    v_add_f32 v40, v40, v64
    v_add_f32 v41, v65, v73
    v_add_f32 v65, v81, v89
    v_add_f32 v41, v41, v65
    v_add_f32 v42, v66, v74
    v_add_f32 v66, v82, v90
    v_add_f32 v42, v42, v66
    v_add_f32 v43, v67, v75
    v_add_f32 v67, v83, v91
    v_add_f32 v43, v43, v67
    v_add_f32 v44, v68, v76
    v_add_f32 v68, v84, v92
    v_add_f32 v44, v44, v68
    v_add_f32 v45, v69, v77
    v_add_f32 v69, v85, v93
    v_add_f32 v45, v45, v69
    v_add_f32 v46, v70, v78
    v_add_f32 v70, v86, v94
    v_add_f32 v46, v46, v70
    v_add_f32 v47, v71, v79
    v_add_f32 v71, v87, v95
    v_add_f32 v47, v47, v71
    v_cvt_pk_bf16_f32 v48, v40, v41
    v_cvt_pk_bf16_f32 v49, v42, v43
    v_cvt_pk_bf16_f32 v50, v44, v45
    v_cvt_pk_bf16_f32 v51, v46, v47
    buffer_store_dwordx4 v[48:51], v105, s[12:15], s64 offen sc0 sc1
    s_mov_b32 s2, s22
    s_lshl_b32 s64, s2, 12
    v_and_b32 v2, 31, v0
    v_bfe_u32 v3, v0, 5, 1
    v_and_b32 v4, 1, v2
    v_mul_u32_u24 v5, 4224, v4
    v_sub_u32 v6, 2048, v2
    v_sub_u32 v6, v6, v4
    v_lshl_add_u32 v6, v3, 3, v6
    v_lshl_add_u32 v5, v6, 1, v5
    s_lshl_b32 s21, s20, 6
    s_sub_u32 s21, 40448, s21
    v_add_u32 v5, s21, v5
    v_mul_u32_u24 v9, 80, v2
    v_lshl_add_u32 v9, v3, 4, v9
    s_mul_i32 s21, s20, 80
    v_subrev_u32 v9, s21, v9
    s_lshr_b32 s22, s79, 2
    s_add_u32 s22, s22, 512
    s_waitcnt lgkmcnt(0)
    s_barrier
    ds_read2_b32 v[28:29], v5 offset0:0 offset1:1
    ds_read2_b32 v[30:31], v5 offset0:2 offset1:3
    ds_read_b128 v[32:35], v9 offset:37888
    ds_read_b128 v[36:39], v9 offset:35328
    ds_read2_b32 v[40:41], v5 offset0:8 offset1:9
    ds_read2_b32 v[42:43], v5 offset0:10 offset1:11
    ds_read_b128 v[44:47], v9 offset:37920
    ds_read_b128 v[48:51], v9 offset:35360
    v_subrev_u32 v5, 256, v5
    v_subrev_u32 v9, 320, v9
    ds_read2_b32 v[52:53], v5 offset0:0 offset1:1
    ds_read2_b32 v[54:55], v5 offset0:2 offset1:3
    ds_read_b128 v[56:59], v9 offset:37888
    ds_read_b128 v[60:63], v9 offset:35328
    ds_read2_b32 v[64:65], v5 offset0:8 offset1:9
    ds_read2_b32 v[66:67], v5 offset0:10 offset1:11
    ds_read_b128 v[68:71], v9 offset:37920
    ds_read_b128 v[72:75], v9 offset:35360
    v_subrev_u32 v5, 256, v5
    v_subrev_u32 v9, 320, v9
    s_lshl_b32 s65, s22, 12
    buffer_load_dwordx4 v[100:103], v105, s[8:11], s65 offen
    s_mul_i32 s3, s22, 8448
    s_add_u32 s17, s20, 0
    s_lshl_b32 s17, s17, 10
    s_min_u32 s17, s17, 7424
    s_add_u32 s19, s3, s17
    s_add_u32 m0, s17, 7680
    s_nop 0
    buffer_load_dwordx4 v104, s[4:7], s19 offen lds
    s_add_u32 s17, s20, 4
    s_lshl_b32 s17, s17, 10
    s_min_u32 s17, s17, 7424
    s_add_u32 s19, s3, s17
    s_add_u32 m0, s17, 7680
    s_nop 0
    buffer_load_dwordx4 v104, s[4:7], s19 offen lds
    s_add_u32 s17, s20, 8
    s_lshl_b32 s17, s17, 10
    s_min_u32 s17, s17, 7424
    s_add_u32 s19, s3, s17
    s_add_u32 m0, s17, 7680
    s_nop 0
    buffer_load_dwordx4 v104, s[4:7], s19 offen lds
    s_waitcnt lgkmcnt(8)
    ds_read2_b32 v[76:77], v5 offset0:0 offset1:1
    ds_read2_b32 v[78:79], v5 offset0:2 offset1:3
    ds_read_b128 v[80:83], v9 offset:37888
    ds_read_b128 v[84:87], v9 offset:35328
    ds_read2_b32 v[88:89], v5 offset0:8 offset1:9
    ds_read2_b32 v[90:91], v5 offset0:10 offset1:11
    ds_read_b128 v[92:95], v9 offset:37920
    ds_read_b128 v[96:99], v9 offset:35360
    v_subrev_u32 v5, 256, v5
    v_subrev_u32 v9, 320, v9
    v_mfma_f32_32x32x16_bf16 v[112:127], v[28:31], v[32:35], 0
    v_mfma_f32_32x32x16_bf16 v[128:143], v[28:31], v[36:39], 0
    v_mfma_f32_32x32x16_bf16 v[112:127], v[40:43], v[44:47], v[112:127]
    v_mfma_f32_32x32x16_bf16 v[128:143], v[40:43], v[48:51], v[128:143]
    s_waitcnt lgkmcnt(8)
    ds_read2_b32 v[28:29], v5 offset0:0 offset1:1
    ds_read2_b32 v[30:31], v5 offset0:2 offset1:3
    ds_read_b128 v[32:35], v9 offset:37888
    ds_read_b128 v[36:39], v9 offset:35328
    ds_read2_b32 v[40:41], v5 offset0:8 offset1:9
    ds_read2_b32 v[42:43], v5 offset0:10 offset1:11
    ds_read_b128 v[44:47], v9 offset:37920
    ds_read_b128 v[48:51], v9 offset:35360
    v_subrev_u32 v5, 256, v5
    v_subrev_u32 v9, 320, v9
    v_mfma_f32_32x32x16_bf16 v[112:127], v[52:55], v[56:59], v[112:127]
    v_mfma_f32_32x32x16_bf16 v[128:143], v[52:55], v[60:63], v[128:143]
    v_mfma_f32_32x32x16_bf16 v[112:127], v[64:67], v[68:71], v[112:127]
    v_mfma_f32_32x32x16_bf16 v[128:143], v[64:67], v[72:75], v[128:143]
    s_waitcnt lgkmcnt(8)
    ds_read2_b32 v[52:53], v5 offset0:0 offset1:1
    ds_read2_b32 v[54:55], v5 offset0:2 offset1:3
    ds_read_b128 v[56:59], v9 offset:37888
    ds_read_b128 v[60:63], v9 offset:35328
    ds_read2_b32 v[64:65], v5 offset0:8 offset1:9
    ds_read2_b32 v[66:67], v5 offset0:10 offset1:11
    ds_read_b128 v[68:71], v9 offset:37920
    ds_read_b128 v[72:75], v9 offset:35360
    v_subrev_u32 v5, 256, v5
    v_subrev_u32 v9, 320, v9
    v_mfma_f32_32x32x16_bf16 v[112:127], v[76:79], v[80:83], v[112:127]
    v_mfma_f32_32x32x16_bf16 v[128:143], v[76:79], v[84:87], v[128:143]
    v_mfma_f32_32x32x16_bf16 v[112:127], v[88:91], v[92:95], v[112:127]
    v_mfma_f32_32x32x16_bf16 v[128:143], v[88:91], v[96:99], v[128:143]
    s_waitcnt lgkmcnt(8)
    ds_read2_b32 v[76:77], v5 offset0:0 offset1:1
    ds_read2_b32 v[78:79], v5 offset0:2 offset1:3
    ds_read_b128 v[80:83], v9 offset:37888
    ds_read_b128 v[84:87], v9 offset:35328
    ds_read2_b32 v[88:89], v5 offset0:8 offset1:9
    ds_read2_b32 v[90:91], v5 offset0:10 offset1:11
    ds_read_b128 v[92:95], v9 offset:37920
    ds_read_b128 v[96:99], v9 offset:35360
    v_subrev_u32 v5, 256, v5
    v_subrev_u32 v9, 320, v9
    v_mfma_f32_32x32x16_bf16 v[112:127], v[28:31], v[32:35], v[112:127]
    v_mfma_f32_32x32x16_bf16 v[128:143], v[28:31], v[36:39], v[128:143]
    v_mfma_f32_32x32x16_bf16 v[112:127], v[40:43], v[44:47], v[112:127]
    v_mfma_f32_32x32x16_bf16 v[128:143], v[40:43], v[48:51], v[128:143]
    s_waitcnt lgkmcnt(8)
    ds_read2_b32 v[28:29], v5 offset0:0 offset1:1
    ds_read2_b32 v[30:31], v5 offset0:2 offset1:3
    ds_read_b128 v[32:35], v9 offset:37888
    ds_read_b128 v[36:39], v9 offset:35328
    ds_read2_b32 v[40:41], v5 offset0:8 offset1:9
    ds_read2_b32 v[42:43], v5 offset0:10 offset1:11
    ds_read_b128 v[44:47], v9 offset:37920
    ds_read_b128 v[48:51], v9 offset:35360
    v_subrev_u32 v5, 256, v5
    v_subrev_u32 v9, 320, v9
    v_mfma_f32_32x32x16_bf16 v[112:127], v[52:55], v[56:59], v[112:127]
    v_mfma_f32_32x32x16_bf16 v[128:143], v[52:55], v[60:63], v[128:143]
    v_mfma_f32_32x32x16_bf16 v[112:127], v[64:67], v[68:71], v[112:127]
    v_mfma_f32_32x32x16_bf16 v[128:143], v[64:67], v[72:75], v[128:143]
    s_waitcnt lgkmcnt(8)
    ds_read2_b32 v[52:53], v5 offset0:0 offset1:1
    ds_read2_b32 v[54:55], v5 offset0:2 offset1:3
    ds_read_b128 v[56:59], v9 offset:37888
    ds_read_b128 v[60:63], v9 offset:35328
    ds_read2_b32 v[64:65], v5 offset0:8 offset1:9
    ds_read2_b32 v[66:67], v5 offset0:10 offset1:11
    ds_read_b128 v[68:71], v9 offset:37920
    ds_read_b128 v[72:75], v9 offset:35360
    v_subrev_u32 v5, 256, v5
    v_subrev_u32 v9, 320, v9
    v_mfma_f32_32x32x16_bf16 v[112:127], v[76:79], v[80:83], v[112:127]
    v_mfma_f32_32x32x16_bf16 v[128:143], v[76:79], v[84:87], v[128:143]
    v_mfma_f32_32x32x16_bf16 v[112:127], v[88:91], v[92:95], v[112:127]
    v_mfma_f32_32x32x16_bf16 v[128:143], v[88:91], v[96:99], v[128:143]
    s_waitcnt lgkmcnt(8)
    ds_read2_b32 v[76:77], v5 offset0:0 offset1:1
    ds_read2_b32 v[78:79], v5 offset0:2 offset1:3
    ds_read_b128 v[80:83], v9 offset:37888
    ds_read2_b32 v[88:89], v5 offset0:8 offset1:9
    ds_read2_b32 v[90:91], v5 offset0:10 offset1:11
    ds_read_b128 v[92:95], v9 offset:37920
    v_subrev_u32 v5, 256, v5
    v_subrev_u32 v9, 320, v9
    v_mfma_f32_32x32x16_bf16 v[112:127], v[28:31], v[32:35], v[112:127]
    v_mfma_f32_32x32x16_bf16 v[128:143], v[28:31], v[36:39], v[128:143]
    v_mfma_f32_32x32x16_bf16 v[112:127], v[40:43], v[44:47], v[112:127]
    v_mfma_f32_32x32x16_bf16 v[128:143], v[40:43], v[48:51], v[128:143]
    s_waitcnt lgkmcnt(6)
    ds_read2_b32 v[28:29], v5 offset0:0 offset1:1
    ds_read2_b32 v[30:31], v5 offset0:2 offset1:3
    ds_read_b128 v[32:35], v9 offset:37888
    ds_read2_b32 v[40:41], v5 offset0:8 offset1:9
    ds_read2_b32 v[42:43], v5 offset0:10 offset1:11
    ds_read_b128 v[44:47], v9 offset:37920
    v_subrev_u32 v5, 256, v5
    v_subrev_u32 v9, 320, v9
    v_mfma_f32_32x32x16_bf16 v[112:127], v[52:55], v[56:59], v[112:127]
    v_mfma_f32_32x32x16_bf16 v[128:143], v[52:55], v[60:63], v[128:143]
    v_mfma_f32_32x32x16_bf16 v[112:127], v[64:67], v[68:71], v[112:127]
    v_mfma_f32_32x32x16_bf16 v[128:143], v[64:67], v[72:75], v[128:143]
    s_waitcnt lgkmcnt(6)
    ds_read2_b32 v[52:53], v5 offset0:0 offset1:1
    ds_read2_b32 v[54:55], v5 offset0:2 offset1:3
    ds_read_b128 v[56:59], v9 offset:37888
    ds_read2_b32 v[64:65], v5 offset0:8 offset1:9
    ds_read2_b32 v[66:67], v5 offset0:10 offset1:11
    ds_read_b128 v[68:71], v9 offset:37920
    v_subrev_u32 v5, 256, v5
    v_subrev_u32 v9, 320, v9
    v_mfma_f32_32x32x16_bf16 v[112:127], v[76:79], v[80:83], v[112:127]
    v_mfma_f32_32x32x16_bf16 v[112:127], v[88:91], v[92:95], v[112:127]
    s_waitcnt lgkmcnt(6)
    ds_read2_b32 v[76:77], v5 offset0:0 offset1:1
    ds_read2_b32 v[78:79], v5 offset0:2 offset1:3
    ds_read_b128 v[80:83], v9 offset:37888
    ds_read2_b32 v[88:89], v5 offset0:8 offset1:9
    ds_read2_b32 v[90:91], v5 offset0:10 offset1:11
    ds_read_b128 v[92:95], v9 offset:37920
    v_subrev_u32 v5, 256, v5
    v_subrev_u32 v9, 320, v9
    v_mfma_f32_32x32x16_bf16 v[112:127], v[28:31], v[32:35], v[112:127]
    v_mfma_f32_32x32x16_bf16 v[112:127], v[40:43], v[44:47], v[112:127]
    s_waitcnt lgkmcnt(6)
    ds_read2_b32 v[28:29], v5 offset0:0 offset1:1
    ds_read2_b32 v[30:31], v5 offset0:2 offset1:3
    ds_read_b128 v[32:35], v9 offset:37888
    ds_read2_b32 v[40:41], v5 offset0:8 offset1:9
    ds_read2_b32 v[42:43], v5 offset0:10 offset1:11
    ds_read_b128 v[44:47], v9 offset:37920
    v_subrev_u32 v5, 256, v5
    v_subrev_u32 v9, 320, v9
    v_mfma_f32_32x32x16_bf16 v[112:127], v[52:55], v[56:59], v[112:127]
    v_mfma_f32_32x32x16_bf16 v[112:127], v[64:67], v[68:71], v[112:127]
    s_waitcnt lgkmcnt(6)
    ds_read2_b32 v[52:53], v5 offset0:0 offset1:1
    ds_read2_b32 v[54:55], v5 offset0:2 offset1:3
    ds_read_b128 v[56:59], v9 offset:37888
    ds_read2_b32 v[64:65], v5 offset0:8 offset1:9
    ds_read2_b32 v[66:67], v5 offset0:10 offset1:11
    ds_read_b128 v[68:71], v9 offset:37920
    v_subrev_u32 v5, 256, v5
    v_subrev_u32 v9, 320, v9
    v_mfma_f32_32x32x16_bf16 v[112:127], v[76:79], v[80:83], v[112:127]
    v_mfma_f32_32x32x16_bf16 v[112:127], v[88:91], v[92:95], v[112:127]
    s_waitcnt lgkmcnt(6)
    ds_read2_b32 v[76:77], v5 offset0:0 offset1:1
    ds_read2_b32 v[78:79], v5 offset0:2 offset1:3
    ds_read_b128 v[80:83], v9 offset:37888
    ds_read2_b32 v[88:89], v5 offset0:8 offset1:9
    ds_read2_b32 v[90:91], v5 offset0:10 offset1:11
    ds_read_b128 v[92:95], v9 offset:37920
    v_subrev_u32 v5, 256, v5
    v_subrev_u32 v9, 320, v9
    v_mfma_f32_32x32x16_bf16 v[112:127], v[28:31], v[32:35], v[112:127]
    v_mfma_f32_32x32x16_bf16 v[112:127], v[40:43], v[44:47], v[112:127]
    s_waitcnt lgkmcnt(6)
    ds_read2_b32 v[28:29], v5 offset0:0 offset1:1
    ds_read2_b32 v[30:31], v5 offset0:2 offset1:3
    ds_read_b128 v[32:35], v9 offset:37888
    ds_read2_b32 v[40:41], v5 offset0:8 offset1:9
    ds_read2_b32 v[42:43], v5 offset0:10 offset1:11
    ds_read_b128 v[44:47], v9 offset:37920
    v_subrev_u32 v5, 256, v5
    v_subrev_u32 v9, 320, v9
    v_mfma_f32_32x32x16_bf16 v[112:127], v[52:55], v[56:59], v[112:127]
    v_mfma_f32_32x32x16_bf16 v[112:127], v[64:67], v[68:71], v[112:127]
    s_waitcnt lgkmcnt(6)
    v_mfma_f32_32x32x16_bf16 v[112:127], v[76:79], v[80:83], v[112:127]
    v_mfma_f32_32x32x16_bf16 v[112:127], v[88:91], v[92:95], v[112:127]
    s_waitcnt lgkmcnt(0)
    v_mfma_f32_32x32x16_bf16 v[112:127], v[28:31], v[32:35], v[112:127]
    v_mfma_f32_32x32x16_bf16 v[112:127], v[40:43], v[44:47], v[112:127]
    s_nop 15
    s_nop 15
    s_barrier
    v_lshrrev_b32 v1, 6, v0
    v_lshlrev_b32 v9, 7, v2
    v_lshl_add_u32 v9, v3, 4, v9
    v_lshl_add_u32 v9, v1, 13, v9
    ds_write_b128 v9, v[128:131] offset:24576
    ds_write_b128 v9, v[132:135] offset:24608
    ds_write_b128 v9, v[136:139] offset:24640
    ds_write_b128 v9, v[140:143] offset:24672
    ds_write_b128 v9, v[112:115] offset:28672
    ds_write_b128 v9, v[116:119] offset:28704
    ds_write_b128 v9, v[120:123] offset:28736
    ds_write_b128 v9, v[124:127] offset:28768
    s_waitcnt lgkmcnt(0)
    s_barrier
    v_lshlrev_b32 v8, 5, v0
    ds_read_b128 v[64:67], v8 offset:24576
    ds_read_b128 v[68:71], v8 offset:24592
    ds_read_b128 v[72:75], v8 offset:32768
    ds_read_b128 v[76:79], v8 offset:32784
    ds_read_b128 v[80:83], v8 offset:40960
    ds_read_b128 v[84:87], v8 offset:40976
    ds_read_b128 v[88:91], v8 offset:49152
    ds_read_b128 v[92:95], v8 offset:49168
    s_waitcnt vmcnt(0)
    v_cmp_gt_u32 vcc, 160, v0
    s_and_saveexec_b64 s[48:49], vcc
    ds_write_b128 v105, v[108:111] offset:0
    s_or_b64 exec, exec, s[48:49]
    ds_write_b128 v106, v[100:103] offset:2560
    s_waitcnt lgkmcnt(0)
    v_add_f32 v40, v64, v72
    v_add_f32 v64, v80, v88
    v_add_f32 v40, v40, v64
    v_add_f32 v41, v65, v73
    v_add_f32 v65, v81, v89
    v_add_f32 v41, v41, v65
    v_add_f32 v42, v66, v74
    v_add_f32 v66, v82, v90
    v_add_f32 v42, v42, v66
    v_add_f32 v43, v67, v75
    v_add_f32 v67, v83, v91
    v_add_f32 v43, v43, v67
    v_add_f32 v44, v68, v76
    v_add_f32 v68, v84, v92
    v_add_f32 v44, v44, v68
    v_add_f32 v45, v69, v77
    v_add_f32 v69, v85, v93
    v_add_f32 v45, v45, v69
    v_add_f32 v46, v70, v78
    v_add_f32 v70, v86, v94
    v_add_f32 v46, v46, v70
    v_add_f32 v47, v71, v79
    v_add_f32 v71, v87, v95
    v_add_f32 v47, v47, v71
    v_cvt_pk_bf16_f32 v48, v40, v41
    v_cvt_pk_bf16_f32 v49, v42, v43
    v_cvt_pk_bf16_f32 v50, v44, v45
    v_cvt_pk_bf16_f32 v51, v46, v47
    buffer_store_dwordx4 v[48:51], v105, s[12:15], s64 offen sc0 sc1
    s_mov_b32 s2, s22
    s_lshl_b32 s64, s2, 12
    s_and_b32 s23, s79, 3
    s_lshl_b32 s21, s23, 18
    s_add_u32 s21, s21, 47480832
    s_cmp_eq_u32 s23, 0
    s_cselect_b32 s21, 0, s21
    s_add_u32 s64, s64, s21
    v_and_b32 v2, 31, v0
    v_bfe_u32 v3, v0, 5, 1
    v_and_b32 v4, 1, v2
    v_mul_u32_u24 v5, 4224, v4
    v_sub_u32 v6, 2048, v2
    v_sub_u32 v6, v6, v4
    v_lshl_add_u32 v6, v3, 3, v6
    v_lshl_add_u32 v5, v6, 1, v5
    s_lshl_b32 s21, s20, 6
    s_sub_u32 s21, 7680, s21
    v_add_u32 v5, s21, v5
    v_mul_u32_u24 v9, 80, v2
    v_lshl_add_u32 v9, v3, 4, v9
    s_mul_i32 s21, s20, 80
    v_subrev_u32 v9, s21, v9
    s_lshl_b32 s21, s23, 9
    v_subrev_u32 v5, s21, v5
    s_mul_i32 s21, s23, 640
    v_subrev_u32 v9, s21, v9
    s_waitcnt lgkmcnt(0)
    s_barrier
    ds_read2_b32 v[28:29], v5 offset0:0 offset1:1
    ds_read2_b32 v[30:31], v5 offset0:2 offset1:3
    ds_read_b128 v[32:35], v9 offset:5120
    ds_read_b128 v[36:39], v9 offset:2560
    ds_read2_b32 v[40:41], v5 offset0:8 offset1:9
    ds_read2_b32 v[42:43], v5 offset0:10 offset1:11
    ds_read_b128 v[44:47], v9 offset:5152
    ds_read_b128 v[48:51], v9 offset:2592
    v_subrev_u32 v5, 256, v5
    v_subrev_u32 v9, 320, v9
    ds_read2_b32 v[52:53], v5 offset0:0 offset1:1
    ds_read2_b32 v[54:55], v5 offset0:2 offset1:3
    ds_read_b128 v[56:59], v9 offset:5120
    ds_read_b128 v[60:63], v9 offset:2560
    ds_read2_b32 v[64:65], v5 offset0:8 offset1:9
    ds_read2_b32 v[66:67], v5 offset0:10 offset1:11
    ds_read_b128 v[68:71], v9 offset:5152
    ds_read_b128 v[72:75], v9 offset:2592
    v_subrev_u32 v5, 1792, v5
    v_subrev_u32 v9, 2240, v9
    s_waitcnt lgkmcnt(8)
    ds_read2_b32 v[76:77], v5 offset0:0 offset1:1
    ds_read2_b32 v[78:79], v5 offset0:2 offset1:3
    ds_read_b128 v[80:83], v9 offset:5120
    ds_read2_b32 v[88:89], v5 offset0:8 offset1:9
    ds_read2_b32 v[90:91], v5 offset0:10 offset1:11
    ds_read_b128 v[92:95], v9 offset:5152
    v_subrev_u32 v5, 256, v5
    v_subrev_u32 v9, 320, v9
    v_mfma_f32_32x32x16_bf16 v[112:127], v[28:31], v[32:35], 0
    v_mfma_f32_32x32x16_bf16 v[128:143], v[28:31], v[36:39], 0
    v_mfma_f32_32x32x16_bf16 v[112:127], v[40:43], v[44:47], v[112:127]
    v_mfma_f32_32x32x16_bf16 v[128:143], v[40:43], v[48:51], v[128:143]
    s_waitcnt lgkmcnt(6)
    ds_read2_b32 v[28:29], v5 offset0:0 offset1:1
    ds_read2_b32 v[30:31], v5 offset0:2 offset1:3
    ds_read_b128 v[32:35], v9 offset:5120
    ds_read2_b32 v[40:41], v5 offset0:8 offset1:9
    ds_read2_b32 v[42:43], v5 offset0:10 offset1:11
    ds_read_b128 v[44:47], v9 offset:5152
    v_subrev_u32 v5, 256, v5
    v_subrev_u32 v9, 320, v9
    v_mfma_f32_32x32x16_bf16 v[112:127], v[52:55], v[56:59], v[112:127]
    v_mfma_f32_32x32x16_bf16 v[128:143], v[52:55], v[60:63], v[128:143]
    v_mfma_f32_32x32x16_bf16 v[112:127], v[64:67], v[68:71], v[112:127]
    v_mfma_f32_32x32x16_bf16 v[128:143], v[64:67], v[72:75], v[128:143]
    s_waitcnt lgkmcnt(6)
    v_mfma_f32_32x32x16_bf16 v[112:127], v[76:79], v[80:83], v[112:127]
    v_mfma_f32_32x32x16_bf16 v[112:127], v[88:91], v[92:95], v[112:127]
    s_waitcnt lgkmcnt(0)
    v_mfma_f32_32x32x16_bf16 v[112:127], v[28:31], v[32:35], v[112:127]
    v_mfma_f32_32x32x16_bf16 v[112:127], v[40:43], v[44:47], v[112:127]
    s_nop 15
    s_nop 15
    s_barrier
    v_lshrrev_b32 v1, 6, v0
    v_lshlrev_b32 v9, 7, v2
    v_lshl_add_u32 v9, v3, 4, v9
    v_lshl_add_u32 v9, v1, 13, v9
    ds_write_b128 v9, v[128:131] offset:0
    ds_write_b128 v9, v[132:135] offset:32
    ds_write_b128 v9, v[136:139] offset:64
    ds_write_b128 v9, v[140:143] offset:96
    ds_write_b128 v9, v[112:115] offset:4096
    ds_write_b128 v9, v[116:119] offset:4128
    ds_write_b128 v9, v[120:123] offset:4160
    ds_write_b128 v9, v[124:127] offset:4192
    s_waitcnt lgkmcnt(0)
    s_barrier
    v_lshlrev_b32 v8, 5, v0
    ds_read_b128 v[64:67], v8 offset:0
    ds_read_b128 v[68:71], v8 offset:16
    ds_read_b128 v[72:75], v8 offset:8192
    ds_read_b128 v[76:79], v8 offset:8208
    ds_read_b128 v[80:83], v8 offset:16384
    ds_read_b128 v[84:87], v8 offset:16400
    ds_read_b128 v[88:91], v8 offset:24576
    ds_read_b128 v[92:95], v8 offset:24592
    s_waitcnt lgkmcnt(0)
    v_add_f32 v40, v64, v72
    v_add_f32 v64, v80, v88
    v_add_f32 v40, v40, v64
    v_add_f32 v41, v65, v73
    v_add_f32 v65, v81, v89
    v_add_f32 v41, v41, v65
    v_add_f32 v42, v66, v74
    v_add_f32 v66, v82, v90
    v_add_f32 v42, v42, v66
    v_add_f32 v43, v67, v75
    v_add_f32 v67, v83, v91
    v_add_f32 v43, v43, v67
    v_add_f32 v44, v68, v76
    v_add_f32 v68, v84, v92
    v_add_f32 v44, v44, v68
    v_add_f32 v45, v69, v77
    v_add_f32 v69, v85, v93
    v_add_f32 v45, v45, v69
    v_add_f32 v46, v70, v78
    v_add_f32 v70, v86, v94
    v_add_f32 v46, v46, v70
    v_add_f32 v47, v71, v79
    v_add_f32 v71, v87, v95
    v_add_f32 v47, v47, v71
    v_cvt_pk_bf16_f32 v48, v40, v41
    v_cvt_pk_bf16_f32 v49, v42, v43
    v_cvt_pk_bf16_f32 v50, v44, v45
    v_cvt_pk_bf16_f32 v51, v46, v47
    buffer_store_dwordx4 v[48:51], v105, s[12:15], s64 offen sc0 sc1
C_FIN:
    s_waitcnt vmcnt(0)
    s_barrier
    s_add_u32 s4, s46, 20054016
    s_addc_u32 s5, s47, 0
    s_and_b32 s5, s5, 0xffff
    s_mov_b32 s6, 61440
    s_mov_b32 s7, 0x00020000
    s_cmp_lg_u32 s20, 0
    s_cbranch_scc1 C_SIGX
    v_mov_b32 v2, 0
    v_mov_b32 v3, 1
    s_lshr_b32 s65, s79, 4
    s_lshl_b32 s65, s65, 7
    s_add_u32 s65, s65, 24576
    s_mov_b64 exec, 1
    buffer_atomic_add v3, v2, s[4:7], s65 offen sc0 sc1
    s_waitcnt vmcnt(0)
    v_readfirstlane_b32 s21, v3
    v_mov_b32 v3, 1
    s_mov_b32 s65, 26624
    s_cmp_lg_u32 s21, 15
    s_cbranch_scc1 C_SIGX
    buffer_atomic_add v3, v2, s[4:7], s65 offen sc0 sc1
    s_waitcnt vmcnt(0)
    v_readfirstlane_b32 s21, v3
    v_mov_b32 v3, 1
    s_mov_b32 s65, 26624
    s_cmp_lg_u32 s21, 15
    s_cbranch_scc1 C_SIGX
    s_mov_b64 exec, -1
    v_lshlrev_b32 v2, 7, v0
    v_mov_b32 v3, 1
    s_mov_b32 s65, 28672
    buffer_store_dword v3, v2, s[4:7], s65 offen sc0 sc1
    s_mov_b32 s65, 36864
    buffer_store_dword v3, v2, s[4:7], s65 offen sc0 sc1
    s_mov_b32 s65, 45056
    buffer_store_dword v3, v2, s[4:7], s65 offen sc0 sc1
    s_mov_b32 s65, 53248
    buffer_store_dword v3, v2, s[4:7], s65 offen sc0 sc1
C_SIGX:
    s_mov_b64 exec, -1
    s_or_b64 exec, exec, s[48:49]
    s_add_u32 s12, s46, 51019776
    s_addc_u32 s13, s47, 0
    s_and_b32 s13, s13, 0xffff
    s_mov_b32 s14, 18874368
    s_mov_b32 s15, 0x00020000
    s_add_u32 s28, s46, 20054016
    s_addc_u32 s29, s47, 0
    s_and_b32 s29, s29, 0xffff
    s_mov_b32 s30, 61440
    s_mov_b32 s31, 0x00020000
    s_mov_b32 s4, s42
    s_and_b32 s5, s43, 0xffff
    s_mov_b32 s6, 2359296
    s_mov_b32 s7, 0x00020000
    s_mov_b32 s8, s80
    s_and_b32 s9, s81, 0xffff
    s_mov_b32 s10, 2359296
    s_mov_b32 s11, 0x00020000
    s_mov_b32 s53, s20
    s_add_u32 s20, s46, 0
    s_addc_u32 s21, s47, 0
    s_and_b32 s21, s21, 0xffff
    s_mov_b32 s22, 2359296
    s_mov_b32 s23, 0x00020000
    s_add_u32 s24, s46, 38928384
    s_addc_u32 s25, s47, 0
    s_and_b32 s25, s25, 0xffff
    s_mov_b32 s26, 2359296
    s_mov_b32 s27, 0x00020000
    s_mov_b32 s48, s32
    s_and_b32 s49, s33, 0xffff
    s_mov_b32 s50, 1152
    s_mov_b32 s51, 0x00020000
    s_lshr_b32 s54, s79, 2
    s_and_b32 s55, s79, 3
    s_lshr_b32 s61, s79, 3
    s_lshl_b32 s61, s61, 2
    s_add_u32 s61, s61, s55
    s_mul_i32 s61, s61, 192
    s_mul_i32 s55, s55, 9
    s_add_u32 s55, s55, s53
    v_and_b32 v1, 63, v0
    v_lshlrev_b32 v2, 4, v1
    v_and_b32 v3, 15, v1
    v_lshrrev_b32 v4, 4, v1
    v_lshrrev_b32 v12, 2, v1
    v_and_b32 v13, 3, v1
    v_lshlrev_b32 v5, 12, v12
    v_lshl_add_u32 v5, v13, 4, v5
    v_mul_u32_u24 v9, 80, v12
    v_lshl_add_u32 v9, v13, 4, v9
    s_lshl_b32 s56, s53, 12
    s_add_u32 s56, s56, 57344
    v_add_u32 v9, s56, v9
    v_mul_u32_u24 v10, 320, v4
    v_lshl_add_u32 v10, v3, 1, v10
    v_add_u32 v10, s56, v10
    v_lshrrev_b32 v6, 1, v4
    v_lshlrev_b32 v6, 8, v6
    v_lshl_add_u32 v6, v3, 4, v6
    v_and_b32 v12, 1, v4
    v_lshl_add_u32 v6, v12, 3, v6
    v_mul_u32_u24 v7, 1152, v3
    v_lshl_add_u32 v7, v4, 3, v7
    v_lshlrev_b32 v8, 3, v4
    v_and_b32 v11, 7, v1
    v_mul_u32_u24 v11, 4, v11
    s_mov_b32 s58, 0xffff0000
    s_mov_b32 s94, 0x00003f80
    s_mov_b32 s95, 0x3f800000
    s_mul_i32 s57, s54, 36864
    s_mul_i32 s59, s54, 36864
    s_mov_b32 s62, 24576
    s_cmp_lg_u32 s53, 3
    s_cbranch_scc1 RT_MAIN
    v_mov_b32 v15, 0
    s_lshl_b32 s62, s79, 7
    s_add_u32 s62, s62, 28672
    s_mov_b32 s60, 0
RT_POLLc:
    buffer_load_dword v12, v15, s[28:31], s62 offen sc0 sc1
    s_waitcnt vmcnt(0)
    v_cmp_ne_u32 vcc, 1, v12
    s_cmp_eq_u64 vcc, 0
    s_cbranch_scc1 RT_GOc
    s_add_u32 s60, s60, 1
    s_sleep 12
    s_cmp_lt_u32 s60, 200000
    s_cbranch_scc1 RT_POLLc
RT_GOc:
    s_barrier
    s_mov_b32 s60, 0
RT_POLL0:
    buffer_load_dword v12, v11, s[28:31], s61 offen offset:0 sc0 sc1
    s_waitcnt vmcnt(0)
    v_cmp_ne_u32 vcc, 1, v12
    s_cmp_eq_u64 vcc, 0
    s_cbranch_scc1 RT_GO0
    s_add_u32 s60, s60, 1
    s_sleep 8
    s_cmp_lt_u32 s60, 200000
    s_cbranch_scc1 RT_POLL0
RT_GO0:
    s_barrier
    s_mov_b32 s60, 0
RT_POLL1:
    buffer_load_dword v12, v11, s[28:31], s61 offen offset:64 sc0 sc1
    s_waitcnt vmcnt(0)
    v_cmp_ne_u32 vcc, 1, v12
    s_cmp_eq_u64 vcc, 0
    s_cbranch_scc1 RT_GO1
    s_add_u32 s60, s60, 1
    s_sleep 8
    s_cmp_lt_u32 s60, 200000
    s_cbranch_scc1 RT_POLL1
RT_GO1:
    s_barrier
    s_mov_b32 s60, 0
RT_POLL2:
    buffer_load_dword v12, v11, s[28:31], s61 offen offset:128 sc0 sc1
    s_waitcnt vmcnt(0)
    v_cmp_ne_u32 vcc, 1, v12
    s_cmp_eq_u64 vcc, 0
    s_cbranch_scc1 RT_GO2
    s_add_u32 s60, s60, 1
    s_sleep 8
    s_cmp_lt_u32 s60, 200000
    s_cbranch_scc1 RT_POLL2
RT_GO2:
    s_barrier
    s_endpgm
RT_MAIN:
    s_add_u32 s60, s55, 0
    s_lshl_b32 s63, s60, 9
    s_add_u32 s63, s63, s57
    buffer_load_dwordx2 v[112:113], v6, s[20:23], s63 offen
    s_add_u32 s63, s63, 18432
    buffer_load_dwordx2 v[114:115], v6, s[20:23], s63 offen
    s_lshl_b32 s63, s60, 5
    buffer_load_dwordx2 v[120:121], v8, s[48:51], s63 offen
    s_add_u32 s64, s63, s59
    s_add_u32 s65, s64, 18432
    buffer_load_dwordx2 v[116:117], v7, s[8:11], s64 offen
    buffer_load_dwordx2 v[118:119], v7, s[8:11], s65 offen
    s_add_u32 s60, s55, 3
    s_lshl_b32 s63, s60, 9
    s_add_u32 s63, s63, s57
    buffer_load_dwordx2 v[122:123], v6, s[20:23], s63 offen
    s_add_u32 s63, s63, 18432
    buffer_load_dwordx2 v[124:125], v6, s[20:23], s63 offen
    s_lshl_b32 s63, s60, 5
    buffer_load_dwordx2 v[130:131], v8, s[48:51], s63 offen
    s_add_u32 s66, s63, s59
    s_add_u32 s67, s66, 18432
    buffer_load_dwordx2 v[126:127], v7, s[8:11], s66 offen
    buffer_load_dwordx2 v[128:129], v7, s[8:11], s67 offen
    s_add_u32 s60, s55, 6
    s_lshl_b32 s63, s60, 9
    s_add_u32 s63, s63, s57
    buffer_load_dwordx2 v[132:133], v6, s[20:23], s63 offen
    s_add_u32 s63, s63, 18432
    buffer_load_dwordx2 v[134:135], v6, s[20:23], s63 offen
    s_lshl_b32 s63, s60, 5
    buffer_load_dwordx2 v[140:141], v8, s[48:51], s63 offen
    s_add_u32 s68, s63, s59
    s_add_u32 s69, s68, 18432
    buffer_load_dwordx2 v[136:137], v7, s[8:11], s68 offen
    buffer_load_dwordx2 v[138:139], v7, s[8:11], s69 offen
    v_mov_b32 v15, 0
    s_lshl_b32 s62, s79, 7
    s_add_u32 s62, s62, 28672
    s_add_u32 s72, s46, 88768512
    s_addc_u32 s73, s47, 0
    s_and_b32 s73, s73, 0xffff
    s_mov_b32 s74, 786432
    s_mov_b32 s75, 0x00020000
    s_barrier
    s_add_u32 s60, s55, 0
    s_lshl_b32 s60, s60, 16
    s_lshl_b32 s63, s54, 6
    s_add_u32 s60, s60, s63
    buffer_load_dwordx4 v[16:19], v5, s[24:27], s60 offen sc0 sc1
    s_add_u32 s60, s55, 3
    s_lshl_b32 s60, s60, 16
    s_lshl_b32 s63, s54, 6
    s_add_u32 s60, s60, s63
    buffer_load_dwordx4 v[20:23], v5, s[24:27], s60 offen sc0 sc1
    s_cmp_lt_u32 s60, 2097152
    s_cbranch_scc1 RT_YA1
    s_add_u32 s63, s60, 4292870144
    buffer_load_dwordx4 v[44:47], v5, s[72:75], s63 offen sc0 sc1
    s_add_u32 s63, s60, 4293132288
    buffer_load_dwordx4 v[48:51], v5, s[72:75], s63 offen sc0 sc1
    s_add_u32 s63, s60, 4293394432
    buffer_load_dwordx4 v[52:55], v5, s[72:75], s63 offen sc0 sc1
RT_YA1:
    s_add_u32 s60, s55, 6
    s_lshl_b32 s60, s60, 16
    s_lshl_b32 s63, s54, 6
    s_add_u32 s60, s60, s63
    buffer_load_dwordx4 v[24:27], v5, s[24:27], s60 offen sc0 sc1
    s_cmp_lt_u32 s60, 2097152
    s_cbranch_scc1 RT_YA2
    s_add_u32 s63, s60, 4292870144
    buffer_load_dwordx4 v[56:59], v5, s[72:75], s63 offen sc0 sc1
    s_add_u32 s63, s60, 4293132288
    buffer_load_dwordx4 v[60:63], v5, s[72:75], s63 offen sc0 sc1
    s_add_u32 s63, s60, 4293394432
    buffer_load_dwordx4 v[64:67], v5, s[72:75], s63 offen sc0 sc1
RT_YA2:
    s_waitcnt vmcnt(0)
    s_add_u32 s60, s55, 3
    s_cmp_lt_u32 s60, 32
    s_cbranch_scc1 RT_YB1
    v_lshlrev_b32 v72, 16, v20
    v_and_b32 v73, s58, v20
    v_lshlrev_b32 v74, 16, v21
    v_and_b32 v75, s58, v21
    v_lshlrev_b32 v76, 16, v22
    v_and_b32 v77, s58, v22
    v_lshlrev_b32 v78, 16, v23
    v_and_b32 v79, s58, v23
    v_dot2_f32_bf16 v72, v44, s94, v72
    v_dot2_f32_bf16 v73, v44, s95, v73
    v_dot2_f32_bf16 v74, v45, s94, v74
    v_dot2_f32_bf16 v75, v45, s95, v75
    v_dot2_f32_bf16 v76, v46, s94, v76
    v_dot2_f32_bf16 v77, v46, s95, v77
    v_dot2_f32_bf16 v78, v47, s94, v78
    v_dot2_f32_bf16 v79, v47, s95, v79
    v_dot2_f32_bf16 v72, v48, s94, v72
    v_dot2_f32_bf16 v73, v48, s95, v73
    v_dot2_f32_bf16 v74, v49, s94, v74
    v_dot2_f32_bf16 v75, v49, s95, v75
    v_dot2_f32_bf16 v76, v50, s94, v76
    v_dot2_f32_bf16 v77, v50, s95, v77
    v_dot2_f32_bf16 v78, v51, s94, v78
    v_dot2_f32_bf16 v79, v51, s95, v79
    v_dot2_f32_bf16 v72, v52, s94, v72
    v_dot2_f32_bf16 v73, v52, s95, v73
    v_dot2_f32_bf16 v74, v53, s94, v74
    v_dot2_f32_bf16 v75, v53, s95, v75
    v_dot2_f32_bf16 v76, v54, s94, v76
    v_dot2_f32_bf16 v77, v54, s95, v77
    v_dot2_f32_bf16 v78, v55, s94, v78
    v_dot2_f32_bf16 v79, v55, s95, v79
    s_nop 4
    v_cvt_pk_bf16_f32 v20, v72, v73
    v_cvt_pk_bf16_f32 v21, v74, v75
    v_cvt_pk_bf16_f32 v22, v76, v77
    v_cvt_pk_bf16_f32 v23, v78, v79
RT_YB1:
    s_add_u32 s60, s55, 6
    s_cmp_lt_u32 s60, 32
    s_cbranch_scc1 RT_YB2
    v_lshlrev_b32 v72, 16, v24
    v_and_b32 v73, s58, v24
    v_lshlrev_b32 v74, 16, v25
    v_and_b32 v75, s58, v25
    v_lshlrev_b32 v76, 16, v26
    v_and_b32 v77, s58, v26
    v_lshlrev_b32 v78, 16, v27
    v_and_b32 v79, s58, v27
    v_dot2_f32_bf16 v72, v56, s94, v72
    v_dot2_f32_bf16 v73, v56, s95, v73
    v_dot2_f32_bf16 v74, v57, s94, v74
    v_dot2_f32_bf16 v75, v57, s95, v75
    v_dot2_f32_bf16 v76, v58, s94, v76
    v_dot2_f32_bf16 v77, v58, s95, v77
    v_dot2_f32_bf16 v78, v59, s94, v78
    v_dot2_f32_bf16 v79, v59, s95, v79
    v_dot2_f32_bf16 v72, v60, s94, v72
    v_dot2_f32_bf16 v73, v60, s95, v73
    v_dot2_f32_bf16 v74, v61, s94, v74
    v_dot2_f32_bf16 v75, v61, s95, v75
    v_dot2_f32_bf16 v76, v62, s94, v76
    v_dot2_f32_bf16 v77, v62, s95, v77
    v_dot2_f32_bf16 v78, v63, s94, v78
    v_dot2_f32_bf16 v79, v63, s95, v79
    v_dot2_f32_bf16 v72, v64, s94, v72
    v_dot2_f32_bf16 v73, v64, s95, v73
    v_dot2_f32_bf16 v74, v65, s94, v74
    v_dot2_f32_bf16 v75, v65, s95, v75
    v_dot2_f32_bf16 v76, v66, s94, v76
    v_dot2_f32_bf16 v77, v66, s95, v77
    v_dot2_f32_bf16 v78, v67, s94, v78
    v_dot2_f32_bf16 v79, v67, s95, v79
    s_nop 4
    v_cvt_pk_bf16_f32 v24, v72, v73
    v_cvt_pk_bf16_f32 v25, v74, v75
    v_cvt_pk_bf16_f32 v26, v76, v77
    v_cvt_pk_bf16_f32 v27, v78, v79
RT_YB2:
    ds_write_b128 v9, v[16:19] offset:0
    ds_write_b128 v9, v[20:23] offset:1280
    ds_write_b128 v9, v[24:27] offset:2560
    s_waitcnt lgkmcnt(0)
    ds_read_u16 v168, v10 offset:0
    ds_read_u16 v169, v10 offset:80
    ds_read_u16 v170, v10 offset:160
    ds_read_u16 v171, v10 offset:240
    ds_read_u16 v172, v10 offset:32
    ds_read_u16 v173, v10 offset:112
    ds_read_u16 v174, v10 offset:192
    ds_read_u16 v175, v10 offset:272
    ds_read_u16 v176, v10 offset:1280
    ds_read_u16 v177, v10 offset:1360
    ds_read_u16 v178, v10 offset:1440
    ds_read_u16 v179, v10 offset:1520
    ds_read_u16 v180, v10 offset:1312
    ds_read_u16 v181, v10 offset:1392
    ds_read_u16 v182, v10 offset:1472
    ds_read_u16 v183, v10 offset:1552
    ds_read_u16 v184, v10 offset:2560
    ds_read_u16 v185, v10 offset:2640
    ds_read_u16 v186, v10 offset:2720
    ds_read_u16 v187, v10 offset:2800
    ds_read_u16 v188, v10 offset:2592
    ds_read_u16 v189, v10 offset:2672
    ds_read_u16 v190, v10 offset:2752
    ds_read_u16 v191, v10 offset:2832
    s_waitcnt lgkmcnt(0)
    v_lshlrev_b32 v12, 16, v116
    v_lshlrev_b32 v13, 16, v112
    v_lshlrev_b32 v14, 16, v120
    v_lshlrev_b32 v168, 16, v168
    v_mul_f32 v13, v13, v14
    v_cvt_pk_bf16_f32 v13, v13, v13
    v_lshlrev_b32 v13, 16, v13
    v_add_f32 v13, v168, v13
    v_cvt_pk_bf16_f32 v13, v13, v13
    v_lshlrev_b32 v13, 16, v13
    v_add_f32 v12, v12, v13
    v_cvt_pk_bf16_f32 v168, v12, v12
    v_lshlrev_b32 v168, 16, v168
    v_and_b32 v12, s58, v116
    v_and_b32 v13, s58, v112
    v_and_b32 v14, s58, v120
    v_lshlrev_b32 v169, 16, v169
    v_mul_f32 v13, v13, v14
    v_cvt_pk_bf16_f32 v13, v13, v13
    v_lshlrev_b32 v13, 16, v13
    v_add_f32 v13, v169, v13
    v_cvt_pk_bf16_f32 v13, v13, v13
    v_lshlrev_b32 v13, 16, v13
    v_add_f32 v12, v12, v13
    v_cvt_pk_bf16_f32 v169, v12, v12
    v_lshlrev_b32 v169, 16, v169
    v_lshlrev_b32 v12, 16, v117
    v_lshlrev_b32 v13, 16, v113
    v_lshlrev_b32 v14, 16, v121
    v_lshlrev_b32 v170, 16, v170
    v_mul_f32 v13, v13, v14
    v_cvt_pk_bf16_f32 v13, v13, v13
    v_lshlrev_b32 v13, 16, v13
    v_add_f32 v13, v170, v13
    v_cvt_pk_bf16_f32 v13, v13, v13
    v_lshlrev_b32 v13, 16, v13
    v_add_f32 v12, v12, v13
    v_cvt_pk_bf16_f32 v170, v12, v12
    v_lshlrev_b32 v170, 16, v170
    v_and_b32 v12, s58, v117
    v_and_b32 v13, s58, v113
    v_and_b32 v14, s58, v121
    v_lshlrev_b32 v171, 16, v171
    v_mul_f32 v13, v13, v14
    v_cvt_pk_bf16_f32 v13, v13, v13
    v_lshlrev_b32 v13, 16, v13
    v_add_f32 v13, v171, v13
    v_cvt_pk_bf16_f32 v13, v13, v13
    v_lshlrev_b32 v13, 16, v13
    v_add_f32 v12, v12, v13
    v_cvt_pk_bf16_f32 v171, v12, v12
    v_lshlrev_b32 v171, 16, v171
    v_lshlrev_b32 v12, 16, v118
    v_lshlrev_b32 v13, 16, v114
    v_lshlrev_b32 v14, 16, v120
    v_lshlrev_b32 v172, 16, v172
    v_mul_f32 v13, v13, v14
    v_cvt_pk_bf16_f32 v13, v13, v13
    v_lshlrev_b32 v13, 16, v13
    v_add_f32 v13, v172, v13
    v_cvt_pk_bf16_f32 v13, v13, v13
    v_lshlrev_b32 v13, 16, v13
    v_add_f32 v12, v12, v13
    v_cvt_pk_bf16_f32 v172, v12, v12
    v_lshlrev_b32 v172, 16, v172
    v_and_b32 v12, s58, v118
    v_and_b32 v13, s58, v114
    v_and_b32 v14, s58, v120
    v_lshlrev_b32 v173, 16, v173
    v_mul_f32 v13, v13, v14
    v_cvt_pk_bf16_f32 v13, v13, v13
    v_lshlrev_b32 v13, 16, v13
    v_add_f32 v13, v173, v13
    v_cvt_pk_bf16_f32 v13, v13, v13
    v_lshlrev_b32 v13, 16, v13
    v_add_f32 v12, v12, v13
    v_cvt_pk_bf16_f32 v173, v12, v12
    v_lshlrev_b32 v173, 16, v173
    v_lshlrev_b32 v12, 16, v119
    v_lshlrev_b32 v13, 16, v115
    v_lshlrev_b32 v14, 16, v121
    v_lshlrev_b32 v174, 16, v174
    v_mul_f32 v13, v13, v14
    v_cvt_pk_bf16_f32 v13, v13, v13
    v_lshlrev_b32 v13, 16, v13
    v_add_f32 v13, v174, v13
    v_cvt_pk_bf16_f32 v13, v13, v13
    v_lshlrev_b32 v13, 16, v13
    v_add_f32 v12, v12, v13
    v_cvt_pk_bf16_f32 v174, v12, v12
    v_lshlrev_b32 v174, 16, v174
    v_and_b32 v12, s58, v119
    v_and_b32 v13, s58, v115
    v_and_b32 v14, s58, v121
    v_lshlrev_b32 v175, 16, v175
    v_mul_f32 v13, v13, v14
    v_cvt_pk_bf16_f32 v13, v13, v13
    v_lshlrev_b32 v13, 16, v13
    v_add_f32 v13, v175, v13
    v_cvt_pk_bf16_f32 v13, v13, v13
    v_lshlrev_b32 v13, 16, v13
    v_add_f32 v12, v12, v13
    v_cvt_pk_bf16_f32 v175, v12, v12
    v_lshlrev_b32 v175, 16, v175
    v_lshlrev_b32 v12, 16, v126
    v_lshlrev_b32 v13, 16, v122
    v_lshlrev_b32 v14, 16, v130
    v_lshlrev_b32 v176, 16, v176
    v_mul_f32 v13, v13, v14
    v_cvt_pk_bf16_f32 v13, v13, v13
    v_lshlrev_b32 v13, 16, v13
    v_add_f32 v13, v176, v13
    v_cvt_pk_bf16_f32 v13, v13, v13
    v_lshlrev_b32 v13, 16, v13
    v_add_f32 v12, v12, v13
    v_cvt_pk_bf16_f32 v176, v12, v12
    v_lshlrev_b32 v176, 16, v176
    v_and_b32 v12, s58, v126
    v_and_b32 v13, s58, v122
    v_and_b32 v14, s58, v130
    v_lshlrev_b32 v177, 16, v177
    v_mul_f32 v13, v13, v14
    v_cvt_pk_bf16_f32 v13, v13, v13
    v_lshlrev_b32 v13, 16, v13
    v_add_f32 v13, v177, v13
    v_cvt_pk_bf16_f32 v13, v13, v13
    v_lshlrev_b32 v13, 16, v13
    v_add_f32 v12, v12, v13
    v_cvt_pk_bf16_f32 v177, v12, v12
    v_lshlrev_b32 v177, 16, v177
    v_lshlrev_b32 v12, 16, v127
    v_lshlrev_b32 v13, 16, v123
    v_lshlrev_b32 v14, 16, v131
    v_lshlrev_b32 v178, 16, v178
    v_mul_f32 v13, v13, v14
    v_cvt_pk_bf16_f32 v13, v13, v13
    v_lshlrev_b32 v13, 16, v13
    v_add_f32 v13, v178, v13
    v_cvt_pk_bf16_f32 v13, v13, v13
    v_lshlrev_b32 v13, 16, v13
    v_add_f32 v12, v12, v13
    v_cvt_pk_bf16_f32 v178, v12, v12
    v_lshlrev_b32 v178, 16, v178
    v_and_b32 v12, s58, v127
    v_and_b32 v13, s58, v123
    v_and_b32 v14, s58, v131
    v_lshlrev_b32 v179, 16, v179
    v_mul_f32 v13, v13, v14
    v_cvt_pk_bf16_f32 v13, v13, v13
    v_lshlrev_b32 v13, 16, v13
    v_add_f32 v13, v179, v13
    v_cvt_pk_bf16_f32 v13, v13, v13
    v_lshlrev_b32 v13, 16, v13
    v_add_f32 v12, v12, v13
    v_cvt_pk_bf16_f32 v179, v12, v12
    v_lshlrev_b32 v179, 16, v179
    v_lshlrev_b32 v12, 16, v128
    v_lshlrev_b32 v13, 16, v124
    v_lshlrev_b32 v14, 16, v130
    v_lshlrev_b32 v180, 16, v180
    v_mul_f32 v13, v13, v14
    v_cvt_pk_bf16_f32 v13, v13, v13
    v_lshlrev_b32 v13, 16, v13
    v_add_f32 v13, v180, v13
    v_cvt_pk_bf16_f32 v13, v13, v13
    v_lshlrev_b32 v13, 16, v13
    v_add_f32 v12, v12, v13
    v_cvt_pk_bf16_f32 v180, v12, v12
    v_lshlrev_b32 v180, 16, v180
    v_and_b32 v12, s58, v128
    v_and_b32 v13, s58, v124
    v_and_b32 v14, s58, v130
    v_lshlrev_b32 v181, 16, v181
    v_mul_f32 v13, v13, v14
    v_cvt_pk_bf16_f32 v13, v13, v13
    v_lshlrev_b32 v13, 16, v13
    v_add_f32 v13, v181, v13
    v_cvt_pk_bf16_f32 v13, v13, v13
    v_lshlrev_b32 v13, 16, v13
    v_add_f32 v12, v12, v13
    v_cvt_pk_bf16_f32 v181, v12, v12
    v_lshlrev_b32 v181, 16, v181
    v_lshlrev_b32 v12, 16, v129
    v_lshlrev_b32 v13, 16, v125
    v_lshlrev_b32 v14, 16, v131
    v_lshlrev_b32 v182, 16, v182
    v_mul_f32 v13, v13, v14
    v_cvt_pk_bf16_f32 v13, v13, v13
    v_lshlrev_b32 v13, 16, v13
    v_add_f32 v13, v182, v13
    v_cvt_pk_bf16_f32 v13, v13, v13
    v_lshlrev_b32 v13, 16, v13
    v_add_f32 v12, v12, v13
    v_cvt_pk_bf16_f32 v182, v12, v12
    v_lshlrev_b32 v182, 16, v182
    v_and_b32 v12, s58, v129
    v_and_b32 v13, s58, v125
    v_and_b32 v14, s58, v131
    v_lshlrev_b32 v183, 16, v183
    v_mul_f32 v13, v13, v14
    v_cvt_pk_bf16_f32 v13, v13, v13
    v_lshlrev_b32 v13, 16, v13
    v_add_f32 v13, v183, v13
    v_cvt_pk_bf16_f32 v13, v13, v13
    v_lshlrev_b32 v13, 16, v13
    v_add_f32 v12, v12, v13
    v_cvt_pk_bf16_f32 v183, v12, v12
    v_lshlrev_b32 v183, 16, v183
    v_lshlrev_b32 v12, 16, v136
    v_lshlrev_b32 v13, 16, v132
    v_lshlrev_b32 v14, 16, v140
    v_lshlrev_b32 v184, 16, v184
    v_mul_f32 v13, v13, v14
    v_cvt_pk_bf16_f32 v13, v13, v13
    v_lshlrev_b32 v13, 16, v13
    v_add_f32 v13, v184, v13
    v_cvt_pk_bf16_f32 v13, v13, v13
    v_lshlrev_b32 v13, 16, v13
    v_add_f32 v12, v12, v13
    v_cvt_pk_bf16_f32 v184, v12, v12
    v_lshlrev_b32 v184, 16, v184
    v_and_b32 v12, s58, v136
    v_and_b32 v13, s58, v132
    v_and_b32 v14, s58, v140
    v_lshlrev_b32 v185, 16, v185
    v_mul_f32 v13, v13, v14
    v_cvt_pk_bf16_f32 v13, v13, v13
    v_lshlrev_b32 v13, 16, v13
    v_add_f32 v13, v185, v13
    v_cvt_pk_bf16_f32 v13, v13, v13
    v_lshlrev_b32 v13, 16, v13
    v_add_f32 v12, v12, v13
    v_cvt_pk_bf16_f32 v185, v12, v12
    v_lshlrev_b32 v185, 16, v185
    v_lshlrev_b32 v12, 16, v137
    v_lshlrev_b32 v13, 16, v133
    v_lshlrev_b32 v14, 16, v141
    v_lshlrev_b32 v186, 16, v186
    v_mul_f32 v13, v13, v14
    v_cvt_pk_bf16_f32 v13, v13, v13
    v_lshlrev_b32 v13, 16, v13
    v_add_f32 v13, v186, v13
    v_cvt_pk_bf16_f32 v13, v13, v13
    v_lshlrev_b32 v13, 16, v13
    v_add_f32 v12, v12, v13
    v_cvt_pk_bf16_f32 v186, v12, v12
    v_lshlrev_b32 v186, 16, v186
    v_and_b32 v12, s58, v137
    v_and_b32 v13, s58, v133
    v_and_b32 v14, s58, v141
    v_lshlrev_b32 v187, 16, v187
    v_mul_f32 v13, v13, v14
    v_cvt_pk_bf16_f32 v13, v13, v13
    v_lshlrev_b32 v13, 16, v13
    v_add_f32 v13, v187, v13
    v_cvt_pk_bf16_f32 v13, v13, v13
    v_lshlrev_b32 v13, 16, v13
    v_add_f32 v12, v12, v13
    v_cvt_pk_bf16_f32 v187, v12, v12
    v_lshlrev_b32 v187, 16, v187
    v_lshlrev_b32 v12, 16, v138
    v_lshlrev_b32 v13, 16, v134
    v_lshlrev_b32 v14, 16, v140
    v_lshlrev_b32 v188, 16, v188
    v_mul_f32 v13, v13, v14
    v_cvt_pk_bf16_f32 v13, v13, v13
    v_lshlrev_b32 v13, 16, v13
    v_add_f32 v13, v188, v13
    v_cvt_pk_bf16_f32 v13, v13, v13
    v_lshlrev_b32 v13, 16, v13
    v_add_f32 v12, v12, v13
    v_cvt_pk_bf16_f32 v188, v12, v12
    v_lshlrev_b32 v188, 16, v188
    v_and_b32 v12, s58, v138
    v_and_b32 v13, s58, v134
    v_and_b32 v14, s58, v140
    v_lshlrev_b32 v189, 16, v189
    v_mul_f32 v13, v13, v14
    v_cvt_pk_bf16_f32 v13, v13, v13
    v_lshlrev_b32 v13, 16, v13
    v_add_f32 v13, v189, v13
    v_cvt_pk_bf16_f32 v13, v13, v13
    v_lshlrev_b32 v13, 16, v13
    v_add_f32 v12, v12, v13
    v_cvt_pk_bf16_f32 v189, v12, v12
    v_lshlrev_b32 v189, 16, v189
    v_lshlrev_b32 v12, 16, v139
    v_lshlrev_b32 v13, 16, v135
    v_lshlrev_b32 v14, 16, v141
    v_lshlrev_b32 v190, 16, v190
    v_mul_f32 v13, v13, v14
    v_cvt_pk_bf16_f32 v13, v13, v13
    v_lshlrev_b32 v13, 16, v13
    v_add_f32 v13, v190, v13
    v_cvt_pk_bf16_f32 v13, v13, v13
    v_lshlrev_b32 v13, 16, v13
    v_add_f32 v12, v12, v13
    v_cvt_pk_bf16_f32 v190, v12, v12
    v_lshlrev_b32 v190, 16, v190
    v_and_b32 v12, s58, v139
    v_and_b32 v13, s58, v135
    v_and_b32 v14, s58, v141
    v_lshlrev_b32 v191, 16, v191
    v_mul_f32 v13, v13, v14
    v_cvt_pk_bf16_f32 v13, v13, v13
    v_lshlrev_b32 v13, 16, v13
    v_add_f32 v13, v191, v13
    v_cvt_pk_bf16_f32 v13, v13, v13
    v_lshlrev_b32 v13, 16, v13
    v_add_f32 v12, v12, v13
    v_cvt_pk_bf16_f32 v191, v12, v12
    v_lshlrev_b32 v191, 16, v191
    s_barrier
    s_add_u32 s60, s55, 0
    s_lshl_b32 s60, s60, 10
    s_add_u32 s60, s60, s57
    buffer_load_dwordx4 v[32:35], v2, s[12:15], s60 offen sc0 sc1
    s_add_u32 s60, s60, 2359296
    buffer_load_dwordx4 v[36:39], v2, s[12:15], s60 offen sc0 sc1
    s_add_u32 s60, s60, 2359296
    buffer_load_dwordx4 v[40:43], v2, s[12:15], s60 offen sc0 sc1
    s_add_u32 s60, s60, 2359296
    buffer_load_dwordx4 v[44:47], v2, s[12:15], s60 offen sc0 sc1
    s_add_u32 s60, s60, 2359296
    buffer_load_dwordx4 v[48:51], v2, s[12:15], s60 offen sc0 sc1
    s_add_u32 s60, s60, 2359296
    buffer_load_dwordx4 v[52:55], v2, s[12:15], s60 offen sc0 sc1
    s_add_u32 s60, s60, 2359296
    buffer_load_dwordx4 v[56:59], v2, s[12:15], s60 offen sc0 sc1
    s_add_u32 s60, s60, 2359296
    buffer_load_dwordx4 v[60:63], v2, s[12:15], s60 offen sc0 sc1
    s_waitcnt vmcnt(6)
    v_lshlrev_b32 v144, 16, v32
    v_and_b32 v145, s58, v32
    v_lshlrev_b32 v146, 16, v33
    v_and_b32 v147, s58, v33
    v_lshlrev_b32 v148, 16, v34
    v_and_b32 v149, s58, v34
    v_lshlrev_b32 v150, 16, v35
    v_and_b32 v151, s58, v35
    v_dot2_f32_bf16 v144, v36, s94, v144
    v_dot2_f32_bf16 v145, v36, s95, v145
    v_dot2_f32_bf16 v146, v37, s94, v146
    v_dot2_f32_bf16 v147, v37, s95, v147
    v_dot2_f32_bf16 v148, v38, s94, v148
    v_dot2_f32_bf16 v149, v38, s95, v149
    v_dot2_f32_bf16 v150, v39, s94, v150
    v_dot2_f32_bf16 v151, v39, s95, v151
    s_waitcnt vmcnt(4)
    v_dot2_f32_bf16 v144, v40, s94, v144
    v_dot2_f32_bf16 v145, v40, s95, v145
    v_dot2_f32_bf16 v146, v41, s94, v146
    v_dot2_f32_bf16 v147, v41, s95, v147
    v_dot2_f32_bf16 v148, v42, s94, v148
    v_dot2_f32_bf16 v149, v42, s95, v149
    v_dot2_f32_bf16 v150, v43, s94, v150
    v_dot2_f32_bf16 v151, v43, s95, v151
    v_dot2_f32_bf16 v144, v44, s94, v144
    v_dot2_f32_bf16 v145, v44, s95, v145
    v_dot2_f32_bf16 v146, v45, s94, v146
    v_dot2_f32_bf16 v147, v45, s95, v147
    v_dot2_f32_bf16 v148, v46, s94, v148
    v_dot2_f32_bf16 v149, v46, s95, v149
    v_dot2_f32_bf16 v150, v47, s94, v150
    v_dot2_f32_bf16 v151, v47, s95, v151
    s_waitcnt vmcnt(2)
    v_dot2_f32_bf16 v144, v48, s94, v144
    v_dot2_f32_bf16 v145, v48, s95, v145
    v_dot2_f32_bf16 v146, v49, s94, v146
    v_dot2_f32_bf16 v147, v49, s95, v147
    v_dot2_f32_bf16 v148, v50, s94, v148
    v_dot2_f32_bf16 v149, v50, s95, v149
    v_dot2_f32_bf16 v150, v51, s94, v150
    v_dot2_f32_bf16 v151, v51, s95, v151
    v_dot2_f32_bf16 v144, v52, s94, v144
    v_dot2_f32_bf16 v145, v52, s95, v145
    v_dot2_f32_bf16 v146, v53, s94, v146
    v_dot2_f32_bf16 v147, v53, s95, v147
    v_dot2_f32_bf16 v148, v54, s94, v148
    v_dot2_f32_bf16 v149, v54, s95, v149
    v_dot2_f32_bf16 v150, v55, s94, v150
    v_dot2_f32_bf16 v151, v55, s95, v151
    s_waitcnt vmcnt(0)
    v_dot2_f32_bf16 v144, v56, s94, v144
    v_dot2_f32_bf16 v145, v56, s95, v145
    v_dot2_f32_bf16 v146, v57, s94, v146
    v_dot2_f32_bf16 v147, v57, s95, v147
    v_dot2_f32_bf16 v148, v58, s94, v148
    v_dot2_f32_bf16 v149, v58, s95, v149
    v_dot2_f32_bf16 v150, v59, s94, v150
    v_dot2_f32_bf16 v151, v59, s95, v151
    v_dot2_f32_bf16 v144, v60, s94, v144
    v_dot2_f32_bf16 v145, v60, s95, v145
    v_dot2_f32_bf16 v146, v61, s94, v146
    v_dot2_f32_bf16 v147, v61, s95, v147
    v_dot2_f32_bf16 v148, v62, s94, v148
    v_dot2_f32_bf16 v149, v62, s95, v149
    v_dot2_f32_bf16 v150, v63, s94, v150
    v_dot2_f32_bf16 v151, v63, s95, v151
    s_nop 4
    v_cvt_pk_bf16_f32 v144, v144, v144
    v_lshlrev_b32 v144, 16, v144
    v_add_f32 v144, v168, v144
    v_cvt_pk_bf16_f32 v145, v145, v145
    v_lshlrev_b32 v145, 16, v145
    v_add_f32 v145, v169, v145
    v_cvt_pk_bf16_f32 v146, v146, v146
    v_lshlrev_b32 v146, 16, v146
    v_add_f32 v146, v170, v146
    v_cvt_pk_bf16_f32 v147, v147, v147
    v_lshlrev_b32 v147, 16, v147
    v_add_f32 v147, v171, v147
    v_cvt_pk_bf16_f32 v148, v148, v148
    v_lshlrev_b32 v148, 16, v148
    v_add_f32 v148, v172, v148
    v_cvt_pk_bf16_f32 v149, v149, v149
    v_lshlrev_b32 v149, 16, v149
    v_add_f32 v149, v173, v149
    v_cvt_pk_bf16_f32 v150, v150, v150
    v_lshlrev_b32 v150, 16, v150
    v_add_f32 v150, v174, v150
    v_cvt_pk_bf16_f32 v151, v151, v151
    v_lshlrev_b32 v151, 16, v151
    v_add_f32 v151, v175, v151
    v_cvt_pk_bf16_f32 v112, v144, v145
    v_cvt_pk_bf16_f32 v113, v146, v147
    v_cvt_pk_bf16_f32 v114, v148, v149
    v_cvt_pk_bf16_f32 v115, v150, v151
    buffer_store_dwordx2 v[112:113], v7, s[4:7], s64 offen
    buffer_store_dwordx2 v[114:115], v7, s[4:7], s65 offen
    s_barrier
    s_add_u32 s60, s55, 3
    s_lshl_b32 s60, s60, 10
    s_add_u32 s60, s60, s57
    buffer_load_dwordx4 v[32:35], v2, s[12:15], s60 offen sc0 sc1
    s_add_u32 s60, s60, 2359296
    buffer_load_dwordx4 v[36:39], v2, s[12:15], s60 offen sc0 sc1
    s_add_u32 s60, s60, 2359296
    buffer_load_dwordx4 v[40:43], v2, s[12:15], s60 offen sc0 sc1
    s_add_u32 s60, s60, 2359296
    buffer_load_dwordx4 v[44:47], v2, s[12:15], s60 offen sc0 sc1
    s_add_u32 s60, s60, 2359296
    buffer_load_dwordx4 v[48:51], v2, s[12:15], s60 offen sc0 sc1
    s_add_u32 s60, s60, 2359296
    buffer_load_dwordx4 v[52:55], v2, s[12:15], s60 offen sc0 sc1
    s_add_u32 s60, s60, 2359296
    buffer_load_dwordx4 v[56:59], v2, s[12:15], s60 offen sc0 sc1
    s_add_u32 s60, s60, 2359296
    buffer_load_dwordx4 v[60:63], v2, s[12:15], s60 offen sc0 sc1
    s_waitcnt vmcnt(6)
    v_lshlrev_b32 v152, 16, v32
    v_and_b32 v153, s58, v32
    v_lshlrev_b32 v154, 16, v33
    v_and_b32 v155, s58, v33
    v_lshlrev_b32 v156, 16, v34
    v_and_b32 v157, s58, v34
    v_lshlrev_b32 v158, 16, v35
    v_and_b32 v159, s58, v35
    v_dot2_f32_bf16 v152, v36, s94, v152
    v_dot2_f32_bf16 v153, v36, s95, v153
    v_dot2_f32_bf16 v154, v37, s94, v154
    v_dot2_f32_bf16 v155, v37, s95, v155
    v_dot2_f32_bf16 v156, v38, s94, v156
    v_dot2_f32_bf16 v157, v38, s95, v157
    v_dot2_f32_bf16 v158, v39, s94, v158
    v_dot2_f32_bf16 v159, v39, s95, v159
    s_waitcnt vmcnt(4)
    v_dot2_f32_bf16 v152, v40, s94, v152
    v_dot2_f32_bf16 v153, v40, s95, v153
    v_dot2_f32_bf16 v154, v41, s94, v154
    v_dot2_f32_bf16 v155, v41, s95, v155
    v_dot2_f32_bf16 v156, v42, s94, v156
    v_dot2_f32_bf16 v157, v42, s95, v157
    v_dot2_f32_bf16 v158, v43, s94, v158
    v_dot2_f32_bf16 v159, v43, s95, v159
    v_dot2_f32_bf16 v152, v44, s94, v152
    v_dot2_f32_bf16 v153, v44, s95, v153
    v_dot2_f32_bf16 v154, v45, s94, v154
    v_dot2_f32_bf16 v155, v45, s95, v155
    v_dot2_f32_bf16 v156, v46, s94, v156
    v_dot2_f32_bf16 v157, v46, s95, v157
    v_dot2_f32_bf16 v158, v47, s94, v158
    v_dot2_f32_bf16 v159, v47, s95, v159
    s_waitcnt vmcnt(2)
    v_dot2_f32_bf16 v152, v48, s94, v152
    v_dot2_f32_bf16 v153, v48, s95, v153
    v_dot2_f32_bf16 v154, v49, s94, v154
    v_dot2_f32_bf16 v155, v49, s95, v155
    v_dot2_f32_bf16 v156, v50, s94, v156
    v_dot2_f32_bf16 v157, v50, s95, v157
    v_dot2_f32_bf16 v158, v51, s94, v158
    v_dot2_f32_bf16 v159, v51, s95, v159
    v_dot2_f32_bf16 v152, v52, s94, v152
    v_dot2_f32_bf16 v153, v52, s95, v153
    v_dot2_f32_bf16 v154, v53, s94, v154
    v_dot2_f32_bf16 v155, v53, s95, v155
    v_dot2_f32_bf16 v156, v54, s94, v156
    v_dot2_f32_bf16 v157, v54, s95, v157
    v_dot2_f32_bf16 v158, v55, s94, v158
    v_dot2_f32_bf16 v159, v55, s95, v159
    s_waitcnt vmcnt(0)
    v_dot2_f32_bf16 v152, v56, s94, v152
    v_dot2_f32_bf16 v153, v56, s95, v153
    v_dot2_f32_bf16 v154, v57, s94, v154
    v_dot2_f32_bf16 v155, v57, s95, v155
    v_dot2_f32_bf16 v156, v58, s94, v156
    v_dot2_f32_bf16 v157, v58, s95, v157
    v_dot2_f32_bf16 v158, v59, s94, v158
    v_dot2_f32_bf16 v159, v59, s95, v159
    v_dot2_f32_bf16 v152, v60, s94, v152
    v_dot2_f32_bf16 v153, v60, s95, v153
    v_dot2_f32_bf16 v154, v61, s94, v154
    v_dot2_f32_bf16 v155, v61, s95, v155
    v_dot2_f32_bf16 v156, v62, s94, v156
    v_dot2_f32_bf16 v157, v62, s95, v157
    v_dot2_f32_bf16 v158, v63, s94, v158
    v_dot2_f32_bf16 v159, v63, s95, v159
    s_nop 4
    v_cvt_pk_bf16_f32 v152, v152, v152
    v_lshlrev_b32 v152, 16, v152
    v_add_f32 v152, v176, v152
    v_cvt_pk_bf16_f32 v153, v153, v153
    v_lshlrev_b32 v153, 16, v153
    v_add_f32 v153, v177, v153
    v_cvt_pk_bf16_f32 v154, v154, v154
    v_lshlrev_b32 v154, 16, v154
    v_add_f32 v154, v178, v154
    v_cvt_pk_bf16_f32 v155, v155, v155
    v_lshlrev_b32 v155, 16, v155
    v_add_f32 v155, v179, v155
    v_cvt_pk_bf16_f32 v156, v156, v156
    v_lshlrev_b32 v156, 16, v156
    v_add_f32 v156, v180, v156
    v_cvt_pk_bf16_f32 v157, v157, v157
    v_lshlrev_b32 v157, 16, v157
    v_add_f32 v157, v181, v157
    v_cvt_pk_bf16_f32 v158, v158, v158
    v_lshlrev_b32 v158, 16, v158
    v_add_f32 v158, v182, v158
    v_cvt_pk_bf16_f32 v159, v159, v159
    v_lshlrev_b32 v159, 16, v159
    v_add_f32 v159, v183, v159
    v_cvt_pk_bf16_f32 v122, v152, v153
    v_cvt_pk_bf16_f32 v123, v154, v155
    v_cvt_pk_bf16_f32 v124, v156, v157
    v_cvt_pk_bf16_f32 v125, v158, v159
    buffer_store_dwordx2 v[122:123], v7, s[4:7], s66 offen
    buffer_store_dwordx2 v[124:125], v7, s[4:7], s67 offen
    s_barrier
    s_add_u32 s60, s55, 6
    s_lshl_b32 s60, s60, 10
    s_add_u32 s60, s60, s57
    buffer_load_dwordx4 v[32:35], v2, s[12:15], s60 offen sc0 sc1
    s_add_u32 s60, s60, 2359296
    buffer_load_dwordx4 v[36:39], v2, s[12:15], s60 offen sc0 sc1
    s_add_u32 s60, s60, 2359296
    buffer_load_dwordx4 v[40:43], v2, s[12:15], s60 offen sc0 sc1
    s_add_u32 s60, s60, 2359296
    buffer_load_dwordx4 v[44:47], v2, s[12:15], s60 offen sc0 sc1
    s_add_u32 s60, s60, 2359296
    buffer_load_dwordx4 v[48:51], v2, s[12:15], s60 offen sc0 sc1
    s_add_u32 s60, s60, 2359296
    buffer_load_dwordx4 v[52:55], v2, s[12:15], s60 offen sc0 sc1
    s_add_u32 s60, s60, 2359296
    buffer_load_dwordx4 v[56:59], v2, s[12:15], s60 offen sc0 sc1
    s_add_u32 s60, s60, 2359296
    buffer_load_dwordx4 v[60:63], v2, s[12:15], s60 offen sc0 sc1
    s_waitcnt vmcnt(6)
    v_lshlrev_b32 v160, 16, v32
    v_and_b32 v161, s58, v32
    v_lshlrev_b32 v162, 16, v33
    v_and_b32 v163, s58, v33
    v_lshlrev_b32 v164, 16, v34
    v_and_b32 v165, s58, v34
    v_lshlrev_b32 v166, 16, v35
    v_and_b32 v167, s58, v35
    v_dot2_f32_bf16 v160, v36, s94, v160
    v_dot2_f32_bf16 v161, v36, s95, v161
    v_dot2_f32_bf16 v162, v37, s94, v162
    v_dot2_f32_bf16 v163, v37, s95, v163
    v_dot2_f32_bf16 v164, v38, s94, v164
    v_dot2_f32_bf16 v165, v38, s95, v165
    v_dot2_f32_bf16 v166, v39, s94, v166
    v_dot2_f32_bf16 v167, v39, s95, v167
    s_waitcnt vmcnt(4)
    v_dot2_f32_bf16 v160, v40, s94, v160
    v_dot2_f32_bf16 v161, v40, s95, v161
    v_dot2_f32_bf16 v162, v41, s94, v162
    v_dot2_f32_bf16 v163, v41, s95, v163
    v_dot2_f32_bf16 v164, v42, s94, v164
    v_dot2_f32_bf16 v165, v42, s95, v165
    v_dot2_f32_bf16 v166, v43, s94, v166
    v_dot2_f32_bf16 v167, v43, s95, v167
    v_dot2_f32_bf16 v160, v44, s94, v160
    v_dot2_f32_bf16 v161, v44, s95, v161
    v_dot2_f32_bf16 v162, v45, s94, v162
    v_dot2_f32_bf16 v163, v45, s95, v163
    v_dot2_f32_bf16 v164, v46, s94, v164
    v_dot2_f32_bf16 v165, v46, s95, v165
    v_dot2_f32_bf16 v166, v47, s94, v166
    v_dot2_f32_bf16 v167, v47, s95, v167
    s_waitcnt vmcnt(2)
    v_dot2_f32_bf16 v160, v48, s94, v160
    v_dot2_f32_bf16 v161, v48, s95, v161
    v_dot2_f32_bf16 v162, v49, s94, v162
    v_dot2_f32_bf16 v163, v49, s95, v163
    v_dot2_f32_bf16 v164, v50, s94, v164
    v_dot2_f32_bf16 v165, v50, s95, v165
    v_dot2_f32_bf16 v166, v51, s94, v166
    v_dot2_f32_bf16 v167, v51, s95, v167
    v_dot2_f32_bf16 v160, v52, s94, v160
    v_dot2_f32_bf16 v161, v52, s95, v161
    v_dot2_f32_bf16 v162, v53, s94, v162
    v_dot2_f32_bf16 v163, v53, s95, v163
    v_dot2_f32_bf16 v164, v54, s94, v164
    v_dot2_f32_bf16 v165, v54, s95, v165
    v_dot2_f32_bf16 v166, v55, s94, v166
    v_dot2_f32_bf16 v167, v55, s95, v167
    s_waitcnt vmcnt(0)
    v_dot2_f32_bf16 v160, v56, s94, v160
    v_dot2_f32_bf16 v161, v56, s95, v161
    v_dot2_f32_bf16 v162, v57, s94, v162
    v_dot2_f32_bf16 v163, v57, s95, v163
    v_dot2_f32_bf16 v164, v58, s94, v164
    v_dot2_f32_bf16 v165, v58, s95, v165
    v_dot2_f32_bf16 v166, v59, s94, v166
    v_dot2_f32_bf16 v167, v59, s95, v167
    v_dot2_f32_bf16 v160, v60, s94, v160
    v_dot2_f32_bf16 v161, v60, s95, v161
    v_dot2_f32_bf16 v162, v61, s94, v162
    v_dot2_f32_bf16 v163, v61, s95, v163
    v_dot2_f32_bf16 v164, v62, s94, v164
    v_dot2_f32_bf16 v165, v62, s95, v165
    v_dot2_f32_bf16 v166, v63, s94, v166
    v_dot2_f32_bf16 v167, v63, s95, v167
    s_nop 4
    v_cvt_pk_bf16_f32 v160, v160, v160
    v_lshlrev_b32 v160, 16, v160
    v_add_f32 v160, v184, v160
    v_cvt_pk_bf16_f32 v161, v161, v161
    v_lshlrev_b32 v161, 16, v161
    v_add_f32 v161, v185, v161
    v_cvt_pk_bf16_f32 v162, v162, v162
    v_lshlrev_b32 v162, 16, v162
    v_add_f32 v162, v186, v162
    v_cvt_pk_bf16_f32 v163, v163, v163
    v_lshlrev_b32 v163, 16, v163
    v_add_f32 v163, v187, v163
    v_cvt_pk_bf16_f32 v164, v164, v164
    v_lshlrev_b32 v164, 16, v164
    v_add_f32 v164, v188, v164
    v_cvt_pk_bf16_f32 v165, v165, v165
    v_lshlrev_b32 v165, 16, v165
    v_add_f32 v165, v189, v165
    v_cvt_pk_bf16_f32 v166, v166, v166
    v_lshlrev_b32 v166, 16, v166
    v_add_f32 v166, v190, v166
    v_cvt_pk_bf16_f32 v167, v167, v167
    v_lshlrev_b32 v167, 16, v167
    v_add_f32 v167, v191, v167
    v_cvt_pk_bf16_f32 v132, v160, v161
    v_cvt_pk_bf16_f32 v133, v162, v163
    v_cvt_pk_bf16_f32 v134, v164, v165
    v_cvt_pk_bf16_f32 v135, v166, v167
    buffer_store_dwordx2 v[132:133], v7, s[4:7], s68 offen
    buffer_store_dwordx2 v[134:135], v7, s[4:7], s69 offen
C_END:
    s_endpgm
.section .rodata,"a"
.p2align 6
.amdhsa_kernel prep_kernel
  .amdhsa_next_free_vgpr 112
  .amdhsa_next_free_sgpr 102
  .amdhsa_accum_offset 112
  .amdhsa_group_segment_fixed_size 0
  .amdhsa_kernarg_size 128
  .amdhsa_user_sgpr_count 2
  .amdhsa_user_sgpr_kernarg_segment_ptr 1
  .amdhsa_system_sgpr_workgroup_id_x 1
.end_amdhsa_kernel
.p2align 6
.amdhsa_kernel gemm1_kernel
  .amdhsa_next_free_vgpr 256
  .amdhsa_next_free_sgpr 102
  .amdhsa_accum_offset 256
  .amdhsa_group_segment_fixed_size 0
  .amdhsa_kernarg_size 128
  .amdhsa_user_sgpr_count 2
  .amdhsa_user_sgpr_kernarg_segment_ptr 1
  .amdhsa_system_sgpr_workgroup_id_x 1
.end_amdhsa_kernel
```
